```python
import torch

def _softmax(x, axis=-1):
    return torch.softmax(x, dim=axis)
def _gelu(x):
    return torch.nn.functional.gelu(x, approximate="tanh")
def _silu(x):
    return torch.nn.functional.silu(x)
def _sigmoid(x):
    return torch.sigmoid(x)
def _layernorm(x, axis=-1, eps=1e-5):
    m = x.mean(dim=axis, keepdim=True)
    v = x.var(dim=axis, keepdim=True, unbiased=False)
    return (x - m) / torch.sqrt(v + eps)
def _scatter_add(tgt, idx, src, axis=0):
    return tgt.clone().index_add_(axis, idx, src)
def _segment_sum(src, seg, n):
    out = torch.zeros((n,) + src.shape[1:], dtype=src.dtype)
    return out.index_add_(0, seg, src)
def _pad(x, pw):
    flat = tuple(v for pair in reversed(pw) for v in pair)
    return torch.nn.functional.pad(x, flat)

kernel_name = 'interleave_layers__softmax_full_mha__dense_activation_mish__prompt'

def setup_inputs():

    _w = (lambda a: (lambda t: t.to(torch.bfloat16) if t.is_floating_point() else t)(torch.as_tensor(a)))
    def _A_setup():
        B, S, D = 1, 2048, 512
        return {
            "x": _w((lambda *s: torch.randn(*s, dtype=torch.bfloat16) * 0.05)(B, S, D)),
            "wqkv": _w((lambda *s: torch.randn(*s, dtype=torch.bfloat16) * 0.05)(D, 3 * D)),
            "wo": _w((lambda *s: torch.randn(*s, dtype=torch.bfloat16) * 0.05)(D, D)),
        }
    _A_in = _A_setup()

    def _B_setup():
        B, S, D, F = 1, 2048, 512, 1792
        return {
            "x": _w((lambda *s: torch.randn(*s, dtype=torch.bfloat16) * 0.05)(B, S, D)),
            "w1": _w((lambda *s: torch.randn(*s, dtype=torch.bfloat16) * 1.6)(D, F) * (D ** -0.5)),
            "b1": _w((lambda *s: torch.randn(*s, dtype=torch.bfloat16) * 0.4)(F)),
            "w2": _w((lambda *s: torch.randn(*s, dtype=torch.bfloat16) * 0.2)(F, D) * (F ** -0.5)),
        }
    _B_in = _B_setup()

    return {
        "A_x": _A_in["x"],
        "A_wqkv": _A_in["wqkv"],
        "A_wo": _A_in["wo"],
        "B_x": _B_in["x"],
        "B_w1": _B_in["w1"],
        "B_b1": _B_in["b1"],
        "B_w2": _B_in["w2"],
    }

def reference(A_x, A_wqkv, A_wo, B_x, B_w1, B_b1, B_w2):
    def _A_ref(x, wqkv, wo):
        B, S, D = x.shape
        H = 32; Dh = D // H
        qkv = (lambda x, *d: x.permute(*d))((x @ wqkv).reshape(B, S, 3, H, Dh), 2, 0, 3, 1, 4)
        q, k, v = qkv[0], qkv[1], qkv[2]
        scale = Dh ** -0.5
        scores = torch.einsum("bhqd,bhkd->bhqk", q, k) * scale
        p = _softmax(scores, axis=-1)
        o = torch.einsum("bhqk,bhkd->bhqd", p, v)
        return (lambda x, *d: x.permute(*d))(o, 0, 2, 1, 3).reshape(B, S, D) @ wo

    def _B_ref(x, w1, b1, w2):
        h = torch.einsum("bsd,df->bsf", x, w1) + b1
        sp = torch.log1p(torch.exp(-torch.abs(h))) + torch.where(h > 0, h, torch.zeros_like(h))
        act = h * torch.tanh(sp)
        return torch.einsum("bsf,fd->bsd", act, w2)

    x = A_x
    x = x + _A_ref(_layernorm(x, axis=-1), A_wqkv, A_wo)
    x = x + _B_ref(_layernorm(x, axis=-1), B_w1, B_b1, B_w2)
    x = x + _A_ref(_layernorm(x, axis=-1), A_wqkv, A_wo)
    x = x + _B_ref(_layernorm(x, axis=-1), B_w1, B_b1, B_w2)
    return x
```

```asm
; @launch kernel=qkv1_kernel grid=(256,1,1) block=(512,1,1) lds=118784
; @launch kernel=attn_kernel grid=(256,1,1) block=(768,1,1) lds=133120
; @launch kernel=wo1_kernel grid=(256,1,1) block=(512,1,1) lds=131072
; @launch kernel=ffa1_kernel grid=(224,1,1) block=(512,1,1) lds=135168
; @launch kernel=ffb1_kernel grid=(256,1,1) block=(512,1,1) lds=114688
; @launch kernel=qkv2_kernel grid=(256,1,1) block=(512,1,1) lds=118784
; @launch kernel=attn_kernel grid=(256,1,1) block=(768,1,1) lds=133120
; @launch kernel=wo2_kernel grid=(256,1,1) block=(512,1,1) lds=131072
; @launch kernel=ffa2_kernel grid=(224,1,1) block=(512,1,1) lds=135168
; @launch kernel=ffb2_kernel grid=(256,1,1) block=(512,1,1) lds=114688
.amdgcn_target "amdgcn-amd-amdhsa--gfx950"
.text
.globl qkv1_kernel
.p2align 8
.type qkv1_kernel,@function
qkv1_kernel:
    s_cmp_ge_u32 s2, 256
    s_cbranch_scc1 qkv1_kernel_end
    s_load_dwordx2 s[28:29], s[0:1], 72
    s_load_dwordx2 s[30:31], s[0:1], 8
    s_load_dwordx2 s[32:33], s[0:1], 0
    s_load_dwordx2 s[34:35], s[0:1], 40
    v_and_b32 v1, 63, v0
    v_lshrrev_b32 v2, 6, v0
    s_bfe_u32 s20, s2, 0x20001
    v_readfirstlane_b32 s44, v2
    s_lshl_b32 s20, s20, 2
    s_bfe_u32 s22, s2, 0x20003
    s_add_u32 s20, s20, s22
    s_and_b32 s21, s2, 1
    s_mul_i32 s21, s21, 8
    s_lshr_b32 s22, s2, 5
    s_add_u32 s21, s21, s22
    s_and_b32 s3, s44, 3
    s_lshl_b32 s26, s3, 12
    s_lshl_b32 s22, s20, 7
    s_lshl_b32 s23, s3, 5
    s_add_u32 s22, s22, s23
    s_cmp_lt_u32 s44, 4
    s_cbranch_scc1 qkv1_kernel_comp
    v_lshrrev_b32 v2, 3, v1
    v_and_b32 v3, 7, v1
    v_lshrrev_b32 v4, 4, v1
    v_add_u32 v2, s22, v2
    v_lshlrev_b32 v2, 10, v2
    v_or_b32 v5, 0, v4
    v_xor_b32 v5, v5, v3
    v_lshl_add_u32 v6, v5, 4, v2
    v_or_b32 v5, 4, v4
    v_xor_b32 v5, v5, v3
    v_lshl_add_u32 v7, v5, 4, v2
    v_add_u32 v7, 8192, v7
    v_add_u32 v8, 16384, v6
    v_add_u32 v9, 16384, v7
    s_lshl_b32 s24, s3, 4
    s_lshl_b32 s23, s21, 6
    v_add_u32 v2, 0, v1
    v_mul_u32_u24 v3, 171, v2
    v_lshrrev_b32 v3, 11, v3
    v_mul_u32_u24 v4, 12, v3
    v_sub_u32 v4, v2, v4
    v_add_u32 v3, s24, v3
    v_mul_u32_u24 v10, 3072, v3
    v_lshrrev_b32 v5, 2, v4
    v_lshl_add_u32 v10, v5, 10, v10
    v_and_b32 v5, 3, v4
    v_lshl_add_u32 v10, v5, 4, v10
    v_add_u32 v10, s23, v10
    v_add_u32 v2, 64, v1
    v_mul_u32_u24 v3, 171, v2
    v_lshrrev_b32 v3, 11, v3
    v_mul_u32_u24 v4, 12, v3
    v_sub_u32 v4, v2, v4
    v_add_u32 v3, s24, v3
    v_mul_u32_u24 v11, 3072, v3
    v_lshrrev_b32 v5, 2, v4
    v_lshl_add_u32 v11, v5, 10, v11
    v_and_b32 v5, 3, v4
    v_lshl_add_u32 v11, v5, 4, v11
    v_add_u32 v11, s23, v11
    v_add_u32 v2, 128, v1
    v_mul_u32_u24 v3, 171, v2
    v_lshrrev_b32 v3, 11, v3
    v_mul_u32_u24 v4, 12, v3
    v_sub_u32 v4, v2, v4
    v_add_u32 v3, s24, v3
    v_mul_u32_u24 v12, 3072, v3
    v_lshrrev_b32 v5, 2, v4
    v_lshl_add_u32 v12, v5, 10, v12
    v_and_b32 v5, 3, v4
    v_lshl_add_u32 v12, v5, 4, v12
    v_add_u32 v12, s23, v12
    s_mul_i32 s27, s3, 3072
    s_waitcnt lgkmcnt(0)
    s_mov_b32 s4, s32
    s_mov_b32 s5, s33
    s_and_b32 s5, s5, 0xffff
    s_mov_b32 s6, 0x200000
    s_mov_b32 s7, 0x00020000
    s_mov_b32 s8, s30
    s_mov_b32 s9, s31
    s_and_b32 s9, s9, 0xffff
    s_mov_b32 s10, 0x180000
    s_mov_b32 s11, 0x00020000
    s_mov_b32 s24, 0
    s_add_u32 m0, s26, 0
    s_nop 0
    buffer_load_dwordx4 v6, s[4:7], s24 offen lds
    s_add_u32 m0, s26, 1024
    s_nop 0
    buffer_load_dwordx4 v7, s[4:7], s24 offen lds
    s_add_u32 m0, s26, 2048
    s_nop 0
    buffer_load_dwordx4 v8, s[4:7], s24 offen lds
    s_add_u32 m0, s26, 3072
    s_nop 0
    buffer_load_dwordx4 v9, s[4:7], s24 offen lds
    s_mov_b32 s25, 0
    s_add_u32 m0, s27, 16384
    s_nop 0
    buffer_load_dwordx4 v10, s[8:11], s25 offen lds
    s_add_u32 m0, s27, 17408
    s_nop 0
    buffer_load_dwordx4 v11, s[8:11], s25 offen lds
    s_add_u32 m0, s27, 18432
    s_nop 0
    buffer_load_dwordx4 v12, s[8:11], s25 offen lds
    s_mov_b32 s24, 128
    s_add_u32 m0, s26, 28672
    s_nop 0
    buffer_load_dwordx4 v6, s[4:7], s24 offen lds
    s_add_u32 m0, s26, 29696
    s_nop 0
    buffer_load_dwordx4 v7, s[4:7], s24 offen lds
    s_add_u32 m0, s26, 30720
    s_nop 0
    buffer_load_dwordx4 v8, s[4:7], s24 offen lds
    s_add_u32 m0, s26, 31744
    s_nop 0
    buffer_load_dwordx4 v9, s[4:7], s24 offen lds
    s_mov_b32 s25, 196608
    s_add_u32 m0, s27, 45056
    s_nop 0
    buffer_load_dwordx4 v10, s[8:11], s25 offen lds
    s_add_u32 m0, s27, 46080
    s_nop 0
    buffer_load_dwordx4 v11, s[8:11], s25 offen lds
    s_add_u32 m0, s27, 47104
    s_nop 0
    buffer_load_dwordx4 v12, s[8:11], s25 offen lds
    s_mov_b32 s24, 256
    s_add_u32 m0, s26, 57344
    s_nop 0
    buffer_load_dwordx4 v6, s[4:7], s24 offen lds
    s_add_u32 m0, s26, 58368
    s_nop 0
    buffer_load_dwordx4 v7, s[4:7], s24 offen lds
    s_add_u32 m0, s26, 59392
    s_nop 0
    buffer_load_dwordx4 v8, s[4:7], s24 offen lds
    s_add_u32 m0, s26, 60416
    s_nop 0
    buffer_load_dwordx4 v9, s[4:7], s24 offen lds
    s_mov_b32 s25, 393216
    s_add_u32 m0, s27, 73728
    s_nop 0
    buffer_load_dwordx4 v10, s[8:11], s25 offen lds
    s_add_u32 m0, s27, 74752
    s_nop 0
    buffer_load_dwordx4 v11, s[8:11], s25 offen lds
    s_add_u32 m0, s27, 75776
    s_nop 0
    buffer_load_dwordx4 v12, s[8:11], s25 offen lds
    s_waitcnt vmcnt(14)
    s_barrier
    s_mov_b32 s24, 384
    s_add_u32 m0, s26, 86016
    s_nop 0
    buffer_load_dwordx4 v6, s[4:7], s24 offen lds
    s_add_u32 m0, s26, 87040
    s_nop 0
    buffer_load_dwordx4 v7, s[4:7], s24 offen lds
    s_add_u32 m0, s26, 88064
    s_nop 0
    buffer_load_dwordx4 v8, s[4:7], s24 offen lds
    s_add_u32 m0, s26, 89088
    s_nop 0
    buffer_load_dwordx4 v9, s[4:7], s24 offen lds
    s_mov_b32 s25, 589824
    s_add_u32 m0, s27, 102400
    s_nop 0
    buffer_load_dwordx4 v10, s[8:11], s25 offen lds
    s_add_u32 m0, s27, 103424
    s_nop 0
    buffer_load_dwordx4 v11, s[8:11], s25 offen lds
    s_add_u32 m0, s27, 104448
    s_nop 0
    buffer_load_dwordx4 v12, s[8:11], s25 offen lds
    s_waitcnt vmcnt(14)
    s_barrier
    s_mov_b32 s24, 512
    s_add_u32 m0, s26, 0
    s_nop 0
    buffer_load_dwordx4 v6, s[4:7], s24 offen lds
    s_add_u32 m0, s26, 1024
    s_nop 0
    buffer_load_dwordx4 v7, s[4:7], s24 offen lds
    s_add_u32 m0, s26, 2048
    s_nop 0
    buffer_load_dwordx4 v8, s[4:7], s24 offen lds
    s_add_u32 m0, s26, 3072
    s_nop 0
    buffer_load_dwordx4 v9, s[4:7], s24 offen lds
    s_mov_b32 s25, 786432
    s_add_u32 m0, s27, 16384
    s_nop 0
    buffer_load_dwordx4 v10, s[8:11], s25 offen lds
    s_add_u32 m0, s27, 17408
    s_nop 0
    buffer_load_dwordx4 v11, s[8:11], s25 offen lds
    s_add_u32 m0, s27, 18432
    s_nop 0
    buffer_load_dwordx4 v12, s[8:11], s25 offen lds
    s_waitcnt vmcnt(14)
    s_barrier
    s_mov_b32 s24, 640
    s_add_u32 m0, s26, 28672
    s_nop 0
    buffer_load_dwordx4 v6, s[4:7], s24 offen lds
    s_add_u32 m0, s26, 29696
    s_nop 0
    buffer_load_dwordx4 v7, s[4:7], s24 offen lds
    s_add_u32 m0, s26, 30720
    s_nop 0
    buffer_load_dwordx4 v8, s[4:7], s24 offen lds
    s_add_u32 m0, s26, 31744
    s_nop 0
    buffer_load_dwordx4 v9, s[4:7], s24 offen lds
    s_mov_b32 s25, 983040
    s_add_u32 m0, s27, 45056
    s_nop 0
    buffer_load_dwordx4 v10, s[8:11], s25 offen lds
    s_add_u32 m0, s27, 46080
    s_nop 0
    buffer_load_dwordx4 v11, s[8:11], s25 offen lds
    s_add_u32 m0, s27, 47104
    s_nop 0
    buffer_load_dwordx4 v12, s[8:11], s25 offen lds
    s_waitcnt vmcnt(14)
    s_barrier
    s_mov_b32 s24, 768
    s_add_u32 m0, s26, 57344
    s_nop 0
    buffer_load_dwordx4 v6, s[4:7], s24 offen lds
    s_add_u32 m0, s26, 58368
    s_nop 0
    buffer_load_dwordx4 v7, s[4:7], s24 offen lds
    s_add_u32 m0, s26, 59392
    s_nop 0
    buffer_load_dwordx4 v8, s[4:7], s24 offen lds
    s_add_u32 m0, s26, 60416
    s_nop 0
    buffer_load_dwordx4 v9, s[4:7], s24 offen lds
    s_mov_b32 s25, 1179648
    s_add_u32 m0, s27, 73728
    s_nop 0
    buffer_load_dwordx4 v10, s[8:11], s25 offen lds
    s_add_u32 m0, s27, 74752
    s_nop 0
    buffer_load_dwordx4 v11, s[8:11], s25 offen lds
    s_add_u32 m0, s27, 75776
    s_nop 0
    buffer_load_dwordx4 v12, s[8:11], s25 offen lds
    s_waitcnt vmcnt(14)
    s_barrier
    s_mov_b32 s24, 896
    s_add_u32 m0, s26, 86016
    s_nop 0
    buffer_load_dwordx4 v6, s[4:7], s24 offen lds
    s_add_u32 m0, s26, 87040
    s_nop 0
    buffer_load_dwordx4 v7, s[4:7], s24 offen lds
    s_add_u32 m0, s26, 88064
    s_nop 0
    buffer_load_dwordx4 v8, s[4:7], s24 offen lds
    s_add_u32 m0, s26, 89088
    s_nop 0
    buffer_load_dwordx4 v9, s[4:7], s24 offen lds
    s_mov_b32 s25, 1376256
    s_add_u32 m0, s27, 102400
    s_nop 0
    buffer_load_dwordx4 v10, s[8:11], s25 offen lds
    s_add_u32 m0, s27, 103424
    s_nop 0
    buffer_load_dwordx4 v11, s[8:11], s25 offen lds
    s_add_u32 m0, s27, 104448
    s_nop 0
    buffer_load_dwordx4 v12, s[8:11], s25 offen lds
    s_waitcnt vmcnt(14)
    s_barrier
    s_waitcnt vmcnt(7)
    s_barrier
    s_waitcnt vmcnt(0)
    s_barrier
    s_endpgm
qkv1_kernel_comp:
    v_and_b32 v2, 31, v1
    v_add_u32 v2, s22, v2
    v_lshlrev_b32 v2, 7, v2
    v_lshrrev_b32 v3, 5, v1
    v_lshl_add_u32 v168, v3, 6, v2
    v_and_b32 v2, 31, v1
    v_lshrrev_b32 v3, 5, v1
    v_bfe_u32 v4, v1, 1, 3
    v_or_b32 v5, 0, v3
    v_xor_b32 v5, v5, v4
    v_lshlrev_b32 v5, 4, v5
    v_lshl_add_u32 v14, v2, 7, v5
    v_add_u32 v14, s26, v14
    v_or_b32 v5, 2, v3
    v_xor_b32 v5, v5, v4
    v_lshlrev_b32 v5, 4, v5
    v_lshl_add_u32 v15, v2, 7, v5
    v_add_u32 v15, s26, v15
    v_or_b32 v5, 4, v3
    v_xor_b32 v5, v5, v4
    v_lshlrev_b32 v5, 4, v5
    v_lshl_add_u32 v16, v2, 7, v5
    v_add_u32 v16, s26, v16
    v_or_b32 v5, 6, v3
    v_xor_b32 v5, v5, v4
    v_lshlrev_b32 v5, 4, v5
    v_lshl_add_u32 v17, v2, 7, v5
    v_add_u32 v17, s26, v17
    v_bfe_u32 v2, v1, 2, 2
    v_lshrrev_b32 v3, 5, v1
    v_lshl_add_u32 v3, v3, 3, v2
    v_mul_u32_u24 v3, 192, v3
    v_bfe_u32 v4, v1, 4, 1
    v_lshl_add_u32 v3, v4, 5, v3
    v_and_b32 v4, 3, v1
    v_lshl_add_u32 v3, v4, 3, v3
    v_add_u32 v3, 16384, v3
    v_add_u32 v22, 0, v3
    v_add_u32 v23, 64, v3
    v_add_u32 v24, 128, v3
    s_min_u32 s23, s3, 2
    s_lshl_b32 s23, s23, 6
    v_add_u32 v30, s23, v3
    v_add_u32 v18, 57344, v14
    v_add_u32 v19, 57344, v15
    v_add_u32 v20, 57344, v16
    v_add_u32 v21, 57344, v17
    v_add_u32 v26, 57344, v22
    v_add_u32 v27, 57344, v23
    v_add_u32 v28, 57344, v24
    v_add_u32 v31, 57344, v30
    v_mov_b32 v32, 0x3f803f80
    v_mov_b32 v33, 0
    v_mov_b32 v34, 0
    v_mov_b32 v35, 0
    v_mov_b32 v216, 0
    v_mov_b32 v217, 0
    v_mov_b32 v218, 0
    v_mov_b32 v219, 0
    v_mov_b32 v220, 0
    v_mov_b32 v221, 0
    s_mov_b32 s36, 2.0
    s_mov_b32 s37, 2.0
    s_mov_b32 s38, 0x3fb8aa3b
    s_mov_b32 s39, 0x3fb8aa3b
    s_waitcnt lgkmcnt(0)
    s_mov_b32 s12, s28
    s_mov_b32 s13, s29
    s_and_b32 s13, s13, 0xffff
    s_mov_b32 s14, 0x10000000
    s_mov_b32 s15, 0x00020000
    s_barrier
    ds_read_b128 v[60:63], v14 offset:0
    ds_read_b64_tr_b16 v[72:73], v22 offset:0
    ds_read_b64_tr_b16 v[74:75], v22 offset:768
    ds_read_b64_tr_b16 v[76:77], v23 offset:0
    ds_read_b64_tr_b16 v[78:79], v23 offset:768
    ds_read_b64_tr_b16 v[80:81], v24 offset:0
    ds_read_b64_tr_b16 v[82:83], v24 offset:768
    ds_read_b64_tr_b16 v[108:109], v30 offset:0
    ds_read_b64_tr_b16 v[110:111], v30 offset:768
    ds_read_b128 v[64:67], v15 offset:0
    ds_read_b64_tr_b16 v[84:85], v22 offset:3072
    ds_read_b64_tr_b16 v[86:87], v22 offset:3840
    ds_read_b64_tr_b16 v[88:89], v23 offset:3072
    ds_read_b64_tr_b16 v[90:91], v23 offset:3840
    ds_read_b64_tr_b16 v[92:93], v24 offset:3072
    ds_read_b64_tr_b16 v[94:95], v24 offset:3840
    ds_read_b64_tr_b16 v[112:113], v30 offset:3072
    ds_read_b64_tr_b16 v[114:115], v30 offset:3840
    s_waitcnt lgkmcnt(9)
    v_mfma_f32_32x32x16_bf16 v[120:135], v[72:75], v[60:63], 0
    ds_read_b128 v[68:71], v16 offset:0
    ds_read_b64_tr_b16 v[96:97], v22 offset:6144
    ds_read_b64_tr_b16 v[98:99], v22 offset:6912
    ds_read_b64_tr_b16 v[100:101], v23 offset:6144
    ds_read_b64_tr_b16 v[102:103], v23 offset:6912
    v_mfma_f32_32x32x16_bf16 v[136:151], v[76:79], v[60:63], 0
    ds_read_b64_tr_b16 v[104:105], v24 offset:6144
    ds_read_b64_tr_b16 v[106:107], v24 offset:6912
    ds_read_b64_tr_b16 v[116:117], v30 offset:6144
    ds_read_b64_tr_b16 v[118:119], v30 offset:6912
    v_dot2c_f32_bf16 v216, v108, v32
    v_dot2c_f32_bf16 v216, v109, v32
    v_dot2c_f32_bf16 v216, v110, v32
    v_dot2c_f32_bf16 v216, v111, v32
    v_mfma_f32_32x32x16_bf16 v[152:167], v[60:63], v[80:83], 0
    v_dot2c_f32_bf16 v218, v60, v32
    v_dot2c_f32_bf16 v218, v61, v32
    v_dot2c_f32_bf16 v218, v62, v32
    v_dot2c_f32_bf16 v218, v63, v32
    v_dot2c_f32_bf16 v220, v60, v60
    v_dot2c_f32_bf16 v220, v61, v61
    v_dot2c_f32_bf16 v220, v62, v62
    v_dot2c_f32_bf16 v220, v63, v63
    s_waitcnt lgkmcnt(9)
    v_mfma_f32_32x32x16_bf16 v[120:135], v[84:87], v[64:67], v[120:135]
    ds_read_b128 v[60:63], v17 offset:0
    ds_read_b64_tr_b16 v[72:73], v22 offset:9216
    ds_read_b64_tr_b16 v[74:75], v22 offset:9984
    ds_read_b64_tr_b16 v[76:77], v23 offset:9216
    ds_read_b64_tr_b16 v[78:79], v23 offset:9984
    v_mfma_f32_32x32x16_bf16 v[136:151], v[88:91], v[64:67], v[136:151]
    ds_read_b64_tr_b16 v[80:81], v24 offset:9216
    ds_read_b64_tr_b16 v[82:83], v24 offset:9984
    ds_read_b64_tr_b16 v[108:109], v30 offset:9216
    ds_read_b64_tr_b16 v[110:111], v30 offset:9984
    v_dot2c_f32_bf16 v216, v112, v32
    v_dot2c_f32_bf16 v216, v113, v32
    v_dot2c_f32_bf16 v216, v114, v32
    v_dot2c_f32_bf16 v216, v115, v32
    v_mfma_f32_32x32x16_bf16 v[152:167], v[64:67], v[92:95], v[152:167]
    v_dot2c_f32_bf16 v218, v64, v32
    v_dot2c_f32_bf16 v218, v65, v32
    v_dot2c_f32_bf16 v218, v66, v32
    v_dot2c_f32_bf16 v218, v67, v32
    v_dot2c_f32_bf16 v220, v64, v64
    v_dot2c_f32_bf16 v220, v65, v65
    v_dot2c_f32_bf16 v220, v66, v66
    v_dot2c_f32_bf16 v220, v67, v67
    s_waitcnt lgkmcnt(0)
    s_barrier
    v_mfma_f32_32x32x16_bf16 v[120:135], v[96:99], v[68:71], v[120:135]
    ds_read_b128 v[64:67], v14 offset:28672
    ds_read_b64_tr_b16 v[84:85], v22 offset:28672
    ds_read_b64_tr_b16 v[86:87], v22 offset:29440
    ds_read_b64_tr_b16 v[88:89], v23 offset:28672
    ds_read_b64_tr_b16 v[90:91], v23 offset:29440
    v_mfma_f32_32x32x16_bf16 v[136:151], v[100:103], v[68:71], v[136:151]
    ds_read_b64_tr_b16 v[92:93], v24 offset:28672
    ds_read_b64_tr_b16 v[94:95], v24 offset:29440
    ds_read_b64_tr_b16 v[112:113], v30 offset:28672
    ds_read_b64_tr_b16 v[114:115], v30 offset:29440
    v_dot2c_f32_bf16 v216, v116, v32
    v_dot2c_f32_bf16 v216, v117, v32
    v_dot2c_f32_bf16 v216, v118, v32
    v_dot2c_f32_bf16 v216, v119, v32
    v_mfma_f32_32x32x16_bf16 v[152:167], v[68:71], v[104:107], v[152:167]
    v_dot2c_f32_bf16 v218, v68, v32
    v_dot2c_f32_bf16 v218, v69, v32
    v_dot2c_f32_bf16 v218, v70, v32
    v_dot2c_f32_bf16 v218, v71, v32
    v_dot2c_f32_bf16 v220, v68, v68
    v_dot2c_f32_bf16 v220, v69, v69
    v_dot2c_f32_bf16 v220, v70, v70
    v_dot2c_f32_bf16 v220, v71, v71
    s_waitcnt lgkmcnt(9)
    v_mfma_f32_32x32x16_bf16 v[120:135], v[72:75], v[60:63], v[120:135]
    ds_read_b128 v[68:71], v15 offset:28672
    ds_read_b64_tr_b16 v[96:97], v22 offset:31744
    ds_read_b64_tr_b16 v[98:99], v22 offset:32512
    ds_read_b64_tr_b16 v[100:101], v23 offset:31744
    ds_read_b64_tr_b16 v[102:103], v23 offset:32512
    v_mfma_f32_32x32x16_bf16 v[136:151], v[76:79], v[60:63], v[136:151]
    ds_read_b64_tr_b16 v[104:105], v24 offset:31744
    ds_read_b64_tr_b16 v[106:107], v24 offset:32512
    ds_read_b64_tr_b16 v[116:117], v30 offset:31744
    ds_read_b64_tr_b16 v[118:119], v30 offset:32512
    v_dot2c_f32_bf16 v216, v108, v32
    v_dot2c_f32_bf16 v216, v109, v32
    v_dot2c_f32_bf16 v216, v110, v32
    v_dot2c_f32_bf16 v216, v111, v32
    v_mfma_f32_32x32x16_bf16 v[152:167], v[60:63], v[80:83], v[152:167]
    v_dot2c_f32_bf16 v218, v60, v32
    v_dot2c_f32_bf16 v218, v61, v32
    v_dot2c_f32_bf16 v218, v62, v32
    v_dot2c_f32_bf16 v218, v63, v32
    v_dot2c_f32_bf16 v220, v60, v60
    v_dot2c_f32_bf16 v220, v61, v61
    v_dot2c_f32_bf16 v220, v62, v62
    v_dot2c_f32_bf16 v220, v63, v63
    s_waitcnt lgkmcnt(9)
    v_mfma_f32_32x32x16_bf16 v[120:135], v[84:87], v[64:67], v[120:135]
    ds_read_b128 v[60:63], v16 offset:28672
    ds_read_b64_tr_b16 v[72:73], v22 offset:34816
    ds_read_b64_tr_b16 v[74:75], v22 offset:35584
    ds_read_b64_tr_b16 v[76:77], v23 offset:34816
    ds_read_b64_tr_b16 v[78:79], v23 offset:35584
    v_mfma_f32_32x32x16_bf16 v[136:151], v[88:91], v[64:67], v[136:151]
    ds_read_b64_tr_b16 v[80:81], v24 offset:34816
    ds_read_b64_tr_b16 v[82:83], v24 offset:35584
    ds_read_b64_tr_b16 v[108:109], v30 offset:34816
    ds_read_b64_tr_b16 v[110:111], v30 offset:35584
    v_dot2c_f32_bf16 v216, v112, v32
    v_dot2c_f32_bf16 v216, v113, v32
    v_dot2c_f32_bf16 v216, v114, v32
    v_dot2c_f32_bf16 v216, v115, v32
    v_mfma_f32_32x32x16_bf16 v[152:167], v[64:67], v[92:95], v[152:167]
    v_dot2c_f32_bf16 v218, v64, v32
    v_dot2c_f32_bf16 v218, v65, v32
    v_dot2c_f32_bf16 v218, v66, v32
    v_dot2c_f32_bf16 v218, v67, v32
    v_dot2c_f32_bf16 v220, v64, v64
    v_dot2c_f32_bf16 v220, v65, v65
    v_dot2c_f32_bf16 v220, v66, v66
    v_dot2c_f32_bf16 v220, v67, v67
    s_waitcnt lgkmcnt(9)
    v_mfma_f32_32x32x16_bf16 v[120:135], v[96:99], v[68:71], v[120:135]
    ds_read_b128 v[64:67], v17 offset:28672
    ds_read_b64_tr_b16 v[84:85], v22 offset:37888
    ds_read_b64_tr_b16 v[86:87], v22 offset:38656
    ds_read_b64_tr_b16 v[88:89], v23 offset:37888
    ds_read_b64_tr_b16 v[90:91], v23 offset:38656
    v_mfma_f32_32x32x16_bf16 v[136:151], v[100:103], v[68:71], v[136:151]
    ds_read_b64_tr_b16 v[92:93], v24 offset:37888
    ds_read_b64_tr_b16 v[94:95], v24 offset:38656
    ds_read_b64_tr_b16 v[112:113], v30 offset:37888
    ds_read_b64_tr_b16 v[114:115], v30 offset:38656
    v_dot2c_f32_bf16 v216, v116, v32
    v_dot2c_f32_bf16 v216, v117, v32
    v_dot2c_f32_bf16 v216, v118, v32
    v_dot2c_f32_bf16 v216, v119, v32
    v_mfma_f32_32x32x16_bf16 v[152:167], v[68:71], v[104:107], v[152:167]
    v_dot2c_f32_bf16 v218, v68, v32
    v_dot2c_f32_bf16 v218, v69, v32
    v_dot2c_f32_bf16 v218, v70, v32
    v_dot2c_f32_bf16 v218, v71, v32
    v_dot2c_f32_bf16 v220, v68, v68
    v_dot2c_f32_bf16 v220, v69, v69
    v_dot2c_f32_bf16 v220, v70, v70
    v_dot2c_f32_bf16 v220, v71, v71
    s_waitcnt lgkmcnt(0)
    s_barrier
    v_mfma_f32_32x32x16_bf16 v[120:135], v[72:75], v[60:63], v[120:135]
    ds_read_b128 v[68:71], v18 offset:0
    ds_read_b64_tr_b16 v[96:97], v26 offset:0
    ds_read_b64_tr_b16 v[98:99], v26 offset:768
    ds_read_b64_tr_b16 v[100:101], v27 offset:0
    ds_read_b64_tr_b16 v[102:103], v27 offset:768
    v_mfma_f32_32x32x16_bf16 v[136:151], v[76:79], v[60:63], v[136:151]
    ds_read_b64_tr_b16 v[104:105], v28 offset:0
    ds_read_b64_tr_b16 v[106:107], v28 offset:768
    ds_read_b64_tr_b16 v[116:117], v31 offset:0
    ds_read_b64_tr_b16 v[118:119], v31 offset:768
    v_dot2c_f32_bf16 v216, v108, v32
    v_dot2c_f32_bf16 v216, v109, v32
    v_dot2c_f32_bf16 v216, v110, v32
    v_dot2c_f32_bf16 v216, v111, v32
    v_mfma_f32_32x32x16_bf16 v[152:167], v[60:63], v[80:83], v[152:167]
    v_dot2c_f32_bf16 v218, v60, v32
    v_dot2c_f32_bf16 v218, v61, v32
    v_dot2c_f32_bf16 v218, v62, v32
    v_dot2c_f32_bf16 v218, v63, v32
    v_dot2c_f32_bf16 v220, v60, v60
    v_dot2c_f32_bf16 v220, v61, v61
    v_dot2c_f32_bf16 v220, v62, v62
    v_dot2c_f32_bf16 v220, v63, v63
    s_waitcnt lgkmcnt(9)
    v_mfma_f32_32x32x16_bf16 v[120:135], v[84:87], v[64:67], v[120:135]
    ds_read_b128 v[60:63], v19 offset:0
    ds_read_b64_tr_b16 v[72:73], v26 offset:3072
    ds_read_b64_tr_b16 v[74:75], v26 offset:3840
    ds_read_b64_tr_b16 v[76:77], v27 offset:3072
    ds_read_b64_tr_b16 v[78:79], v27 offset:3840
    v_mfma_f32_32x32x16_bf16 v[136:151], v[88:91], v[64:67], v[136:151]
    ds_read_b64_tr_b16 v[80:81], v28 offset:3072
    ds_read_b64_tr_b16 v[82:83], v28 offset:3840
    ds_read_b64_tr_b16 v[108:109], v31 offset:3072
    ds_read_b64_tr_b16 v[110:111], v31 offset:3840
    v_dot2c_f32_bf16 v216, v112, v32
    v_dot2c_f32_bf16 v216, v113, v32
    v_dot2c_f32_bf16 v216, v114, v32
    v_dot2c_f32_bf16 v216, v115, v32
    v_mfma_f32_32x32x16_bf16 v[152:167], v[64:67], v[92:95], v[152:167]
    v_dot2c_f32_bf16 v218, v64, v32
    v_dot2c_f32_bf16 v218, v65, v32
    v_dot2c_f32_bf16 v218, v66, v32
    v_dot2c_f32_bf16 v218, v67, v32
    v_dot2c_f32_bf16 v220, v64, v64
    v_dot2c_f32_bf16 v220, v65, v65
    v_dot2c_f32_bf16 v220, v66, v66
    v_dot2c_f32_bf16 v220, v67, v67
    s_waitcnt lgkmcnt(9)
    v_mfma_f32_32x32x16_bf16 v[120:135], v[96:99], v[68:71], v[120:135]
    ds_read_b128 v[64:67], v20 offset:0
    ds_read_b64_tr_b16 v[84:85], v26 offset:6144
    ds_read_b64_tr_b16 v[86:87], v26 offset:6912
    ds_read_b64_tr_b16 v[88:89], v27 offset:6144
    ds_read_b64_tr_b16 v[90:91], v27 offset:6912
    v_mfma_f32_32x32x16_bf16 v[136:151], v[100:103], v[68:71], v[136:151]
    ds_read_b64_tr_b16 v[92:93], v28 offset:6144
    ds_read_b64_tr_b16 v[94:95], v28 offset:6912
    ds_read_b64_tr_b16 v[112:113], v31 offset:6144
    ds_read_b64_tr_b16 v[114:115], v31 offset:6912
    v_dot2c_f32_bf16 v216, v116, v32
    v_dot2c_f32_bf16 v216, v117, v32
    v_dot2c_f32_bf16 v216, v118, v32
    v_dot2c_f32_bf16 v216, v119, v32
    v_mfma_f32_32x32x16_bf16 v[152:167], v[68:71], v[104:107], v[152:167]
    v_dot2c_f32_bf16 v218, v68, v32
    v_dot2c_f32_bf16 v218, v69, v32
    v_dot2c_f32_bf16 v218, v70, v32
    v_dot2c_f32_bf16 v218, v71, v32
    v_dot2c_f32_bf16 v220, v68, v68
    v_dot2c_f32_bf16 v220, v69, v69
    v_dot2c_f32_bf16 v220, v70, v70
    v_dot2c_f32_bf16 v220, v71, v71
    s_waitcnt lgkmcnt(9)
    v_mfma_f32_32x32x16_bf16 v[120:135], v[72:75], v[60:63], v[120:135]
    ds_read_b128 v[68:71], v21 offset:0
    ds_read_b64_tr_b16 v[96:97], v26 offset:9216
    ds_read_b64_tr_b16 v[98:99], v26 offset:9984
    ds_read_b64_tr_b16 v[100:101], v27 offset:9216
    ds_read_b64_tr_b16 v[102:103], v27 offset:9984
    v_mfma_f32_32x32x16_bf16 v[136:151], v[76:79], v[60:63], v[136:151]
    ds_read_b64_tr_b16 v[104:105], v28 offset:9216
    ds_read_b64_tr_b16 v[106:107], v28 offset:9984
    ds_read_b64_tr_b16 v[116:117], v31 offset:9216
    ds_read_b64_tr_b16 v[118:119], v31 offset:9984
    v_dot2c_f32_bf16 v216, v108, v32
    v_dot2c_f32_bf16 v216, v109, v32
    v_dot2c_f32_bf16 v216, v110, v32
    v_dot2c_f32_bf16 v216, v111, v32
    v_mfma_f32_32x32x16_bf16 v[152:167], v[60:63], v[80:83], v[152:167]
    v_dot2c_f32_bf16 v218, v60, v32
    v_dot2c_f32_bf16 v218, v61, v32
    v_dot2c_f32_bf16 v218, v62, v32
    v_dot2c_f32_bf16 v218, v63, v32
    v_dot2c_f32_bf16 v220, v60, v60
    v_dot2c_f32_bf16 v220, v61, v61
    v_dot2c_f32_bf16 v220, v62, v62
    v_dot2c_f32_bf16 v220, v63, v63
    s_waitcnt lgkmcnt(0)
    s_barrier
    v_mfma_f32_32x32x16_bf16 v[120:135], v[84:87], v[64:67], v[120:135]
    ds_read_b128 v[60:63], v18 offset:28672
    ds_read_b64_tr_b16 v[72:73], v26 offset:28672
    ds_read_b64_tr_b16 v[74:75], v26 offset:29440
    ds_read_b64_tr_b16 v[76:77], v27 offset:28672
    ds_read_b64_tr_b16 v[78:79], v27 offset:29440
    v_mfma_f32_32x32x16_bf16 v[136:151], v[88:91], v[64:67], v[136:151]
    ds_read_b64_tr_b16 v[80:81], v28 offset:28672
    ds_read_b64_tr_b16 v[82:83], v28 offset:29440
    ds_read_b64_tr_b16 v[108:109], v31 offset:28672
    ds_read_b64_tr_b16 v[110:111], v31 offset:29440
    v_dot2c_f32_bf16 v216, v112, v32
    v_dot2c_f32_bf16 v216, v113, v32
    v_dot2c_f32_bf16 v216, v114, v32
    v_dot2c_f32_bf16 v216, v115, v32
    v_mfma_f32_32x32x16_bf16 v[152:167], v[64:67], v[92:95], v[152:167]
    v_dot2c_f32_bf16 v218, v64, v32
    v_dot2c_f32_bf16 v218, v65, v32
    v_dot2c_f32_bf16 v218, v66, v32
    v_dot2c_f32_bf16 v218, v67, v32
    v_dot2c_f32_bf16 v220, v64, v64
    v_dot2c_f32_bf16 v220, v65, v65
    v_dot2c_f32_bf16 v220, v66, v66
    v_dot2c_f32_bf16 v220, v67, v67
    s_waitcnt lgkmcnt(9)
    v_mfma_f32_32x32x16_bf16 v[120:135], v[96:99], v[68:71], v[120:135]
    ds_read_b128 v[64:67], v19 offset:28672
    ds_read_b64_tr_b16 v[84:85], v26 offset:31744
    ds_read_b64_tr_b16 v[86:87], v26 offset:32512
    ds_read_b64_tr_b16 v[88:89], v27 offset:31744
    ds_read_b64_tr_b16 v[90:91], v27 offset:32512
    v_mfma_f32_32x32x16_bf16 v[136:151], v[100:103], v[68:71], v[136:151]
    ds_read_b64_tr_b16 v[92:93], v28 offset:31744
    ds_read_b64_tr_b16 v[94:95], v28 offset:32512
    ds_read_b64_tr_b16 v[112:113], v31 offset:31744
    ds_read_b64_tr_b16 v[114:115], v31 offset:32512
    v_dot2c_f32_bf16 v216, v116, v32
    v_dot2c_f32_bf16 v216, v117, v32
    v_dot2c_f32_bf16 v216, v118, v32
    v_dot2c_f32_bf16 v216, v119, v32
    v_mfma_f32_32x32x16_bf16 v[152:167], v[68:71], v[104:107], v[152:167]
    v_dot2c_f32_bf16 v218, v68, v32
    v_dot2c_f32_bf16 v218, v69, v32
    v_dot2c_f32_bf16 v218, v70, v32
    v_dot2c_f32_bf16 v218, v71, v32
    v_dot2c_f32_bf16 v220, v68, v68
    v_dot2c_f32_bf16 v220, v69, v69
    v_dot2c_f32_bf16 v220, v70, v70
    v_dot2c_f32_bf16 v220, v71, v71
    s_waitcnt lgkmcnt(9)
    v_mfma_f32_32x32x16_bf16 v[120:135], v[72:75], v[60:63], v[120:135]
    ds_read_b128 v[68:71], v20 offset:28672
    ds_read_b64_tr_b16 v[96:97], v26 offset:34816
    ds_read_b64_tr_b16 v[98:99], v26 offset:35584
    ds_read_b64_tr_b16 v[100:101], v27 offset:34816
    ds_read_b64_tr_b16 v[102:103], v27 offset:35584
    v_mfma_f32_32x32x16_bf16 v[136:151], v[76:79], v[60:63], v[136:151]
    ds_read_b64_tr_b16 v[104:105], v28 offset:34816
    ds_read_b64_tr_b16 v[106:107], v28 offset:35584
    ds_read_b64_tr_b16 v[116:117], v31 offset:34816
    ds_read_b64_tr_b16 v[118:119], v31 offset:35584
    v_dot2c_f32_bf16 v216, v108, v32
    v_dot2c_f32_bf16 v216, v109, v32
    v_dot2c_f32_bf16 v216, v110, v32
    v_dot2c_f32_bf16 v216, v111, v32
    v_mfma_f32_32x32x16_bf16 v[152:167], v[60:63], v[80:83], v[152:167]
    v_dot2c_f32_bf16 v218, v60, v32
    v_dot2c_f32_bf16 v218, v61, v32
    v_dot2c_f32_bf16 v218, v62, v32
    v_dot2c_f32_bf16 v218, v63, v32
    v_dot2c_f32_bf16 v220, v60, v60
    v_dot2c_f32_bf16 v220, v61, v61
    v_dot2c_f32_bf16 v220, v62, v62
    v_dot2c_f32_bf16 v220, v63, v63
    s_waitcnt lgkmcnt(9)
    v_mfma_f32_32x32x16_bf16 v[120:135], v[84:87], v[64:67], v[120:135]
    ds_read_b128 v[60:63], v21 offset:28672
    ds_read_b64_tr_b16 v[72:73], v26 offset:37888
    ds_read_b64_tr_b16 v[74:75], v26 offset:38656
    ds_read_b64_tr_b16 v[76:77], v27 offset:37888
    ds_read_b64_tr_b16 v[78:79], v27 offset:38656
    v_mfma_f32_32x32x16_bf16 v[136:151], v[88:91], v[64:67], v[136:151]
    ds_read_b64_tr_b16 v[80:81], v28 offset:37888
    ds_read_b64_tr_b16 v[82:83], v28 offset:38656
    ds_read_b64_tr_b16 v[108:109], v31 offset:37888
    ds_read_b64_tr_b16 v[110:111], v31 offset:38656
    v_dot2c_f32_bf16 v216, v112, v32
    v_dot2c_f32_bf16 v216, v113, v32
    v_dot2c_f32_bf16 v216, v114, v32
    v_dot2c_f32_bf16 v216, v115, v32
    v_mfma_f32_32x32x16_bf16 v[152:167], v[64:67], v[92:95], v[152:167]
    v_dot2c_f32_bf16 v218, v64, v32
    v_dot2c_f32_bf16 v218, v65, v32
    v_dot2c_f32_bf16 v218, v66, v32
    v_dot2c_f32_bf16 v218, v67, v32
    v_dot2c_f32_bf16 v220, v64, v64
    v_dot2c_f32_bf16 v220, v65, v65
    v_dot2c_f32_bf16 v220, v66, v66
    v_dot2c_f32_bf16 v220, v67, v67
    s_waitcnt lgkmcnt(0)
    s_barrier
    v_mfma_f32_32x32x16_bf16 v[120:135], v[96:99], v[68:71], v[120:135]
    ds_read_b128 v[64:67], v14 offset:0
    ds_read_b64_tr_b16 v[84:85], v22 offset:0
    ds_read_b64_tr_b16 v[86:87], v22 offset:768
    ds_read_b64_tr_b16 v[88:89], v23 offset:0
    ds_read_b64_tr_b16 v[90:91], v23 offset:768
    v_mfma_f32_32x32x16_bf16 v[136:151], v[100:103], v[68:71], v[136:151]
    ds_read_b64_tr_b16 v[92:93], v24 offset:0
    ds_read_b64_tr_b16 v[94:95], v24 offset:768
    ds_read_b64_tr_b16 v[112:113], v30 offset:0
    ds_read_b64_tr_b16 v[114:115], v30 offset:768
    v_dot2c_f32_bf16 v216, v116, v32
    v_dot2c_f32_bf16 v216, v117, v32
    v_dot2c_f32_bf16 v216, v118, v32
    v_dot2c_f32_bf16 v216, v119, v32
    v_mfma_f32_32x32x16_bf16 v[152:167], v[68:71], v[104:107], v[152:167]
    v_dot2c_f32_bf16 v218, v68, v32
    v_dot2c_f32_bf16 v218, v69, v32
    v_dot2c_f32_bf16 v218, v70, v32
    v_dot2c_f32_bf16 v218, v71, v32
    v_dot2c_f32_bf16 v220, v68, v68
    v_dot2c_f32_bf16 v220, v69, v69
    v_dot2c_f32_bf16 v220, v70, v70
    v_dot2c_f32_bf16 v220, v71, v71
    s_waitcnt lgkmcnt(9)
    v_mfma_f32_32x32x16_bf16 v[120:135], v[72:75], v[60:63], v[120:135]
    ds_read_b128 v[68:71], v15 offset:0
    ds_read_b64_tr_b16 v[96:97], v22 offset:3072
    ds_read_b64_tr_b16 v[98:99], v22 offset:3840
    ds_read_b64_tr_b16 v[100:101], v23 offset:3072
    ds_read_b64_tr_b16 v[102:103], v23 offset:3840
    v_mfma_f32_32x32x16_bf16 v[136:151], v[76:79], v[60:63], v[136:151]
    ds_read_b64_tr_b16 v[104:105], v24 offset:3072
    ds_read_b64_tr_b16 v[106:107], v24 offset:3840
    ds_read_b64_tr_b16 v[116:117], v30 offset:3072
    ds_read_b64_tr_b16 v[118:119], v30 offset:3840
    v_dot2c_f32_bf16 v216, v108, v32
    v_dot2c_f32_bf16 v216, v109, v32
    v_dot2c_f32_bf16 v216, v110, v32
    v_dot2c_f32_bf16 v216, v111, v32
    v_mfma_f32_32x32x16_bf16 v[152:167], v[60:63], v[80:83], v[152:167]
    v_dot2c_f32_bf16 v218, v60, v32
    v_dot2c_f32_bf16 v218, v61, v32
    v_dot2c_f32_bf16 v218, v62, v32
    v_dot2c_f32_bf16 v218, v63, v32
    v_dot2c_f32_bf16 v220, v60, v60
    v_dot2c_f32_bf16 v220, v61, v61
    v_dot2c_f32_bf16 v220, v62, v62
    v_dot2c_f32_bf16 v220, v63, v63
    s_waitcnt lgkmcnt(9)
    v_mfma_f32_32x32x16_bf16 v[120:135], v[84:87], v[64:67], v[120:135]
    ds_read_b128 v[60:63], v16 offset:0
    ds_read_b64_tr_b16 v[72:73], v22 offset:6144
    ds_read_b64_tr_b16 v[74:75], v22 offset:6912
    ds_read_b64_tr_b16 v[76:77], v23 offset:6144
    ds_read_b64_tr_b16 v[78:79], v23 offset:6912
    v_mfma_f32_32x32x16_bf16 v[136:151], v[88:91], v[64:67], v[136:151]
    ds_read_b64_tr_b16 v[80:81], v24 offset:6144
    ds_read_b64_tr_b16 v[82:83], v24 offset:6912
    ds_read_b64_tr_b16 v[108:109], v30 offset:6144
    ds_read_b64_tr_b16 v[110:111], v30 offset:6912
    v_dot2c_f32_bf16 v216, v112, v32
    v_dot2c_f32_bf16 v216, v113, v32
    v_dot2c_f32_bf16 v216, v114, v32
    v_dot2c_f32_bf16 v216, v115, v32
    v_mfma_f32_32x32x16_bf16 v[152:167], v[64:67], v[92:95], v[152:167]
    v_dot2c_f32_bf16 v218, v64, v32
    v_dot2c_f32_bf16 v218, v65, v32
    v_dot2c_f32_bf16 v218, v66, v32
    v_dot2c_f32_bf16 v218, v67, v32
    v_dot2c_f32_bf16 v220, v64, v64
    v_dot2c_f32_bf16 v220, v65, v65
    v_dot2c_f32_bf16 v220, v66, v66
    v_dot2c_f32_bf16 v220, v67, v67
    s_waitcnt lgkmcnt(9)
    v_mfma_f32_32x32x16_bf16 v[120:135], v[96:99], v[68:71], v[120:135]
    ds_read_b128 v[64:67], v17 offset:0
    ds_read_b64_tr_b16 v[84:85], v22 offset:9216
    ds_read_b64_tr_b16 v[86:87], v22 offset:9984
    ds_read_b64_tr_b16 v[88:89], v23 offset:9216
    ds_read_b64_tr_b16 v[90:91], v23 offset:9984
    v_mfma_f32_32x32x16_bf16 v[136:151], v[100:103], v[68:71], v[136:151]
    ds_read_b64_tr_b16 v[92:93], v24 offset:9216
    ds_read_b64_tr_b16 v[94:95], v24 offset:9984
    ds_read_b64_tr_b16 v[112:113], v30 offset:9216
    ds_read_b64_tr_b16 v[114:115], v30 offset:9984
    v_dot2c_f32_bf16 v216, v116, v32
    v_dot2c_f32_bf16 v216, v117, v32
    v_dot2c_f32_bf16 v216, v118, v32
    v_dot2c_f32_bf16 v216, v119, v32
    v_mfma_f32_32x32x16_bf16 v[152:167], v[68:71], v[104:107], v[152:167]
    v_dot2c_f32_bf16 v218, v68, v32
    v_dot2c_f32_bf16 v218, v69, v32
    v_dot2c_f32_bf16 v218, v70, v32
    v_dot2c_f32_bf16 v218, v71, v32
    v_dot2c_f32_bf16 v220, v68, v68
    v_dot2c_f32_bf16 v220, v69, v69
    v_dot2c_f32_bf16 v220, v70, v70
    v_dot2c_f32_bf16 v220, v71, v71
    s_waitcnt lgkmcnt(0)
    s_barrier
    v_mfma_f32_32x32x16_bf16 v[120:135], v[72:75], v[60:63], v[120:135]
    ds_read_b128 v[68:71], v14 offset:28672
    ds_read_b64_tr_b16 v[96:97], v22 offset:28672
    ds_read_b64_tr_b16 v[98:99], v22 offset:29440
    ds_read_b64_tr_b16 v[100:101], v23 offset:28672
    ds_read_b64_tr_b16 v[102:103], v23 offset:29440
    v_mfma_f32_32x32x16_bf16 v[136:151], v[76:79], v[60:63], v[136:151]
    ds_read_b64_tr_b16 v[104:105], v24 offset:28672
    ds_read_b64_tr_b16 v[106:107], v24 offset:29440
    ds_read_b64_tr_b16 v[116:117], v30 offset:28672
    ds_read_b64_tr_b16 v[118:119], v30 offset:29440
    v_dot2c_f32_bf16 v216, v108, v32
    v_dot2c_f32_bf16 v216, v109, v32
    v_dot2c_f32_bf16 v216, v110, v32
    v_dot2c_f32_bf16 v216, v111, v32
    v_mfma_f32_32x32x16_bf16 v[152:167], v[60:63], v[80:83], v[152:167]
    v_dot2c_f32_bf16 v218, v60, v32
    v_dot2c_f32_bf16 v218, v61, v32
    v_dot2c_f32_bf16 v218, v62, v32
    v_dot2c_f32_bf16 v218, v63, v32
    v_dot2c_f32_bf16 v220, v60, v60
    v_dot2c_f32_bf16 v220, v61, v61
    v_dot2c_f32_bf16 v220, v62, v62
    v_dot2c_f32_bf16 v220, v63, v63
    s_waitcnt lgkmcnt(9)
    v_mfma_f32_32x32x16_bf16 v[120:135], v[84:87], v[64:67], v[120:135]
    ds_read_b128 v[60:63], v15 offset:28672
    ds_read_b64_tr_b16 v[72:73], v22 offset:31744
    ds_read_b64_tr_b16 v[74:75], v22 offset:32512
    ds_read_b64_tr_b16 v[76:77], v23 offset:31744
    ds_read_b64_tr_b16 v[78:79], v23 offset:32512
    v_mfma_f32_32x32x16_bf16 v[136:151], v[88:91], v[64:67], v[136:151]
    ds_read_b64_tr_b16 v[80:81], v24 offset:31744
    ds_read_b64_tr_b16 v[82:83], v24 offset:32512
    ds_read_b64_tr_b16 v[108:109], v30 offset:31744
    ds_read_b64_tr_b16 v[110:111], v30 offset:32512
    v_dot2c_f32_bf16 v216, v112, v32
    v_dot2c_f32_bf16 v216, v113, v32
    v_dot2c_f32_bf16 v216, v114, v32
    v_dot2c_f32_bf16 v216, v115, v32
    v_mfma_f32_32x32x16_bf16 v[152:167], v[64:67], v[92:95], v[152:167]
    v_dot2c_f32_bf16 v218, v64, v32
    v_dot2c_f32_bf16 v218, v65, v32
    v_dot2c_f32_bf16 v218, v66, v32
    v_dot2c_f32_bf16 v218, v67, v32
    v_dot2c_f32_bf16 v220, v64, v64
    v_dot2c_f32_bf16 v220, v65, v65
    v_dot2c_f32_bf16 v220, v66, v66
    v_dot2c_f32_bf16 v220, v67, v67
    s_waitcnt lgkmcnt(9)
    v_mfma_f32_32x32x16_bf16 v[120:135], v[96:99], v[68:71], v[120:135]
    ds_read_b128 v[64:67], v16 offset:28672
    ds_read_b64_tr_b16 v[84:85], v22 offset:34816
    ds_read_b64_tr_b16 v[86:87], v22 offset:35584
    ds_read_b64_tr_b16 v[88:89], v23 offset:34816
    ds_read_b64_tr_b16 v[90:91], v23 offset:35584
    v_mfma_f32_32x32x16_bf16 v[136:151], v[100:103], v[68:71], v[136:151]
    ds_read_b64_tr_b16 v[92:93], v24 offset:34816
    ds_read_b64_tr_b16 v[94:95], v24 offset:35584
    ds_read_b64_tr_b16 v[112:113], v30 offset:34816
    ds_read_b64_tr_b16 v[114:115], v30 offset:35584
    v_dot2c_f32_bf16 v216, v116, v32
    v_dot2c_f32_bf16 v216, v117, v32
    v_dot2c_f32_bf16 v216, v118, v32
    v_dot2c_f32_bf16 v216, v119, v32
    v_mfma_f32_32x32x16_bf16 v[152:167], v[68:71], v[104:107], v[152:167]
    v_dot2c_f32_bf16 v218, v68, v32
    v_dot2c_f32_bf16 v218, v69, v32
    v_dot2c_f32_bf16 v218, v70, v32
    v_dot2c_f32_bf16 v218, v71, v32
    v_dot2c_f32_bf16 v220, v68, v68
    v_dot2c_f32_bf16 v220, v69, v69
    v_dot2c_f32_bf16 v220, v70, v70
    v_dot2c_f32_bf16 v220, v71, v71
    s_waitcnt lgkmcnt(9)
    v_mfma_f32_32x32x16_bf16 v[120:135], v[72:75], v[60:63], v[120:135]
    ds_read_b128 v[68:71], v17 offset:28672
    ds_read_b64_tr_b16 v[96:97], v22 offset:37888
    ds_read_b64_tr_b16 v[98:99], v22 offset:38656
    ds_read_b64_tr_b16 v[100:101], v23 offset:37888
    ds_read_b64_tr_b16 v[102:103], v23 offset:38656
    v_mfma_f32_32x32x16_bf16 v[136:151], v[76:79], v[60:63], v[136:151]
    ds_read_b64_tr_b16 v[104:105], v24 offset:37888
    ds_read_b64_tr_b16 v[106:107], v24 offset:38656
    ds_read_b64_tr_b16 v[116:117], v30 offset:37888
    ds_read_b64_tr_b16 v[118:119], v30 offset:38656
    v_dot2c_f32_bf16 v216, v108, v32
    v_dot2c_f32_bf16 v216, v109, v32
    v_dot2c_f32_bf16 v216, v110, v32
    v_dot2c_f32_bf16 v216, v111, v32
    v_mfma_f32_32x32x16_bf16 v[152:167], v[60:63], v[80:83], v[152:167]
    v_dot2c_f32_bf16 v218, v60, v32
    v_dot2c_f32_bf16 v218, v61, v32
    v_dot2c_f32_bf16 v218, v62, v32
    v_dot2c_f32_bf16 v218, v63, v32
    v_dot2c_f32_bf16 v220, v60, v60
    v_dot2c_f32_bf16 v220, v61, v61
    v_dot2c_f32_bf16 v220, v62, v62
    v_dot2c_f32_bf16 v220, v63, v63
    s_waitcnt lgkmcnt(0)
    s_barrier
    v_mfma_f32_32x32x16_bf16 v[120:135], v[84:87], v[64:67], v[120:135]
    ds_read_b128 v[60:63], v18 offset:0
    ds_read_b64_tr_b16 v[72:73], v26 offset:0
    ds_read_b64_tr_b16 v[74:75], v26 offset:768
    ds_read_b64_tr_b16 v[76:77], v27 offset:0
    ds_read_b64_tr_b16 v[78:79], v27 offset:768
    v_mfma_f32_32x32x16_bf16 v[136:151], v[88:91], v[64:67], v[136:151]
    ds_read_b64_tr_b16 v[80:81], v28 offset:0
    ds_read_b64_tr_b16 v[82:83], v28 offset:768
    ds_read_b64_tr_b16 v[108:109], v31 offset:0
    ds_read_b64_tr_b16 v[110:111], v31 offset:768
    v_dot2c_f32_bf16 v216, v112, v32
    v_dot2c_f32_bf16 v216, v113, v32
    v_dot2c_f32_bf16 v216, v114, v32
    v_dot2c_f32_bf16 v216, v115, v32
    v_mfma_f32_32x32x16_bf16 v[152:167], v[64:67], v[92:95], v[152:167]
    v_dot2c_f32_bf16 v218, v64, v32
    v_dot2c_f32_bf16 v218, v65, v32
    v_dot2c_f32_bf16 v218, v66, v32
    v_dot2c_f32_bf16 v218, v67, v32
    v_dot2c_f32_bf16 v220, v64, v64
    v_dot2c_f32_bf16 v220, v65, v65
    v_dot2c_f32_bf16 v220, v66, v66
    v_dot2c_f32_bf16 v220, v67, v67
    s_waitcnt lgkmcnt(9)
    v_mfma_f32_32x32x16_bf16 v[120:135], v[96:99], v[68:71], v[120:135]
    ds_read_b128 v[64:67], v19 offset:0
    ds_read_b64_tr_b16 v[84:85], v26 offset:3072
    ds_read_b64_tr_b16 v[86:87], v26 offset:3840
    ds_read_b64_tr_b16 v[88:89], v27 offset:3072
    ds_read_b64_tr_b16 v[90:91], v27 offset:3840
    v_mfma_f32_32x32x16_bf16 v[136:151], v[100:103], v[68:71], v[136:151]
    ds_read_b64_tr_b16 v[92:93], v28 offset:3072
    ds_read_b64_tr_b16 v[94:95], v28 offset:3840
    ds_read_b64_tr_b16 v[112:113], v31 offset:3072
    ds_read_b64_tr_b16 v[114:115], v31 offset:3840
    v_dot2c_f32_bf16 v216, v116, v32
    v_dot2c_f32_bf16 v216, v117, v32
    v_dot2c_f32_bf16 v216, v118, v32
    v_dot2c_f32_bf16 v216, v119, v32
    v_mfma_f32_32x32x16_bf16 v[152:167], v[68:71], v[104:107], v[152:167]
    v_dot2c_f32_bf16 v218, v68, v32
    v_dot2c_f32_bf16 v218, v69, v32
    v_dot2c_f32_bf16 v218, v70, v32
    v_dot2c_f32_bf16 v218, v71, v32
    v_dot2c_f32_bf16 v220, v68, v68
    v_dot2c_f32_bf16 v220, v69, v69
    v_dot2c_f32_bf16 v220, v70, v70
    v_dot2c_f32_bf16 v220, v71, v71
    s_waitcnt lgkmcnt(9)
    v_mfma_f32_32x32x16_bf16 v[120:135], v[72:75], v[60:63], v[120:135]
    ds_read_b128 v[68:71], v20 offset:0
    ds_read_b64_tr_b16 v[96:97], v26 offset:6144
    ds_read_b64_tr_b16 v[98:99], v26 offset:6912
    ds_read_b64_tr_b16 v[100:101], v27 offset:6144
    ds_read_b64_tr_b16 v[102:103], v27 offset:6912
    v_mfma_f32_32x32x16_bf16 v[136:151], v[76:79], v[60:63], v[136:151]
    ds_read_b64_tr_b16 v[104:105], v28 offset:6144
    ds_read_b64_tr_b16 v[106:107], v28 offset:6912
    ds_read_b64_tr_b16 v[116:117], v31 offset:6144
    ds_read_b64_tr_b16 v[118:119], v31 offset:6912
    v_dot2c_f32_bf16 v216, v108, v32
    v_dot2c_f32_bf16 v216, v109, v32
    v_dot2c_f32_bf16 v216, v110, v32
    v_dot2c_f32_bf16 v216, v111, v32
    v_mfma_f32_32x32x16_bf16 v[152:167], v[60:63], v[80:83], v[152:167]
    v_dot2c_f32_bf16 v218, v60, v32
    v_dot2c_f32_bf16 v218, v61, v32
    v_dot2c_f32_bf16 v218, v62, v32
    v_dot2c_f32_bf16 v218, v63, v32
    v_dot2c_f32_bf16 v220, v60, v60
    v_dot2c_f32_bf16 v220, v61, v61
    v_dot2c_f32_bf16 v220, v62, v62
    v_dot2c_f32_bf16 v220, v63, v63
    s_waitcnt lgkmcnt(9)
    v_mfma_f32_32x32x16_bf16 v[120:135], v[84:87], v[64:67], v[120:135]
    ds_read_b128 v[60:63], v21 offset:0
    ds_read_b64_tr_b16 v[72:73], v26 offset:9216
    ds_read_b64_tr_b16 v[74:75], v26 offset:9984
    ds_read_b64_tr_b16 v[76:77], v27 offset:9216
    ds_read_b64_tr_b16 v[78:79], v27 offset:9984
    v_mfma_f32_32x32x16_bf16 v[136:151], v[88:91], v[64:67], v[136:151]
    ds_read_b64_tr_b16 v[80:81], v28 offset:9216
    ds_read_b64_tr_b16 v[82:83], v28 offset:9984
    ds_read_b64_tr_b16 v[108:109], v31 offset:9216
    ds_read_b64_tr_b16 v[110:111], v31 offset:9984
    v_dot2c_f32_bf16 v216, v112, v32
    v_dot2c_f32_bf16 v216, v113, v32
    v_dot2c_f32_bf16 v216, v114, v32
    v_dot2c_f32_bf16 v216, v115, v32
    v_mfma_f32_32x32x16_bf16 v[152:167], v[64:67], v[92:95], v[152:167]
    v_dot2c_f32_bf16 v218, v64, v32
    v_dot2c_f32_bf16 v218, v65, v32
    v_dot2c_f32_bf16 v218, v66, v32
    v_dot2c_f32_bf16 v218, v67, v32
    v_dot2c_f32_bf16 v220, v64, v64
    v_dot2c_f32_bf16 v220, v65, v65
    v_dot2c_f32_bf16 v220, v66, v66
    v_dot2c_f32_bf16 v220, v67, v67
    s_waitcnt lgkmcnt(0)
    s_barrier
    v_mfma_f32_32x32x16_bf16 v[120:135], v[96:99], v[68:71], v[120:135]
    ds_read_b128 v[64:67], v18 offset:28672
    ds_read_b64_tr_b16 v[84:85], v26 offset:28672
    ds_read_b64_tr_b16 v[86:87], v26 offset:29440
    ds_read_b64_tr_b16 v[88:89], v27 offset:28672
    ds_read_b64_tr_b16 v[90:91], v27 offset:29440
    v_mfma_f32_32x32x16_bf16 v[136:151], v[100:103], v[68:71], v[136:151]
    ds_read_b64_tr_b16 v[92:93], v28 offset:28672
    ds_read_b64_tr_b16 v[94:95], v28 offset:29440
    ds_read_b64_tr_b16 v[112:113], v31 offset:28672
    ds_read_b64_tr_b16 v[114:115], v31 offset:29440
    v_dot2c_f32_bf16 v216, v116, v32
    v_dot2c_f32_bf16 v216, v117, v32
    v_dot2c_f32_bf16 v216, v118, v32
    v_dot2c_f32_bf16 v216, v119, v32
    v_mfma_f32_32x32x16_bf16 v[152:167], v[68:71], v[104:107], v[152:167]
    v_dot2c_f32_bf16 v218, v68, v32
    v_dot2c_f32_bf16 v218, v69, v32
    v_dot2c_f32_bf16 v218, v70, v32
    v_dot2c_f32_bf16 v218, v71, v32
    v_dot2c_f32_bf16 v220, v68, v68
    v_dot2c_f32_bf16 v220, v69, v69
    v_dot2c_f32_bf16 v220, v70, v70
    v_dot2c_f32_bf16 v220, v71, v71
    s_waitcnt lgkmcnt(9)
    v_mfma_f32_32x32x16_bf16 v[120:135], v[72:75], v[60:63], v[120:135]
    ds_read_b128 v[68:71], v19 offset:28672
    ds_read_b64_tr_b16 v[96:97], v26 offset:31744
    ds_read_b64_tr_b16 v[98:99], v26 offset:32512
    ds_read_b64_tr_b16 v[100:101], v27 offset:31744
    ds_read_b64_tr_b16 v[102:103], v27 offset:32512
    v_mfma_f32_32x32x16_bf16 v[136:151], v[76:79], v[60:63], v[136:151]
    ds_read_b64_tr_b16 v[104:105], v28 offset:31744
    ds_read_b64_tr_b16 v[106:107], v28 offset:32512
    ds_read_b64_tr_b16 v[116:117], v31 offset:31744
    ds_read_b64_tr_b16 v[118:119], v31 offset:32512
    v_dot2c_f32_bf16 v216, v108, v32
    v_dot2c_f32_bf16 v216, v109, v32
    v_dot2c_f32_bf16 v216, v110, v32
    v_dot2c_f32_bf16 v216, v111, v32
    v_mfma_f32_32x32x16_bf16 v[152:167], v[60:63], v[80:83], v[152:167]
    v_dot2c_f32_bf16 v218, v60, v32
    v_dot2c_f32_bf16 v218, v61, v32
    v_dot2c_f32_bf16 v218, v62, v32
    v_dot2c_f32_bf16 v218, v63, v32
    v_dot2c_f32_bf16 v220, v60, v60
    v_dot2c_f32_bf16 v220, v61, v61
    v_dot2c_f32_bf16 v220, v62, v62
    v_dot2c_f32_bf16 v220, v63, v63
    s_waitcnt lgkmcnt(9)
    v_mfma_f32_32x32x16_bf16 v[120:135], v[84:87], v[64:67], v[120:135]
    ds_read_b128 v[60:63], v20 offset:28672
    ds_read_b64_tr_b16 v[72:73], v26 offset:34816
    ds_read_b64_tr_b16 v[74:75], v26 offset:35584
    ds_read_b64_tr_b16 v[76:77], v27 offset:34816
    ds_read_b64_tr_b16 v[78:79], v27 offset:35584
    v_mfma_f32_32x32x16_bf16 v[136:151], v[88:91], v[64:67], v[136:151]
    ds_read_b64_tr_b16 v[80:81], v28 offset:34816
    ds_read_b64_tr_b16 v[82:83], v28 offset:35584
    ds_read_b64_tr_b16 v[108:109], v31 offset:34816
    ds_read_b64_tr_b16 v[110:111], v31 offset:35584
    v_dot2c_f32_bf16 v216, v112, v32
    v_dot2c_f32_bf16 v216, v113, v32
    v_dot2c_f32_bf16 v216, v114, v32
    v_dot2c_f32_bf16 v216, v115, v32
    v_mfma_f32_32x32x16_bf16 v[152:167], v[64:67], v[92:95], v[152:167]
    v_dot2c_f32_bf16 v218, v64, v32
    v_dot2c_f32_bf16 v218, v65, v32
    v_dot2c_f32_bf16 v218, v66, v32
    v_dot2c_f32_bf16 v218, v67, v32
    v_dot2c_f32_bf16 v220, v64, v64
    v_dot2c_f32_bf16 v220, v65, v65
    v_dot2c_f32_bf16 v220, v66, v66
    v_dot2c_f32_bf16 v220, v67, v67
    s_waitcnt lgkmcnt(9)
    v_mfma_f32_32x32x16_bf16 v[120:135], v[96:99], v[68:71], v[120:135]
    ds_read_b128 v[64:67], v21 offset:28672
    ds_read_b64_tr_b16 v[84:85], v26 offset:37888
    ds_read_b64_tr_b16 v[86:87], v26 offset:38656
    ds_read_b64_tr_b16 v[88:89], v27 offset:37888
    ds_read_b64_tr_b16 v[90:91], v27 offset:38656
    v_mfma_f32_32x32x16_bf16 v[136:151], v[100:103], v[68:71], v[136:151]
    ds_read_b64_tr_b16 v[92:93], v28 offset:37888
    ds_read_b64_tr_b16 v[94:95], v28 offset:38656
    ds_read_b64_tr_b16 v[112:113], v31 offset:37888
    ds_read_b64_tr_b16 v[114:115], v31 offset:38656
    v_dot2c_f32_bf16 v216, v116, v32
    v_dot2c_f32_bf16 v216, v117, v32
    v_dot2c_f32_bf16 v216, v118, v32
    v_dot2c_f32_bf16 v216, v119, v32
    v_mfma_f32_32x32x16_bf16 v[152:167], v[68:71], v[104:107], v[152:167]
    v_dot2c_f32_bf16 v218, v68, v32
    v_dot2c_f32_bf16 v218, v69, v32
    v_dot2c_f32_bf16 v218, v70, v32
    v_dot2c_f32_bf16 v218, v71, v32
    v_dot2c_f32_bf16 v220, v68, v68
    v_dot2c_f32_bf16 v220, v69, v69
    v_dot2c_f32_bf16 v220, v70, v70
    v_dot2c_f32_bf16 v220, v71, v71
    s_waitcnt lgkmcnt(9)
    v_mfma_f32_32x32x16_bf16 v[120:135], v[72:75], v[60:63], v[120:135]
    v_dot2c_f32_bf16 v216, v108, v32
    v_dot2c_f32_bf16 v216, v109, v32
    v_dot2c_f32_bf16 v216, v110, v32
    v_dot2c_f32_bf16 v216, v111, v32
    v_mfma_f32_32x32x16_bf16 v[136:151], v[76:79], v[60:63], v[136:151]
    v_dot2c_f32_bf16 v218, v60, v32
    v_dot2c_f32_bf16 v218, v61, v32
    v_dot2c_f32_bf16 v218, v62, v32
    v_dot2c_f32_bf16 v218, v63, v32
    v_mfma_f32_32x32x16_bf16 v[152:167], v[60:63], v[80:83], v[152:167]
    v_dot2c_f32_bf16 v220, v60, v60
    v_dot2c_f32_bf16 v220, v61, v61
    v_dot2c_f32_bf16 v220, v62, v62
    v_dot2c_f32_bf16 v220, v63, v63
    s_waitcnt lgkmcnt(0)
    v_mfma_f32_32x32x16_bf16 v[120:135], v[84:87], v[64:67], v[120:135]
    v_dot2c_f32_bf16 v216, v112, v32
    v_dot2c_f32_bf16 v216, v113, v32
    v_dot2c_f32_bf16 v216, v114, v32
    v_dot2c_f32_bf16 v216, v115, v32
    v_mfma_f32_32x32x16_bf16 v[136:151], v[88:91], v[64:67], v[136:151]
    v_dot2c_f32_bf16 v218, v64, v32
    v_dot2c_f32_bf16 v218, v65, v32
    v_dot2c_f32_bf16 v218, v66, v32
    v_dot2c_f32_bf16 v218, v67, v32
    v_mfma_f32_32x32x16_bf16 v[152:167], v[64:67], v[92:95], v[152:167]
    v_dot2c_f32_bf16 v220, v64, v64
    v_dot2c_f32_bf16 v220, v65, v65
    v_dot2c_f32_bf16 v220, v66, v66
    v_dot2c_f32_bf16 v220, v67, v67
    s_waitcnt vmcnt(0)
    s_nop 3
    v_add_f32 v33, v218, v219
    v_add_f32 v34, v220, v221
    v_mov_b32 v2, v33
    s_nop 1
    v_permlane32_swap_b32 v33, v2
    v_add_f32 v33, v33, v2
    v_mov_b32 v2, v34
    s_nop 1
    v_permlane32_swap_b32 v34, v2
    v_add_f32 v34, v34, v2
    v_add_f32 v35, v216, v217
    v_mov_b32 v2, v35
    s_nop 1
    v_permlane32_swap_b32 v35, v2
    v_add_f32 v35, v35, v2
    v_and_b32 v2, 31, v1
    v_lshlrev_b32 v2, 2, v2
    s_min_u32 s23, s3, 2
    s_lshl_b32 s23, s23, 11
    s_lshl_b32 s22, s21, 7
    s_add_u32 s23, s23, s22
    s_add_u32 s23, s23, 15728640
    buffer_store_dword v35, v2, s[12:15], s23 offen
    v_mul_f32 v37, 0x3b000000, v33
    v_mul_f32 v2, 0x3b000000, v34
    v_fma_f32 v2, -v37, v37, v2
    v_max_f32 v2, 0, v2
    v_cvt_pk_bf16_f32 v3, v2, v2
    v_and_b32 v2, 0xffff0000, v3
    v_add_f32 v2, 0x3727c5ac, v2
    v_cvt_pk_bf16_f32 v3, v2, v2
    v_and_b32 v2, 0xffff0000, v3
    v_sqrt_f32 v2, v2
    s_nop 0
    v_cvt_pk_bf16_f32 v3, v2, v2
    v_and_b32 v2, 0xffff0000, v3
    v_rcp_f32 v38, v2
    v_cvt_pk_bf16_f32 v3, v37, v37
    v_and_b32 v37, 0xffff0000, v3
    v_mov_b32 v39, v38
    v_mul_f32 v40, v37, v38
    v_sub_f32 v40, 0, v40
    v_mov_b32 v41, v40
    v_and_b32 v2, 31, v1
    v_lshlrev_b32 v2, 2, v2
    s_lshl_b32 s22, s3, 7
    v_add_u32 v3, s22, v2
    v_add_u32 v3, 114688, v3
    ds_write_b32 v3, v35
    s_lshl_b32 s22, s3, 8
    v_add_u32 v4, s22, v2
    v_add_u32 v4, 115712, v4
    ds_write_b32 v4, v37
    ds_write_b32 v4, v38 offset:128
    s_waitcnt lgkmcnt(0)
    s_barrier
    v_lshrrev_b32 v5, 5, v1
    v_lshlrev_b32 v5, 4, v5
    v_add_u32 v5, 114688, v5
    ds_read_b128 v[168:171], v5 offset:0
    ds_read_b128 v[172:175], v5 offset:32
    ds_read_b128 v[176:179], v5 offset:64
    ds_read_b128 v[180:183], v5 offset:96
    ds_read_b128 v[184:187], v5 offset:128
    ds_read_b128 v[188:191], v5 offset:160
    ds_read_b128 v[192:195], v5 offset:192
    ds_read_b128 v[196:199], v5 offset:224
    s_lshl_b32 s22, s20, 2
    s_add_u32 s22, s22, s3
    s_lshl_b32 s23, s22, 10
    s_lshl_b32 s24, s21, 17
    s_add_u32 s23, s23, s24
    v_lshlrev_b32 v228, 4, v1
    v_add_u32 v228, s23, v228
    v_mul_f32 v224, 0x3eb8aa3b, v38
    v_mul_f32 v226, 0x3eb8aa3b, v40
    v_mov_b32 v225, v224
    v_mov_b32 v227, v226
    s_waitcnt lgkmcnt(4)
    v_pk_mul_f32 v[168:169], v[168:169], v[226:227]
    v_pk_mul_f32 v[170:171], v[170:171], v[226:227]
    v_pk_mul_f32 v[172:173], v[172:173], v[226:227]
    v_pk_mul_f32 v[174:175], v[174:175], v[226:227]
    v_pk_mul_f32 v[176:177], v[176:177], v[226:227]
    v_pk_mul_f32 v[178:179], v[178:179], v[226:227]
    v_pk_mul_f32 v[180:181], v[180:181], v[226:227]
    v_pk_mul_f32 v[182:183], v[182:183], v[226:227]
    v_pk_fma_f32 v[120:121], v[120:121], v[224:225], v[168:169]
    v_pk_fma_f32 v[122:123], v[122:123], v[224:225], v[170:171]
    v_pk_fma_f32 v[124:125], v[124:125], v[224:225], v[172:173]
    v_pk_fma_f32 v[126:127], v[126:127], v[224:225], v[174:175]
    v_pk_fma_f32 v[128:129], v[128:129], v[224:225], v[176:177]
    v_pk_fma_f32 v[130:131], v[130:131], v[224:225], v[178:179]
    v_pk_fma_f32 v[132:133], v[132:133], v[224:225], v[180:181]
    v_pk_fma_f32 v[134:135], v[134:135], v[224:225], v[182:183]
    v_cvt_pk_bf16_f32 v200, v120, v121
    v_cvt_pk_bf16_f32 v201, v122, v123
    v_cvt_pk_bf16_f32 v202, v124, v125
    v_cvt_pk_bf16_f32 v203, v126, v127
    v_cvt_pk_bf16_f32 v204, v128, v129
    v_cvt_pk_bf16_f32 v205, v130, v131
    v_cvt_pk_bf16_f32 v206, v132, v133
    v_cvt_pk_bf16_f32 v207, v134, v135
    s_nop 0
    v_permlane32_swap_b32 v200, v202
    v_permlane32_swap_b32 v201, v203
    s_mov_b32 s25, 0
    buffer_store_dwordx4 v[200:203], v228, s[12:15], s25 offen
    v_permlane32_swap_b32 v204, v206
    v_permlane32_swap_b32 v205, v207
    s_mov_b32 s25, 65536
    buffer_store_dwordx4 v[204:207], v228, s[12:15], s25 offen
    s_waitcnt lgkmcnt(0)
    v_pk_mul_f32 v[184:185], v[184:185], v[40:41]
    v_pk_mul_f32 v[186:187], v[186:187], v[40:41]
    v_pk_mul_f32 v[188:189], v[188:189], v[40:41]
    v_pk_mul_f32 v[190:191], v[190:191], v[40:41]
    v_pk_mul_f32 v[192:193], v[192:193], v[40:41]
    v_pk_mul_f32 v[194:195], v[194:195], v[40:41]
    v_pk_mul_f32 v[196:197], v[196:197], v[40:41]
    v_pk_mul_f32 v[198:199], v[198:199], v[40:41]
    v_pk_fma_f32 v[136:137], v[136:137], v[38:39], v[184:185]
    v_pk_fma_f32 v[138:139], v[138:139], v[38:39], v[186:187]
    v_pk_fma_f32 v[140:141], v[140:141], v[38:39], v[188:189]
    v_pk_fma_f32 v[142:143], v[142:143], v[38:39], v[190:191]
    v_pk_fma_f32 v[144:145], v[144:145], v[38:39], v[192:193]
    v_pk_fma_f32 v[146:147], v[146:147], v[38:39], v[194:195]
    v_pk_fma_f32 v[148:149], v[148:149], v[38:39], v[196:197]
    v_pk_fma_f32 v[150:151], v[150:151], v[38:39], v[198:199]
    v_cvt_pk_bf16_f32 v208, v136, v137
    v_cvt_pk_bf16_f32 v209, v138, v139
    v_cvt_pk_bf16_f32 v210, v140, v141
    v_cvt_pk_bf16_f32 v211, v142, v143
    v_cvt_pk_bf16_f32 v212, v144, v145
    v_cvt_pk_bf16_f32 v213, v146, v147
    v_cvt_pk_bf16_f32 v214, v148, v149
    v_cvt_pk_bf16_f32 v215, v150, v151
    s_nop 0
    v_permlane32_swap_b32 v208, v210
    v_permlane32_swap_b32 v209, v211
    s_mov_b32 s25, 2097152
    buffer_store_dwordx4 v[208:211], v228, s[12:15], s25 offen
    v_permlane32_swap_b32 v212, v214
    v_permlane32_swap_b32 v213, v215
    s_mov_b32 s25, 2162688
    buffer_store_dwordx4 v[212:215], v228, s[12:15], s25 offen
    v_and_b32 v2, 31, v1
    v_lshlrev_b32 v2, 2, v2
    v_add_u32 v2, 114688, v2
    ds_read_b32 v35, v2 offset:256
    s_lshl_b32 s25, s3, 8
    v_add_u32 v4, s25, v5
    ds_read_b128 v[168:171], v4 offset:1024
    ds_read_b128 v[184:187], v4 offset:1152
    ds_read_b128 v[172:175], v4 offset:1056
    ds_read_b128 v[188:191], v4 offset:1184
    ds_read_b128 v[176:179], v4 offset:1088
    ds_read_b128 v[192:195], v4 offset:1216
    ds_read_b128 v[180:183], v4 offset:1120
    ds_read_b128 v[196:199], v4 offset:1248
    v_bfe_u32 v229, v1, 4, 1
    v_lshlrev_b32 v229, 16, v229
    v_lshrrev_b32 v2, 5, v1
    v_lshl_add_u32 v229, v2, 8, v229
    v_and_b32 v2, 15, v1
    v_lshl_add_u32 v229, v2, 4, v229
    v_add_u32 v229, s23, v229
    s_waitcnt lgkmcnt(0)
    v_sub_f32 v224, 0, v35
    v_sub_f32 v225, 0, v35
    v_pk_fma_f32 v[152:153], v[168:169], v[224:225], v[152:153]
    v_pk_fma_f32 v[154:155], v[170:171], v[224:225], v[154:155]
    v_pk_fma_f32 v[156:157], v[172:173], v[224:225], v[156:157]
    v_pk_fma_f32 v[158:159], v[174:175], v[224:225], v[158:159]
    v_pk_fma_f32 v[160:161], v[176:177], v[224:225], v[160:161]
    v_pk_fma_f32 v[162:163], v[178:179], v[224:225], v[162:163]
    v_pk_fma_f32 v[164:165], v[180:181], v[224:225], v[164:165]
    v_pk_fma_f32 v[166:167], v[182:183], v[224:225], v[166:167]
    v_pk_mul_f32 v[152:153], v[152:153], v[184:185]
    v_pk_mul_f32 v[154:155], v[154:155], v[186:187]
    v_pk_mul_f32 v[156:157], v[156:157], v[188:189]
    v_pk_mul_f32 v[158:159], v[158:159], v[190:191]
    v_pk_mul_f32 v[160:161], v[160:161], v[192:193]
    v_pk_mul_f32 v[162:163], v[162:163], v[194:195]
    v_pk_mul_f32 v[164:165], v[164:165], v[196:197]
    v_pk_mul_f32 v[166:167], v[166:167], v[198:199]
    v_cvt_pk_bf16_f32 v216, v152, v153
    v_cvt_pk_bf16_f32 v217, v154, v155
    v_cvt_pk_bf16_f32 v218, v156, v157
    v_cvt_pk_bf16_f32 v219, v158, v159
    s_mov_b32 s25, 4194304
    buffer_store_dwordx4 v[216:219], v229, s[12:15], s25 offen
    v_cvt_pk_bf16_f32 v220, v160, v161
    v_cvt_pk_bf16_f32 v221, v162, v163
    v_cvt_pk_bf16_f32 v222, v164, v165
    v_cvt_pk_bf16_f32 v223, v166, v167
    s_mov_b32 s25, 4194816
    buffer_store_dwordx4 v[220:223], v229, s[12:15], s25 offen
qkv1_kernel_end:
    s_endpgm
.section .rodata,"a"
.p2align 6
.amdhsa_kernel qkv1_kernel
  .amdhsa_next_free_vgpr 232
  .amdhsa_next_free_sgpr 96
  .amdhsa_accum_offset 232
  .amdhsa_group_segment_fixed_size 0
  .amdhsa_kernarg_size 80
  .amdhsa_user_sgpr_count 2
  .amdhsa_user_sgpr_kernarg_segment_ptr 1
  .amdhsa_system_sgpr_workgroup_id_x 1
.end_amdhsa_kernel
.text
.globl attn_kernel
.p2align 8
.type attn_kernel,@function
attn_kernel:
    s_cmp_ge_u32 s2, 256
    s_cbranch_scc1 attn_kernel_end
    s_load_dwordx2 s[28:29], s[0:1], 72
    s_load_dwordx2 s[30:31], s[0:1], 16
    s_load_dwordx2 s[32:33], s[0:1], 32
    s_load_dwordx2 s[34:35], s[0:1], 48
    v_and_b32 v1, 63, v0
    v_lshrrev_b32 v2, 6, v0
    s_and_b32 s20, s2, 31
    v_readfirstlane_b32 s3, v2
    s_lshr_b32 s21, s2, 5
    v_lshlrev_b32 v6, 4, v1
    s_lshl_b32 s22, s20, 16
    s_lshl_b32 s23, s21, 13
    s_add_u32 s23, s23, s22
    s_lshl_b32 s24, s3, 10
    s_add_u32 s24, s24, s23
    s_add_u32 s24, s24, 0
    s_cmp_lt_u32 s3, 8
    s_cbranch_scc1 attn_kernel_comp
    s_bfe_u32 s25, s3, 0x10001
    s_and_b32 s23, s3, 1
    s_lshl_b32 s23, s23, 10
    s_lshl_b32 s27, s25, 16
    s_add_u32 s27, s27, s23
    s_mul_i32 s26, s25, 2097152
    s_add_u32 s26, s26, s22
    s_add_u32 s26, s26, s23
    s_add_u32 s26, s26, 2097152
    s_waitcnt lgkmcnt(0)
    s_mov_b32 s4, s28
    s_mov_b32 s5, s29
    s_and_b32 s5, s5, 0xffff
    s_mov_b32 s6, 0x10000000
    s_mov_b32 s7, 0x00020000
    s_add_u32 m0, s27, 0
    s_add_u32 s25, s26, 0
    buffer_load_dwordx4 v6, s[4:7], s25 offen lds
    s_add_u32 m0, s27, 2048
    s_add_u32 s25, s26, 2048
    buffer_load_dwordx4 v6, s[4:7], s25 offen lds
    s_add_u32 m0, s27, 4096
    s_add_u32 s25, s26, 4096
    buffer_load_dwordx4 v6, s[4:7], s25 offen lds
    s_add_u32 m0, s27, 6144
    s_add_u32 s25, s26, 6144
    buffer_load_dwordx4 v6, s[4:7], s25 offen lds
    s_waitcnt vmcnt(1)
    s_barrier
    s_add_u32 m0, s27, 8192
    s_add_u32 s25, s26, 8192
    buffer_load_dwordx4 v6, s[4:7], s25 offen lds
    s_add_u32 m0, s27, 10240
    s_add_u32 s25, s26, 10240
    buffer_load_dwordx4 v6, s[4:7], s25 offen lds
    s_add_u32 m0, s27, 12288
    s_add_u32 s25, s26, 12288
    buffer_load_dwordx4 v6, s[4:7], s25 offen lds
    s_add_u32 m0, s27, 14336
    s_add_u32 s25, s26, 14336
    buffer_load_dwordx4 v6, s[4:7], s25 offen lds
    s_add_u32 m0, s27, 16384
    s_add_u32 s25, s26, 16384
    buffer_load_dwordx4 v6, s[4:7], s25 offen lds
    s_add_u32 m0, s27, 18432
    s_add_u32 s25, s26, 18432
    buffer_load_dwordx4 v6, s[4:7], s25 offen lds
    s_add_u32 m0, s27, 20480
    s_add_u32 s25, s26, 20480
    buffer_load_dwordx4 v6, s[4:7], s25 offen lds
    s_add_u32 m0, s27, 22528
    s_add_u32 s25, s26, 22528
    buffer_load_dwordx4 v6, s[4:7], s25 offen lds
    s_add_u32 m0, s27, 24576
    s_add_u32 s25, s26, 24576
    buffer_load_dwordx4 v6, s[4:7], s25 offen lds
    s_add_u32 m0, s27, 26624
    s_add_u32 s25, s26, 26624
    buffer_load_dwordx4 v6, s[4:7], s25 offen lds
    s_add_u32 m0, s27, 28672
    s_add_u32 s25, s26, 28672
    buffer_load_dwordx4 v6, s[4:7], s25 offen lds
    s_add_u32 m0, s27, 30720
    s_add_u32 s25, s26, 30720
    buffer_load_dwordx4 v6, s[4:7], s25 offen lds
    s_waitcnt vmcnt(4)
    s_barrier
    s_add_u32 m0, s27, 32768
    s_add_u32 s25, s26, 32768
    buffer_load_dwordx4 v6, s[4:7], s25 offen lds
    s_add_u32 m0, s27, 34816
    s_add_u32 s25, s26, 34816
    buffer_load_dwordx4 v6, s[4:7], s25 offen lds
    s_add_u32 m0, s27, 36864
    s_add_u32 s25, s26, 36864
    buffer_load_dwordx4 v6, s[4:7], s25 offen lds
    s_add_u32 m0, s27, 38912
    s_add_u32 s25, s26, 38912
    buffer_load_dwordx4 v6, s[4:7], s25 offen lds
    s_add_u32 m0, s27, 40960
    s_add_u32 s25, s26, 40960
    buffer_load_dwordx4 v6, s[4:7], s25 offen lds
    s_add_u32 m0, s27, 43008
    s_add_u32 s25, s26, 43008
    buffer_load_dwordx4 v6, s[4:7], s25 offen lds
    s_add_u32 m0, s27, 45056
    s_add_u32 s25, s26, 45056
    buffer_load_dwordx4 v6, s[4:7], s25 offen lds
    s_add_u32 m0, s27, 47104
    s_add_u32 s25, s26, 47104
    buffer_load_dwordx4 v6, s[4:7], s25 offen lds
    s_add_u32 m0, s27, 49152
    s_add_u32 s25, s26, 49152
    buffer_load_dwordx4 v6, s[4:7], s25 offen lds
    s_add_u32 m0, s27, 51200
    s_add_u32 s25, s26, 51200
    buffer_load_dwordx4 v6, s[4:7], s25 offen lds
    s_add_u32 m0, s27, 53248
    s_add_u32 s25, s26, 53248
    buffer_load_dwordx4 v6, s[4:7], s25 offen lds
    s_add_u32 m0, s27, 55296
    s_add_u32 s25, s26, 55296
    buffer_load_dwordx4 v6, s[4:7], s25 offen lds
    s_add_u32 m0, s27, 57344
    s_add_u32 s25, s26, 57344
    buffer_load_dwordx4 v6, s[4:7], s25 offen lds
    s_add_u32 m0, s27, 59392
    s_add_u32 s25, s26, 59392
    buffer_load_dwordx4 v6, s[4:7], s25 offen lds
    s_add_u32 m0, s27, 61440
    s_add_u32 s25, s26, 61440
    buffer_load_dwordx4 v6, s[4:7], s25 offen lds
    s_add_u32 m0, s27, 63488
    s_add_u32 s25, s26, 63488
    buffer_load_dwordx4 v6, s[4:7], s25 offen lds
    s_waitcnt vmcnt(0)
    s_barrier
    s_and_b32 s22, s3, 3
    s_cmp_eq_u32 s22, 1
    s_cbranch_scc1 attn_kernel_rw2
    s_cmp_eq_u32 s22, 2
    s_cbranch_scc1 attn_kernel_rw3
    s_cmp_eq_u32 s22, 3
    s_cbranch_scc1 attn_kernel_rw4
    s_mov_b32 s40, s34
    s_mov_b32 s41, s35
    s_and_b32 s41, s41, 0xffff
    s_mov_b32 s42, 0x1c0000
    s_mov_b32 s43, 0x00020000
    v_lshrrev_b32 v2, 3, v1
    v_bfe_u32 v3, v1, 2, 1
    v_bfe_u32 v4, v1, 4, 1
    v_xor_b32 v3, v3, v4
    v_lshlrev_b32 v3, 6, v3
    v_and_b32 v4, 3, v1
    v_lshl_add_u32 v3, v4, 4, v3
    v_lshl_add_u32 v16, v2, 10, v3
    s_lshr_b32 s22, s2, 5
    s_and_b32 s23, s2, 31
    s_mul_i32 s23, s23, 7
    s_lshl_b32 s25, s23, 13
    s_lshl_b32 s36, s22, 7
    s_add_u32 s25, s25, s36
    buffer_load_dwordx4 v[44:47], v16, s[40:43], s25 offen
    s_add_u32 s25, s25, 8192
    buffer_load_dwordx4 v[48:51], v16, s[40:43], s25 offen
    s_add_u32 s25, s25, 8192
    buffer_load_dwordx4 v[52:55], v16, s[40:43], s25 offen
    s_add_u32 s25, s25, 8192
    buffer_load_dwordx4 v[56:59], v16, s[40:43], s25 offen
    s_add_u32 s25, s25, 8192
    buffer_load_dwordx4 v[60:63], v16, s[40:43], s25 offen
    s_add_u32 s25, s25, 8192
    buffer_load_dwordx4 v[64:67], v16, s[40:43], s25 offen
    s_add_u32 s25, s25, 8192
    buffer_load_dwordx4 v[68:71], v16, s[40:43], s25 offen
    s_add_u32 s25, s25, 8192
    s_mul_i32 s22, s22, 224
    s_add_u32 s22, s22, s23
    s_lshl_b32 s22, s22, 10
    s_add_u32 s22, s22, 28311552
    s_waitcnt vmcnt(0)
    buffer_store_dwordx4 v[44:47], v6, s[4:7], s22 offen
    s_add_u32 s22, s22, 1024
    buffer_store_dwordx4 v[48:51], v6, s[4:7], s22 offen
    s_add_u32 s22, s22, 1024
    buffer_store_dwordx4 v[52:55], v6, s[4:7], s22 offen
    s_add_u32 s22, s22, 1024
    buffer_store_dwordx4 v[56:59], v6, s[4:7], s22 offen
    s_add_u32 s22, s22, 1024
    buffer_store_dwordx4 v[60:63], v6, s[4:7], s22 offen
    s_add_u32 s22, s22, 1024
    buffer_store_dwordx4 v[64:67], v6, s[4:7], s22 offen
    s_add_u32 s22, s22, 1024
    buffer_store_dwordx4 v[68:71], v6, s[4:7], s22 offen
    s_add_u32 s22, s22, 1024
    s_branch attn_kernel_rd5
attn_kernel_rw2:
    s_mov_b32 s40, s32
    s_mov_b32 s41, s33
    s_and_b32 s41, s41, 0xffff
    s_mov_b32 s42, 0x1c0000
    s_mov_b32 s43, 0x00020000
    v_lshrrev_b32 v2, 4, v1
    v_bfe_u32 v3, v1, 2, 2
    v_xor_b32 v3, v3, v2
    v_lshlrev_b32 v3, 6, v3
    v_and_b32 v4, 3, v1
    v_lshl_add_u32 v3, v4, 4, v3
    v_mul_u32_u24 v16, 3584, v2
    v_add_u32 v16, v16, v3
    s_mul_i32 s36, s2, 7
    s_add_u32 s22, s36, 0
    s_and_b32 s23, s22, 127
    s_mul_i32 s23, s23, 14336
    s_lshr_b32 s22, s22, 7
    s_lshl_b32 s22, s22, 8
    s_add_u32 s25, s22, s23
    buffer_load_dwordx4 v[44:47], v16, s[40:43], s25 offen
    s_add_u32 s22, s36, 1
    s_and_b32 s23, s22, 127
    s_mul_i32 s23, s23, 14336
    s_lshr_b32 s22, s22, 7
    s_lshl_b32 s22, s22, 8
    s_add_u32 s25, s22, s23
    buffer_load_dwordx4 v[48:51], v16, s[40:43], s25 offen
    s_add_u32 s22, s36, 2
    s_and_b32 s23, s22, 127
    s_mul_i32 s23, s23, 14336
    s_lshr_b32 s22, s22, 7
    s_lshl_b32 s22, s22, 8
    s_add_u32 s25, s22, s23
    buffer_load_dwordx4 v[52:55], v16, s[40:43], s25 offen
    s_add_u32 s22, s36, 3
    s_and_b32 s23, s22, 127
    s_mul_i32 s23, s23, 14336
    s_lshr_b32 s22, s22, 7
    s_lshl_b32 s22, s22, 8
    s_add_u32 s25, s22, s23
    buffer_load_dwordx4 v[56:59], v16, s[40:43], s25 offen
    s_add_u32 s22, s36, 4
    s_and_b32 s23, s22, 127
    s_mul_i32 s23, s23, 14336
    s_lshr_b32 s22, s22, 7
    s_lshl_b32 s22, s22, 8
    s_add_u32 s25, s22, s23
    buffer_load_dwordx4 v[60:63], v16, s[40:43], s25 offen
    s_add_u32 s22, s36, 5
    s_and_b32 s23, s22, 127
    s_mul_i32 s23, s23, 14336
    s_lshr_b32 s22, s22, 7
    s_lshl_b32 s22, s22, 8
    s_add_u32 s25, s22, s23
    buffer_load_dwordx4 v[64:67], v16, s[40:43], s25 offen
    s_add_u32 s22, s36, 6
    s_and_b32 s23, s22, 127
    s_mul_i32 s23, s23, 14336
    s_lshr_b32 s22, s22, 7
    s_lshl_b32 s22, s22, 8
    s_add_u32 s25, s22, s23
    buffer_load_dwordx4 v[68:71], v16, s[40:43], s25 offen
    s_lshl_b32 s22, s36, 10
    s_add_u32 s22, s22, 26214400
    s_waitcnt vmcnt(0)
    buffer_store_dwordx4 v[44:47], v6, s[4:7], s22 offen
    s_add_u32 s22, s22, 1024
    buffer_store_dwordx4 v[48:51], v6, s[4:7], s22 offen
    s_add_u32 s22, s22, 1024
    buffer_store_dwordx4 v[52:55], v6, s[4:7], s22 offen
    s_add_u32 s22, s22, 1024
    buffer_store_dwordx4 v[56:59], v6, s[4:7], s22 offen
    s_add_u32 s22, s22, 1024
    buffer_store_dwordx4 v[60:63], v6, s[4:7], s22 offen
    s_add_u32 s22, s22, 1024
    buffer_store_dwordx4 v[64:67], v6, s[4:7], s22 offen
    s_add_u32 s22, s22, 1024
    buffer_store_dwordx4 v[68:71], v6, s[4:7], s22 offen
    s_add_u32 s22, s22, 1024
    s_branch attn_kernel_rd5
attn_kernel_rw3:
    s_load_dwordx2 s[44:45], s[0:1], 8
    v_add_u32 v2, 0, v1
    v_mul_u32_u24 v3, 171, v2
    v_lshrrev_b32 v3, 11, v3
    v_mul_u32_u24 v4, 12, v3
    v_sub_u32 v4, v2, v4
    v_mul_u32_u24 v16, 3072, v3
    v_lshrrev_b32 v5, 2, v4
    v_lshl_add_u32 v16, v5, 10, v16
    v_and_b32 v5, 3, v4
    v_lshl_add_u32 v16, v5, 4, v16
    v_add_u32 v2, 64, v1
    v_mul_u32_u24 v3, 171, v2
    v_lshrrev_b32 v3, 11, v3
    v_mul_u32_u24 v4, 12, v3
    v_sub_u32 v4, v2, v4
    v_mul_u32_u24 v17, 3072, v3
    v_lshrrev_b32 v5, 2, v4
    v_lshl_add_u32 v17, v5, 10, v17
    v_and_b32 v5, 3, v4
    v_lshl_add_u32 v17, v5, 4, v17
    v_add_u32 v2, 128, v1
    v_mul_u32_u24 v3, 171, v2
    v_lshrrev_b32 v3, 11, v3
    v_mul_u32_u24 v4, 12, v3
    v_sub_u32 v4, v2, v4
    v_mul_u32_u24 v18, 3072, v3
    v_lshrrev_b32 v5, 2, v4
    v_lshl_add_u32 v18, v5, 10, v18
    v_and_b32 v5, 3, v4
    v_lshl_add_u32 v18, v5, 4, v18
    s_waitcnt lgkmcnt(0)
    s_mov_b32 s40, s44
    s_mov_b32 s41, s45
    s_and_b32 s41, s41, 0xffff
    s_mov_b32 s42, 0x180000
    s_mov_b32 s43, 0x00020000
    s_lshl_b32 s36, s2, 1
    s_add_u32 s22, s36, 0
    s_and_b32 s23, s22, 31
    s_mul_i32 s23, s23, 49152
    s_lshr_b32 s22, s22, 5
    s_lshl_b32 s22, s22, 6
    s_add_u32 s25, s22, s23
    buffer_load_dwordx4 v[44:47], v16, s[40:43], s25 offen
    buffer_load_dwordx4 v[48:51], v17, s[40:43], s25 offen
    buffer_load_dwordx4 v[52:55], v18, s[40:43], s25 offen
    s_add_u32 s22, s36, 1
    s_and_b32 s23, s22, 31
    s_mul_i32 s23, s23, 49152
    s_lshr_b32 s22, s22, 5
    s_lshl_b32 s22, s22, 6
    s_add_u32 s25, s22, s23
    buffer_load_dwordx4 v[56:59], v16, s[40:43], s25 offen
    buffer_load_dwordx4 v[60:63], v17, s[40:43], s25 offen
    buffer_load_dwordx4 v[64:67], v18, s[40:43], s25 offen
    s_mul_i32 s22, s2, 6144
    s_add_u32 s22, s22, 30408704
    s_waitcnt vmcnt(0)
    buffer_store_dwordx4 v[44:47], v6, s[4:7], s22 offen
    s_add_u32 s22, s22, 1024
    buffer_store_dwordx4 v[48:51], v6, s[4:7], s22 offen
    s_add_u32 s22, s22, 1024
    buffer_store_dwordx4 v[52:55], v6, s[4:7], s22 offen
    s_add_u32 s22, s22, 1024
    buffer_store_dwordx4 v[56:59], v6, s[4:7], s22 offen
    s_add_u32 s22, s22, 1024
    buffer_store_dwordx4 v[60:63], v6, s[4:7], s22 offen
    s_add_u32 s22, s22, 1024
    buffer_store_dwordx4 v[64:67], v6, s[4:7], s22 offen
    s_add_u32 s22, s22, 1024
    s_branch attn_kernel_rd5
attn_kernel_rw4:
    s_mov_b32 s40, s30
    s_mov_b32 s41, s31
    s_and_b32 s41, s41, 0xffff
    s_mov_b32 s42, 0x80000
    s_mov_b32 s43, 0x00020000
    v_lshrrev_b32 v2, 3, v1
    v_bfe_u32 v3, v1, 2, 1
    v_bfe_u32 v4, v1, 4, 1
    v_xor_b32 v3, v3, v4
    v_lshlrev_b32 v3, 6, v3
    v_and_b32 v4, 3, v1
    v_lshl_add_u32 v3, v4, 4, v3
    v_lshl_add_u32 v16, v2, 10, v3
    s_lshr_b32 s22, s2, 5
    s_and_b32 s23, s2, 31
    s_mul_i32 s23, s23, 2
    s_lshl_b32 s25, s23, 13
    s_lshl_b32 s36, s22, 7
    s_add_u32 s25, s25, s36
    buffer_load_dwordx4 v[44:47], v16, s[40:43], s25 offen
    s_add_u32 s25, s25, 8192
    buffer_load_dwordx4 v[48:51], v16, s[40:43], s25 offen
    s_add_u32 s25, s25, 8192
    s_mul_i32 s22, s22, 64
    s_add_u32 s22, s22, s23
    s_lshl_b32 s22, s22, 10
    s_add_u32 s22, s22, 25165824
    s_waitcnt vmcnt(0)
    buffer_store_dwordx4 v[44:47], v6, s[4:7], s22 offen
    s_add_u32 s22, s22, 1024
    buffer_store_dwordx4 v[48:51], v6, s[4:7], s22 offen
    s_add_u32 s22, s22, 1024
attn_kernel_rd5:
    s_endpgm
attn_kernel_comp:
    s_waitcnt lgkmcnt(0)
    s_mov_b32 s4, s28
    s_mov_b32 s5, s29
    s_and_b32 s5, s5, 0xffff
    s_mov_b32 s6, 0x10000000
    s_mov_b32 s7, 0x00020000
    buffer_load_dwordx4 v[16:19], v6, s[4:7], s24 offen
    v_and_b32 v2, 11, v1
    v_cmp_eq_u32 vcc, 0, v2
    v_mov_b32 v3, 0x3f803f80
    v_add_u32 v5, 131072, v6
    v_cndmask_b32 v116, 0, v3, vcc
    v_mov_b32 v117, v116
    v_mov_b32 v118, v116
    v_mov_b32 v119, v116
    ds_write_b128 v5, v[116:119]
    ds_write_b128 v5, v[116:119] offset:1024
    v_mov_b32 v10, v6
    v_lshrrev_b32 v2, 5, v1
    v_lshlrev_b32 v2, 8, v2
    v_and_b32 v3, 15, v1
    v_lshl_add_u32 v11, v3, 4, v2
    v_bfe_u32 v3, v1, 4, 1
    v_lshl_add_u32 v11, v3, 16, v11
    v_add_u32 v11, 65536, v11
    v_xor_b32 v3, 1, v3
    v_lshlrev_b32 v9, 11, v3
    v_mov_b32 v100, 0
    v_mov_b32 v101, 0
    v_mov_b32 v102, 0
    v_mov_b32 v103, 0
    v_mov_b32 v104, 0
    v_mov_b32 v105, 0
    v_mov_b32 v106, 0
    v_mov_b32 v107, 0
    v_mov_b32 v108, 0
    v_mov_b32 v109, 0
    v_mov_b32 v110, 0
    v_mov_b32 v111, 0
    v_mov_b32 v112, 0
    v_mov_b32 v113, 0
    v_mov_b32 v114, 0
    v_mov_b32 v115, 0
    s_lshl_b32 s22, s21, 3
    s_add_u32 s22, s22, s3
    s_lshl_b32 s22, s22, 15
    s_lshl_b32 s23, s20, 10
    s_add_u32 s22, s22, s23
    s_add_u32 s22, s22, 6291456
    v_add_u32 v12, s22, v6
    s_cmp_lt_u32 s3, 4
    s_cbranch_scc1 attn_kernel_np6
    s_setprio 1
attn_kernel_np6:
    v_mov_b32 v84, 0
    v_mov_b32 v85, 0
    v_mov_b32 v86, 0
    v_mov_b32 v87, 0
    v_mov_b32 v88, 0
    v_mov_b32 v89, 0
    v_mov_b32 v90, 0
    v_mov_b32 v91, 0
    v_mov_b32 v92, 0
    v_mov_b32 v93, 0
    v_mov_b32 v94, 0
    v_mov_b32 v95, 0
    v_mov_b32 v96, 0
    v_mov_b32 v97, 0
    v_mov_b32 v98, 0
    v_mov_b32 v99, 0
    v_mov_b32 v80, 0
    v_mov_b32 v81, 0
    v_mov_b32 v82, 0
    v_mov_b32 v83, 0
    v_mov_b32 v7, v10
    v_mov_b32 v8, v11
    s_waitcnt vmcnt(0) lgkmcnt(0)
    s_barrier
    ds_read_b128 v[20:23], v7 offset:0
    ds_read_b128 v[24:27], v7 offset:1024
    ds_read_b128 v[28:31], v8 offset:0
    ds_read_b128 v[32:35], v8 offset:512
    ds_read_b128 v[36:39], v8 offset:0
    ds_read_b128 v[40:43], v8 offset:512
    s_waitcnt lgkmcnt(5)
    v_mfma_f32_32x32x16_bf16 v[44:59], v[20:23], v[16:19], v[100:115]
    s_mov_b32 s36, 0
    s_waitcnt lgkmcnt(0)
    s_nop 9
    s_mov_b32 s37, 2
attn_kernel_lp7:
    ds_read_b128 v[20:23], v7 offset:2048
    v_exp_f32 v44, v44
    v_exp_f32 v45, v45
    v_exp_f32 v46, v46
    v_exp_f32 v47, v47
    v_cvt_pk_bf16_f32 v76, v44, v45
    v_cvt_pk_bf16_f32 v77, v46, v47
    v_mfma_f32_32x32x16_bf16 v[84:99], v[40:43], v[80:83], v[84:99]
    ds_read_b128 v[36:39], v8 offset:1024
    ds_read_b128 v[40:43], v8 offset:1536
    v_exp_f32 v48, v48
    v_exp_f32 v49, v49
    v_exp_f32 v50, v50
    v_exp_f32 v51, v51
    v_cvt_pk_bf16_f32 v78, v48, v49
    v_cvt_pk_bf16_f32 v79, v50, v51
    s_waitcnt lgkmcnt(3)
    v_mfma_f32_32x32x16_bf16 v[60:75], v[24:27], v[16:19], v[100:115]
    v_exp_f32 v52, v52
    v_exp_f32 v53, v53
    v_exp_f32 v54, v54
    v_exp_f32 v55, v55
    v_cvt_pk_bf16_f32 v80, v52, v53
    v_cvt_pk_bf16_f32 v81, v54, v55
    v_mfma_f32_32x32x16_bf16 v[84:99], v[28:31], v[76:79], v[84:99]
    v_exp_f32 v56, v56
    v_exp_f32 v57, v57
    v_exp_f32 v58, v58
    v_exp_f32 v59, v59
    v_cvt_pk_bf16_f32 v82, v56, v57
    v_cvt_pk_bf16_f32 v83, v58, v59
    v_add_u32 v8, v9, v8
    ds_read_b128 v[24:27], v7 offset:3072
    v_exp_f32 v60, v60
    v_exp_f32 v61, v61
    v_exp_f32 v62, v62
    v_exp_f32 v63, v63
    v_cvt_pk_bf16_f32 v76, v60, v61
    v_cvt_pk_bf16_f32 v77, v62, v63
    v_mfma_f32_32x32x16_bf16 v[84:99], v[32:35], v[80:83], v[84:99]
    ds_read_b128 v[28:31], v8 offset:0
    ds_read_b128 v[32:35], v8 offset:512
    v_exp_f32 v64, v64
    v_exp_f32 v65, v65
    v_exp_f32 v66, v66
    v_exp_f32 v67, v67
    v_cvt_pk_bf16_f32 v78, v64, v65
    v_cvt_pk_bf16_f32 v79, v66, v67
    s_waitcnt lgkmcnt(3)
    v_mfma_f32_32x32x16_bf16 v[44:59], v[20:23], v[16:19], v[100:115]
    v_exp_f32 v68, v68
    v_exp_f32 v69, v69
    v_exp_f32 v70, v70
    v_exp_f32 v71, v71
    v_cvt_pk_bf16_f32 v80, v68, v69
    v_cvt_pk_bf16_f32 v81, v70, v71
    v_mfma_f32_32x32x16_bf16 v[84:99], v[36:39], v[76:79], v[84:99]
    v_exp_f32 v72, v72
    v_exp_f32 v73, v73
    v_exp_f32 v74, v74
    v_exp_f32 v75, v75
    v_cvt_pk_bf16_f32 v82, v72, v73
    v_cvt_pk_bf16_f32 v83, v74, v75
    ds_read_b128 v[20:23], v7 offset:4096
    v_exp_f32 v44, v44
    v_exp_f32 v45, v45
    v_exp_f32 v46, v46
    v_exp_f32 v47, v47
    v_cvt_pk_bf16_f32 v76, v44, v45
    v_cvt_pk_bf16_f32 v77, v46, v47
    v_mfma_f32_32x32x16_bf16 v[84:99], v[40:43], v[80:83], v[84:99]
    ds_read_b128 v[36:39], v8 offset:1024
    ds_read_b128 v[40:43], v8 offset:1536
    v_exp_f32 v48, v48
    v_exp_f32 v49, v49
    v_exp_f32 v50, v50
    v_exp_f32 v51, v51
    v_cvt_pk_bf16_f32 v78, v48, v49
    v_cvt_pk_bf16_f32 v79, v50, v51
    s_waitcnt lgkmcnt(3)
    v_mfma_f32_32x32x16_bf16 v[60:75], v[24:27], v[16:19], v[100:115]
    v_exp_f32 v52, v52
    v_exp_f32 v53, v53
    v_exp_f32 v54, v54
    v_exp_f32 v55, v55
    v_cvt_pk_bf16_f32 v80, v52, v53
    v_cvt_pk_bf16_f32 v81, v54, v55
    v_mfma_f32_32x32x16_bf16 v[84:99], v[28:31], v[76:79], v[84:99]
    v_exp_f32 v56, v56
    v_exp_f32 v57, v57
    v_exp_f32 v58, v58
    v_exp_f32 v59, v59
    v_cvt_pk_bf16_f32 v82, v56, v57
    v_cvt_pk_bf16_f32 v83, v58, v59
    v_add_u32 v8, v9, v8
    ds_read_b128 v[24:27], v7 offset:5120
    v_exp_f32 v60, v60
    v_exp_f32 v61, v61
    v_exp_f32 v62, v62
    v_exp_f32 v63, v63
    v_cvt_pk_bf16_f32 v76, v60, v61
    v_cvt_pk_bf16_f32 v77, v62, v63
    v_mfma_f32_32x32x16_bf16 v[84:99], v[32:35], v[80:83], v[84:99]
    ds_read_b128 v[28:31], v8 offset:0
    ds_read_b128 v[32:35], v8 offset:512
    v_add_u32 v7, 4096, v7
    s_add_u32 s36, s36, 2
    v_exp_f32 v64, v64
    v_exp_f32 v65, v65
    v_exp_f32 v66, v66
    v_exp_f32 v67, v67
    v_cvt_pk_bf16_f32 v78, v64, v65
    v_cvt_pk_bf16_f32 v79, v66, v67
    s_waitcnt lgkmcnt(3)
    v_mfma_f32_32x32x16_bf16 v[44:59], v[20:23], v[16:19], v[100:115]
    v_exp_f32 v68, v68
    v_exp_f32 v69, v69
    v_exp_f32 v70, v70
    v_exp_f32 v71, v71
    v_cvt_pk_bf16_f32 v80, v68, v69
    v_cvt_pk_bf16_f32 v81, v70, v71
    v_mfma_f32_32x32x16_bf16 v[84:99], v[36:39], v[76:79], v[84:99]
    v_exp_f32 v72, v72
    v_exp_f32 v73, v73
    v_exp_f32 v74, v74
    v_exp_f32 v75, v75
    v_cvt_pk_bf16_f32 v82, v72, v73
    v_cvt_pk_bf16_f32 v83, v74, v75
    s_cmp_lt_u32 s36, s37
    s_cbranch_scc1 attn_kernel_lp7
    s_cmp_ge_u32 s36, 32
    s_cbranch_scc1 attn_kernel_sb8
    s_cmp_ge_u32 s36, 26
    s_cbranch_scc1 attn_kernel_md9
    s_barrier
    s_cmp_ge_u32 s36, 10
    s_cbranch_scc1 attn_kernel_b210
    s_mov_b32 s37, 10
    s_branch attn_kernel_lp7
attn_kernel_b210:
    s_mov_b32 s37, 26
    s_branch attn_kernel_lp7
attn_kernel_md9:
    s_setprio 0
    s_mov_b32 s37, 32
    s_branch attn_kernel_lp7
attn_kernel_sb8:
    s_nop 1
    v_mfma_f32_32x32x16_bf16 v[84:99], v[40:43], v[80:83], v[84:99]
    s_waitcnt lgkmcnt(0)
    s_nop 15
    v_mov_b32 v2, 0x2b800000
    v_mov_b32 v3, 0x53800000
    v_cmp_ge_f32 vcc, v92, v2
    v_cmp_le_f32 s[22:23], v92, v3
    s_nop 1
    s_and_b64 vcc, vcc, s[22:23]
    s_cmp_eq_u64 vcc, -1
    s_cbranch_scc1 attn_kernel_fin
    v_mov_b32 v2, 0xff800000
    v_mov_b32 v4, v10
    s_mov_b32 s25, 0
attn_kernel_mx11:
    ds_read_b128 v[20:23], v4
    v_add_u32 v4, 1024, v4
    s_waitcnt lgkmcnt(0)
    v_mfma_f32_32x32x16_bf16 v[44:59], v[20:23], v[16:19], 0
    s_nop 15
    s_nop 3
    v_max3_f32 v2, v44, v45, v2
    v_max3_f32 v2, v46, v47, v2
    v_max3_f32 v2, v48, v49, v2
    v_max3_f32 v2, v50, v51, v2
    v_max3_f32 v2, v52, v53, v2
    v_max3_f32 v2, v54, v55, v2
    v_max3_f32 v2, v56, v57, v2
    v_max3_f32 v2, v58, v59, v2
    s_add_u32 s25, s25, 1
    s_cmp_lt_u32 s25, 64
    s_cbranch_scc1 attn_kernel_mx11
    v_mov_b32 v4, v2
    s_nop 1
    v_permlane32_swap_b32 v2, v4
    v_max_f32 v4, v2, v4
    v_sub_f32 v4, 0, v4
    v_mov_b32 v100, v4
    v_mov_b32 v101, v4
    v_mov_b32 v102, v4
    v_mov_b32 v103, v4
    v_mov_b32 v104, v4
    v_mov_b32 v105, v4
    v_mov_b32 v106, v4
    v_mov_b32 v107, v4
    v_mov_b32 v108, v4
    v_mov_b32 v109, v4
    v_mov_b32 v110, v4
    v_mov_b32 v111, v4
    v_mov_b32 v112, v4
    v_mov_b32 v113, v4
    v_mov_b32 v114, v4
    v_mov_b32 v115, v4
    v_mov_b32 v84, 0
    v_mov_b32 v85, 0
    v_mov_b32 v86, 0
    v_mov_b32 v87, 0
    v_mov_b32 v88, 0
    v_mov_b32 v89, 0
    v_mov_b32 v90, 0
    v_mov_b32 v91, 0
    v_mov_b32 v92, 0
    v_mov_b32 v93, 0
    v_mov_b32 v94, 0
    v_mov_b32 v95, 0
    v_mov_b32 v96, 0
    v_mov_b32 v97, 0
    v_mov_b32 v98, 0
    v_mov_b32 v99, 0
    v_mov_b32 v80, 0
    v_mov_b32 v81, 0
    v_mov_b32 v82, 0
    v_mov_b32 v83, 0
    v_mov_b32 v7, v10
    v_mov_b32 v8, v11
    ds_read_b128 v[20:23], v7 offset:0
    ds_read_b128 v[24:27], v7 offset:1024
    ds_read_b128 v[28:31], v8 offset:0
    ds_read_b128 v[32:35], v8 offset:512
    ds_read_b128 v[36:39], v8 offset:0
    ds_read_b128 v[40:43], v8 offset:512
    s_waitcnt lgkmcnt(5)
    v_mfma_f32_32x32x16_bf16 v[44:59], v[20:23], v[16:19], v[100:115]
    s_mov_b32 s36, 0
    s_waitcnt lgkmcnt(0)
    s_nop 9
    s_mov_b32 s37, 32
attn_kernel_lp12:
    ds_read_b128 v[20:23], v7 offset:2048
    v_exp_f32 v44, v44
    v_exp_f32 v45, v45
    v_exp_f32 v46, v46
    v_exp_f32 v47, v47
    v_cvt_pk_bf16_f32 v76, v44, v45
    v_cvt_pk_bf16_f32 v77, v46, v47
    v_mfma_f32_32x32x16_bf16 v[84:99], v[40:43], v[80:83], v[84:99]
    ds_read_b128 v[36:39], v8 offset:1024
    ds_read_b128 v[40:43], v8 offset:1536
    v_exp_f32 v48, v48
    v_exp_f32 v49, v49
    v_exp_f32 v50, v50
    v_exp_f32 v51, v51
    v_cvt_pk_bf16_f32 v78, v48, v49
    v_cvt_pk_bf16_f32 v79, v50, v51
    s_waitcnt lgkmcnt(3)
    v_mfma_f32_32x32x16_bf16 v[60:75], v[24:27], v[16:19], v[100:115]
    v_exp_f32 v52, v52
    v_exp_f32 v53, v53
    v_exp_f32 v54, v54
    v_exp_f32 v55, v55
    v_cvt_pk_bf16_f32 v80, v52, v53
    v_cvt_pk_bf16_f32 v81, v54, v55
    v_mfma_f32_32x32x16_bf16 v[84:99], v[28:31], v[76:79], v[84:99]
    v_exp_f32 v56, v56
    v_exp_f32 v57, v57
    v_exp_f32 v58, v58
    v_exp_f32 v59, v59
    v_cvt_pk_bf16_f32 v82, v56, v57
    v_cvt_pk_bf16_f32 v83, v58, v59
    v_add_u32 v8, v9, v8
    ds_read_b128 v[24:27], v7 offset:3072
    v_exp_f32 v60, v60
    v_exp_f32 v61, v61
    v_exp_f32 v62, v62
    v_exp_f32 v63, v63
    v_cvt_pk_bf16_f32 v76, v60, v61
    v_cvt_pk_bf16_f32 v77, v62, v63
    v_mfma_f32_32x32x16_bf16 v[84:99], v[32:35], v[80:83], v[84:99]
    ds_read_b128 v[28:31], v8 offset:0
    ds_read_b128 v[32:35], v8 offset:512
    v_exp_f32 v64, v64
    v_exp_f32 v65, v65
    v_exp_f32 v66, v66
    v_exp_f32 v67, v67
    v_cvt_pk_bf16_f32 v78, v64, v65
    v_cvt_pk_bf16_f32 v79, v66, v67
    s_waitcnt lgkmcnt(3)
    v_mfma_f32_32x32x16_bf16 v[44:59], v[20:23], v[16:19], v[100:115]
    v_exp_f32 v68, v68
    v_exp_f32 v69, v69
    v_exp_f32 v70, v70
    v_exp_f32 v71, v71
    v_cvt_pk_bf16_f32 v80, v68, v69
    v_cvt_pk_bf16_f32 v81, v70, v71
    v_mfma_f32_32x32x16_bf16 v[84:99], v[36:39], v[76:79], v[84:99]
    v_exp_f32 v72, v72
    v_exp_f32 v73, v73
    v_exp_f32 v74, v74
    v_exp_f32 v75, v75
    v_cvt_pk_bf16_f32 v82, v72, v73
    v_cvt_pk_bf16_f32 v83, v74, v75
    ds_read_b128 v[20:23], v7 offset:4096
    v_exp_f32 v44, v44
    v_exp_f32 v45, v45
    v_exp_f32 v46, v46
    v_exp_f32 v47, v47
    v_cvt_pk_bf16_f32 v76, v44, v45
    v_cvt_pk_bf16_f32 v77, v46, v47
    v_mfma_f32_32x32x16_bf16 v[84:99], v[40:43], v[80:83], v[84:99]
    ds_read_b128 v[36:39], v8 offset:1024
    ds_read_b128 v[40:43], v8 offset:1536
    v_exp_f32 v48, v48
    v_exp_f32 v49, v49
    v_exp_f32 v50, v50
    v_exp_f32 v51, v51
    v_cvt_pk_bf16_f32 v78, v48, v49
    v_cvt_pk_bf16_f32 v79, v50, v51
    s_waitcnt lgkmcnt(3)
    v_mfma_f32_32x32x16_bf16 v[60:75], v[24:27], v[16:19], v[100:115]
    v_exp_f32 v52, v52
    v_exp_f32 v53, v53
    v_exp_f32 v54, v54
    v_exp_f32 v55, v55
    v_cvt_pk_bf16_f32 v80, v52, v53
    v_cvt_pk_bf16_f32 v81, v54, v55
    v_mfma_f32_32x32x16_bf16 v[84:99], v[28:31], v[76:79], v[84:99]
    v_exp_f32 v56, v56
    v_exp_f32 v57, v57
    v_exp_f32 v58, v58
    v_exp_f32 v59, v59
    v_cvt_pk_bf16_f32 v82, v56, v57
    v_cvt_pk_bf16_f32 v83, v58, v59
    v_add_u32 v8, v9, v8
    ds_read_b128 v[24:27], v7 offset:5120
    v_exp_f32 v60, v60
    v_exp_f32 v61, v61
    v_exp_f32 v62, v62
    v_exp_f32 v63, v63
    v_cvt_pk_bf16_f32 v76, v60, v61
    v_cvt_pk_bf16_f32 v77, v62, v63
    v_mfma_f32_32x32x16_bf16 v[84:99], v[32:35], v[80:83], v[84:99]
    ds_read_b128 v[28:31], v8 offset:0
    ds_read_b128 v[32:35], v8 offset:512
    v_add_u32 v7, 4096, v7
    s_add_u32 s36, s36, 2
    v_exp_f32 v64, v64
    v_exp_f32 v65, v65
    v_exp_f32 v66, v66
    v_exp_f32 v67, v67
    v_cvt_pk_bf16_f32 v78, v64, v65
    v_cvt_pk_bf16_f32 v79, v66, v67
    s_waitcnt lgkmcnt(3)
    v_mfma_f32_32x32x16_bf16 v[44:59], v[20:23], v[16:19], v[100:115]
    v_exp_f32 v68, v68
    v_exp_f32 v69, v69
    v_exp_f32 v70, v70
    v_exp_f32 v71, v71
    v_cvt_pk_bf16_f32 v80, v68, v69
    v_cvt_pk_bf16_f32 v81, v70, v71
    v_mfma_f32_32x32x16_bf16 v[84:99], v[36:39], v[76:79], v[84:99]
    v_exp_f32 v72, v72
    v_exp_f32 v73, v73
    v_exp_f32 v74, v74
    v_exp_f32 v75, v75
    v_cvt_pk_bf16_f32 v82, v72, v73
    v_cvt_pk_bf16_f32 v83, v74, v75
    s_cmp_lt_u32 s36, s37
    s_cbranch_scc1 attn_kernel_lp12
    s_nop 1
    v_mfma_f32_32x32x16_bf16 v[84:99], v[40:43], v[80:83], v[84:99]
    s_waitcnt lgkmcnt(0)
    s_nop 15
attn_kernel_fin:
    v_rcp_f32 v2, v92
    s_nop 0
    v_mul_f32 v84, v84, v2
    v_mul_f32 v85, v85, v2
    v_mul_f32 v86, v86, v2
    v_mul_f32 v87, v87, v2
    v_mul_f32 v88, v88, v2
    v_mul_f32 v89, v89, v2
    v_mul_f32 v90, v90, v2
    v_mul_f32 v91, v91, v2
    v_cvt_pk_bf16_f32 v116, v84, v85
    v_cvt_pk_bf16_f32 v117, v86, v87
    v_cvt_pk_bf16_f32 v118, v88, v89
    v_cvt_pk_bf16_f32 v119, v90, v91
    s_nop 1
    v_permlane32_swap_b32 v116, v118
    v_permlane32_swap_b32 v117, v119
    buffer_store_dwordx4 v[116:119], v12, s[4:7], 0 offen
attn_kernel_end:
    s_endpgm
.section .rodata,"a"
.p2align 6
.amdhsa_kernel attn_kernel
  .amdhsa_next_free_vgpr 128
  .amdhsa_next_free_sgpr 96
  .amdhsa_accum_offset 128
  .amdhsa_group_segment_fixed_size 0
  .amdhsa_kernarg_size 80
  .amdhsa_user_sgpr_count 2
  .amdhsa_user_sgpr_kernarg_segment_ptr 1
  .amdhsa_system_sgpr_workgroup_id_x 1
.end_amdhsa_kernel
.text
.globl wo1_kernel
.p2align 8
.type wo1_kernel,@function
wo1_kernel:
    s_cmp_ge_u32 s2, 256
    s_cbranch_scc1 wo1_kernel_end
    s_load_dwordx2 s[28:29], s[0:1], 72
    s_load_dwordx2 s[30:31], s[0:1], 16
    s_load_dwordx2 s[32:33], s[0:1], 0
    s_load_dwordx2 s[34:35], s[0:1], 56
    v_and_b32 v1, 63, v0
    v_lshrrev_b32 v2, 6, v0
    s_and_b32 s20, s2, 7
    v_readfirstlane_b32 s44, v2
    s_lshl_b32 s20, s20, 2
    s_bfe_u32 s22, s2, 0x20003
    s_add_u32 s20, s20, s22
    s_lshr_b32 s21, s2, 5
    s_and_b32 s3, s44, 3
    s_cmp_lt_u32 s44, 4
    s_cbranch_scc1 wo1_kernel_comp
    s_lshl_b32 s22, s20, 1
    s_lshr_b32 s23, s3, 1
    s_add_u32 s22, s22, s23
    s_mul_i32 s22, s22, 32768
    s_and_b32 s23, s3, 1
    s_lshl_b32 s23, s23, 11
    s_add_u32 s22, s22, s23
    v_lshlrev_b32 v6, 4, v1
    v_add_u32 v6, s22, v6
    v_add_u32 v7, 1024, v6
    s_lshl_b32 s26, s3, 11
    s_waitcnt lgkmcnt(0)
    s_add_u32 s4, s28, 0x600000
    s_addc_u32 s5, s29, 0
    s_and_b32 s5, s5, 0xffff
    s_mov_b32 s6, 0x200000
    s_mov_b32 s7, 0x00020000
    s_add_u32 s8, s28, 0x1800000
    s_addc_u32 s9, s29, 0
    s_and_b32 s9, s9, 0xffff
    s_mov_b32 s10, 0x80000
    s_mov_b32 s11, 0x00020000
    s_mul_i32 s23, s21, 65536
    s_add_u32 s23, s23, s26
    v_lshlrev_b32 v8, 4, v1
    v_add_u32 v8, s23, v8
    v_add_u32 v9, 1024, v8
    s_mov_b32 s24, 0
    s_mov_b32 s25, 0
    s_add_u32 m0, s26, 0
    s_nop 0
    buffer_load_dwordx4 v6, s[4:7], s24 offen lds
    s_add_u32 m0, s26, 1024
    s_nop 0
    buffer_load_dwordx4 v7, s[4:7], s24 offen lds
    s_add_u32 m0, s26, 8192
    s_nop 0
    buffer_load_dwordx4 v8, s[8:11], s25 offen lds
    s_add_u32 m0, s26, 9216
    s_nop 0
    buffer_load_dwordx4 v9, s[8:11], s25 offen lds
    s_mov_b32 s24, 4096
    s_mov_b32 s25, 8192
    s_add_u32 m0, s26, 16384
    s_nop 0
    buffer_load_dwordx4 v6, s[4:7], s24 offen lds
    s_add_u32 m0, s26, 17408
    s_nop 0
    buffer_load_dwordx4 v7, s[4:7], s24 offen lds
    s_add_u32 m0, s26, 24576
    s_nop 0
    buffer_load_dwordx4 v8, s[8:11], s25 offen lds
    s_add_u32 m0, s26, 25600
    s_nop 0
    buffer_load_dwordx4 v9, s[8:11], s25 offen lds
    s_mov_b32 s24, 8192
    s_mov_b32 s25, 16384
    s_add_u32 m0, s26, 32768
    s_nop 0
    buffer_load_dwordx4 v6, s[4:7], s24 offen lds
    s_add_u32 m0, s26, 33792
    s_nop 0
    buffer_load_dwordx4 v7, s[4:7], s24 offen lds
    s_add_u32 m0, s26, 40960
    s_nop 0
    buffer_load_dwordx4 v8, s[8:11], s25 offen lds
    s_add_u32 m0, s26, 41984
    s_nop 0
    buffer_load_dwordx4 v9, s[8:11], s25 offen lds
    s_mov_b32 s24, 12288
    s_mov_b32 s25, 24576
    s_add_u32 m0, s26, 49152
    s_nop 0
    buffer_load_dwordx4 v6, s[4:7], s24 offen lds
    s_add_u32 m0, s26, 50176
    s_nop 0
    buffer_load_dwordx4 v7, s[4:7], s24 offen lds
    s_add_u32 m0, s26, 57344
    s_nop 0
    buffer_load_dwordx4 v8, s[8:11], s25 offen lds
    s_add_u32 m0, s26, 58368
    s_nop 0
    buffer_load_dwordx4 v9, s[8:11], s25 offen lds
    s_mov_b32 s24, 16384
    s_mov_b32 s25, 32768
    s_add_u32 m0, s26, 65536
    s_nop 0
    buffer_load_dwordx4 v6, s[4:7], s24 offen lds
    s_add_u32 m0, s26, 66560
    s_nop 0
    buffer_load_dwordx4 v7, s[4:7], s24 offen lds
    s_add_u32 m0, s26, 73728
    s_nop 0
    buffer_load_dwordx4 v8, s[8:11], s25 offen lds
    s_add_u32 m0, s26, 74752
    s_nop 0
    buffer_load_dwordx4 v9, s[8:11], s25 offen lds
    s_mov_b32 s24, 20480
    s_mov_b32 s25, 40960
    s_add_u32 m0, s26, 81920
    s_nop 0
    buffer_load_dwordx4 v6, s[4:7], s24 offen lds
    s_add_u32 m0, s26, 82944
    s_nop 0
    buffer_load_dwordx4 v7, s[4:7], s24 offen lds
    s_add_u32 m0, s26, 90112
    s_nop 0
    buffer_load_dwordx4 v8, s[8:11], s25 offen lds
    s_add_u32 m0, s26, 91136
    s_nop 0
    buffer_load_dwordx4 v9, s[8:11], s25 offen lds
    s_waitcnt vmcnt(20)
    s_barrier
    s_mov_b32 s24, 24576
    s_mov_b32 s25, 49152
    s_add_u32 m0, s26, 98304
    s_nop 0
    buffer_load_dwordx4 v6, s[4:7], s24 offen lds
    s_add_u32 m0, s26, 99328
    s_nop 0
    buffer_load_dwordx4 v7, s[4:7], s24 offen lds
    s_add_u32 m0, s26, 106496
    s_nop 0
    buffer_load_dwordx4 v8, s[8:11], s25 offen lds
    s_add_u32 m0, s26, 107520
    s_nop 0
    buffer_load_dwordx4 v9, s[8:11], s25 offen lds
    s_waitcnt vmcnt(20)
    s_barrier
    s_mov_b32 s24, 28672
    s_mov_b32 s25, 57344
    s_add_u32 m0, s26, 114688
    s_nop 0
    buffer_load_dwordx4 v6, s[4:7], s24 offen lds
    s_add_u32 m0, s26, 115712
    s_nop 0
    buffer_load_dwordx4 v7, s[4:7], s24 offen lds
    s_add_u32 m0, s26, 122880
    s_nop 0
    buffer_load_dwordx4 v8, s[8:11], s25 offen lds
    s_add_u32 m0, s26, 123904
    s_nop 0
    buffer_load_dwordx4 v9, s[8:11], s25 offen lds
    s_waitcnt vmcnt(20)
    s_barrier
    s_waitcnt vmcnt(16)
    s_barrier
    s_waitcnt vmcnt(12)
    s_barrier
    s_waitcnt vmcnt(8)
    s_barrier
    s_waitcnt vmcnt(4)
    s_barrier
    s_waitcnt vmcnt(0)
    s_barrier
    s_endpgm
wo1_kernel_comp:
    s_lshl_b32 s22, s20, 1
    s_and_b32 s23, s3, 1
    s_add_u32 s22, s22, s23
    s_lshl_b32 s23, s21, 1
    s_lshr_b32 s25, s3, 1
    s_add_u32 s23, s23, s25
    s_lshl_b32 s24, s22, 15
    s_lshl_b32 s25, s23, 6
    s_add_u32 s25, s24, s25
    v_and_b32 v4, 31, v1
    v_lshlrev_b32 v4, 10, v4
    v_lshrrev_b32 v2, 5, v1
    v_lshl_add_u32 v4, v2, 4, v4
    v_add_u32 v4, s25, v4
    s_lshl_b32 s25, s23, 11
    s_add_u32 s25, s24, s25
    v_lshlrev_b32 v5, 4, v1
    v_add_u32 v5, s25, v5
    v_mov_b32 v88, v5
    v_mov_b32 v89, v4
    s_lshl_b32 s27, s22, 12
    s_lshl_b32 s23, s23, 3
    s_add_u32 s27, s27, s23
    s_add_u32 s27, s27, 14680064
    s_and_b32 s22, s3, 1
    s_lshl_b32 s22, s22, 12
    v_lshlrev_b32 v10, 4, v1
    v_add_u32 v10, s22, v10
    v_add_u32 v11, 1024, v10
    v_add_u32 v12, 2048, v10
    v_add_u32 v13, 3072, v10
    v_add_u32 v14, 65536, v10
    v_add_u32 v15, 65536, v11
    v_add_u32 v16, 65536, v12
    v_add_u32 v17, 65536, v13
    s_lshr_b32 s22, s3, 1
    v_bfe_u32 v2, v1, 2, 2
    v_lshrrev_b32 v3, 5, v1
    v_lshl_add_u32 v3, v3, 3, v2
    v_lshlrev_b32 v3, 7, v3
    v_lshrrev_b32 v4, 1, v2
    v_xor_b32 v4, s22, v4
    v_lshl_add_u32 v3, v4, 6, v3
    v_bfe_u32 v4, v1, 4, 1
    v_lshl_add_u32 v3, v4, 5, v3
    v_and_b32 v4, 3, v1
    v_lshl_add_u32 v3, v4, 3, v3
    v_add_u32 v18, 8192, v3
    v_add_u32 v19, 65536, v18
    v_mov_b32 v20, 0x3f803f80
    v_mov_b32 v56, 0
    v_mov_b32 v57, 0
    v_mov_b32 v58, 0
    v_mov_b32 v59, 0
    v_mov_b32 v60, 0
    v_mov_b32 v61, 0
    v_mov_b32 v62, 0
    v_mov_b32 v63, 0
    v_mov_b32 v64, 0
    v_mov_b32 v65, 0
    v_mov_b32 v66, 0
    v_mov_b32 v67, 0
    v_mov_b32 v68, 0
    v_mov_b32 v69, 0
    v_mov_b32 v70, 0
    v_mov_b32 v71, 0
    s_waitcnt lgkmcnt(0)
    s_mov_b32 s16, s32
    s_mov_b32 s17, s33
    s_and_b32 s17, s17, 0xffff
    s_mov_b32 s18, 0x200000
    s_mov_b32 s19, 0x00020000
    buffer_load_dwordx4 v[72:75], v89, s[16:19], 0 offen offset:0
    buffer_load_dwordx4 v[76:79], v89, s[16:19], 0 offen offset:32
    s_add_u32 s12, s28, 0x800000
    s_addc_u32 s13, s29, 0
    s_and_b32 s13, s13, 0xffff
    s_mov_b32 s14, 0x200000
    s_mov_b32 s15, 0x00020000
    s_mov_b32 s40, s28
    s_mov_b32 s41, s29
    s_and_b32 s41, s41, 0xffff
    s_mov_b32 s42, 0x10000000
    s_mov_b32 s43, 0x00020000
    s_barrier
    ds_read_b128 v[24:27], v10 offset:0
    ds_read_b64_tr_b16 v[40:41], v18 offset:0
    ds_read_b64_tr_b16 v[42:43], v18 offset:512
    ds_read_b128 v[28:31], v11 offset:0
    ds_read_b64_tr_b16 v[44:45], v18 offset:2048
    ds_read_b64_tr_b16 v[46:47], v18 offset:2560
    s_waitcnt lgkmcnt(3)
    v_mfma_f32_32x32x16_bf16 v[56:71], v[40:43], v[24:27], v[56:71]
    ds_read_b128 v[32:35], v12 offset:0
    ds_read_b64_tr_b16 v[48:49], v18 offset:4096
    ds_read_b64_tr_b16 v[50:51], v18 offset:4608
    s_waitcnt lgkmcnt(3)
    v_mfma_f32_32x32x16_bf16 v[56:71], v[44:47], v[28:31], v[56:71]
    ds_read_b128 v[36:39], v13 offset:0
    ds_read_b64_tr_b16 v[52:53], v18 offset:6144
    ds_read_b64_tr_b16 v[54:55], v18 offset:6656
    s_waitcnt lgkmcnt(3)
    s_barrier
    v_mfma_f32_32x32x16_bf16 v[56:71], v[48:51], v[32:35], v[56:71]
    ds_read_b128 v[24:27], v10 offset:16384
    ds_read_b64_tr_b16 v[40:41], v18 offset:16384
    ds_read_b64_tr_b16 v[42:43], v18 offset:16896
    s_waitcnt lgkmcnt(3)
    v_mfma_f32_32x32x16_bf16 v[56:71], v[52:55], v[36:39], v[56:71]
    ds_read_b128 v[28:31], v11 offset:16384
    ds_read_b64_tr_b16 v[44:45], v18 offset:18432
    ds_read_b64_tr_b16 v[46:47], v18 offset:18944
    s_waitcnt lgkmcnt(3)
    v_mfma_f32_32x32x16_bf16 v[56:71], v[40:43], v[24:27], v[56:71]
    ds_read_b128 v[32:35], v12 offset:16384
    ds_read_b64_tr_b16 v[48:49], v18 offset:20480
    ds_read_b64_tr_b16 v[50:51], v18 offset:20992
    s_waitcnt lgkmcnt(3)
    v_mfma_f32_32x32x16_bf16 v[56:71], v[44:47], v[28:31], v[56:71]
    ds_read_b128 v[36:39], v13 offset:16384
    ds_read_b64_tr_b16 v[52:53], v18 offset:22528
    ds_read_b64_tr_b16 v[54:55], v18 offset:23040
    s_waitcnt lgkmcnt(3)
    s_barrier
    v_mfma_f32_32x32x16_bf16 v[56:71], v[48:51], v[32:35], v[56:71]
    ds_read_b128 v[24:27], v10 offset:32768
    ds_read_b64_tr_b16 v[40:41], v18 offset:32768
    ds_read_b64_tr_b16 v[42:43], v18 offset:33280
    s_waitcnt lgkmcnt(3)
    v_mfma_f32_32x32x16_bf16 v[56:71], v[52:55], v[36:39], v[56:71]
    ds_read_b128 v[28:31], v11 offset:32768
    ds_read_b64_tr_b16 v[44:45], v18 offset:34816
    ds_read_b64_tr_b16 v[46:47], v18 offset:35328
    s_waitcnt lgkmcnt(3)
    v_mfma_f32_32x32x16_bf16 v[56:71], v[40:43], v[24:27], v[56:71]
    ds_read_b128 v[32:35], v12 offset:32768
    ds_read_b64_tr_b16 v[48:49], v18 offset:36864
    ds_read_b64_tr_b16 v[50:51], v18 offset:37376
    s_waitcnt lgkmcnt(3)
    v_mfma_f32_32x32x16_bf16 v[56:71], v[44:47], v[28:31], v[56:71]
    ds_read_b128 v[36:39], v13 offset:32768
    ds_read_b64_tr_b16 v[52:53], v18 offset:38912
    ds_read_b64_tr_b16 v[54:55], v18 offset:39424
    s_waitcnt lgkmcnt(3)
    s_barrier
    v_mfma_f32_32x32x16_bf16 v[56:71], v[48:51], v[32:35], v[56:71]
    ds_read_b128 v[24:27], v10 offset:49152
    ds_read_b64_tr_b16 v[40:41], v18 offset:49152
    ds_read_b64_tr_b16 v[42:43], v18 offset:49664
    s_waitcnt lgkmcnt(3)
    v_mfma_f32_32x32x16_bf16 v[56:71], v[52:55], v[36:39], v[56:71]
    ds_read_b128 v[28:31], v11 offset:49152
    ds_read_b64_tr_b16 v[44:45], v18 offset:51200
    ds_read_b64_tr_b16 v[46:47], v18 offset:51712
    s_waitcnt lgkmcnt(3)
    v_mfma_f32_32x32x16_bf16 v[56:71], v[40:43], v[24:27], v[56:71]
    ds_read_b128 v[32:35], v12 offset:49152
    ds_read_b64_tr_b16 v[48:49], v18 offset:53248
    ds_read_b64_tr_b16 v[50:51], v18 offset:53760
    s_waitcnt lgkmcnt(3)
    v_mfma_f32_32x32x16_bf16 v[56:71], v[44:47], v[28:31], v[56:71]
    ds_read_b128 v[36:39], v13 offset:49152
    ds_read_b64_tr_b16 v[52:53], v18 offset:55296
    ds_read_b64_tr_b16 v[54:55], v18 offset:55808
    s_waitcnt lgkmcnt(3)
    s_barrier
    v_mfma_f32_32x32x16_bf16 v[56:71], v[48:51], v[32:35], v[56:71]
    ds_read_b128 v[24:27], v14 offset:0
    ds_read_b64_tr_b16 v[40:41], v19 offset:0
    ds_read_b64_tr_b16 v[42:43], v19 offset:512
    s_waitcnt lgkmcnt(3)
    v_mfma_f32_32x32x16_bf16 v[56:71], v[52:55], v[36:39], v[56:71]
    ds_read_b128 v[28:31], v15 offset:0
    ds_read_b64_tr_b16 v[44:45], v19 offset:2048
    ds_read_b64_tr_b16 v[46:47], v19 offset:2560
    s_waitcnt lgkmcnt(3)
    v_mfma_f32_32x32x16_bf16 v[56:71], v[40:43], v[24:27], v[56:71]
    ds_read_b128 v[32:35], v16 offset:0
    ds_read_b64_tr_b16 v[48:49], v19 offset:4096
    ds_read_b64_tr_b16 v[50:51], v19 offset:4608
    s_waitcnt lgkmcnt(3)
    v_mfma_f32_32x32x16_bf16 v[56:71], v[44:47], v[28:31], v[56:71]
    ds_read_b128 v[36:39], v17 offset:0
    ds_read_b64_tr_b16 v[52:53], v19 offset:6144
    ds_read_b64_tr_b16 v[54:55], v19 offset:6656
    s_waitcnt lgkmcnt(3)
    s_barrier
    v_mfma_f32_32x32x16_bf16 v[56:71], v[48:51], v[32:35], v[56:71]
    ds_read_b128 v[24:27], v14 offset:16384
    ds_read_b64_tr_b16 v[40:41], v19 offset:16384
    ds_read_b64_tr_b16 v[42:43], v19 offset:16896
    s_waitcnt lgkmcnt(3)
    v_mfma_f32_32x32x16_bf16 v[56:71], v[52:55], v[36:39], v[56:71]
    ds_read_b128 v[28:31], v15 offset:16384
    ds_read_b64_tr_b16 v[44:45], v19 offset:18432
    ds_read_b64_tr_b16 v[46:47], v19 offset:18944
    s_waitcnt lgkmcnt(3)
    v_mfma_f32_32x32x16_bf16 v[56:71], v[40:43], v[24:27], v[56:71]
    ds_read_b128 v[32:35], v16 offset:16384
    ds_read_b64_tr_b16 v[48:49], v19 offset:20480
    ds_read_b64_tr_b16 v[50:51], v19 offset:20992
    s_waitcnt lgkmcnt(3)
    v_mfma_f32_32x32x16_bf16 v[56:71], v[44:47], v[28:31], v[56:71]
    ds_read_b128 v[36:39], v17 offset:16384
    ds_read_b64_tr_b16 v[52:53], v19 offset:22528
    ds_read_b64_tr_b16 v[54:55], v19 offset:23040
    s_waitcnt lgkmcnt(3)
    s_barrier
    v_mfma_f32_32x32x16_bf16 v[56:71], v[48:51], v[32:35], v[56:71]
    ds_read_b128 v[24:27], v14 offset:32768
    ds_read_b64_tr_b16 v[40:41], v19 offset:32768
    ds_read_b64_tr_b16 v[42:43], v19 offset:33280
    s_waitcnt lgkmcnt(3)
    v_mfma_f32_32x32x16_bf16 v[56:71], v[52:55], v[36:39], v[56:71]
    ds_read_b128 v[28:31], v15 offset:32768
    ds_read_b64_tr_b16 v[44:45], v19 offset:34816
    ds_read_b64_tr_b16 v[46:47], v19 offset:35328
    s_waitcnt lgkmcnt(3)
    v_mfma_f32_32x32x16_bf16 v[56:71], v[40:43], v[24:27], v[56:71]
    ds_read_b128 v[32:35], v16 offset:32768
    ds_read_b64_tr_b16 v[48:49], v19 offset:36864
    ds_read_b64_tr_b16 v[50:51], v19 offset:37376
    s_waitcnt lgkmcnt(3)
    v_mfma_f32_32x32x16_bf16 v[56:71], v[44:47], v[28:31], v[56:71]
    ds_read_b128 v[36:39], v17 offset:32768
    ds_read_b64_tr_b16 v[52:53], v19 offset:38912
    ds_read_b64_tr_b16 v[54:55], v19 offset:39424
    s_waitcnt lgkmcnt(3)
    s_barrier
    v_mfma_f32_32x32x16_bf16 v[56:71], v[48:51], v[32:35], v[56:71]
    ds_read_b128 v[24:27], v14 offset:49152
    ds_read_b64_tr_b16 v[40:41], v19 offset:49152
    ds_read_b64_tr_b16 v[42:43], v19 offset:49664
    s_waitcnt lgkmcnt(3)
    v_mfma_f32_32x32x16_bf16 v[56:71], v[52:55], v[36:39], v[56:71]
    ds_read_b128 v[28:31], v15 offset:49152
    ds_read_b64_tr_b16 v[44:45], v19 offset:51200
    ds_read_b64_tr_b16 v[46:47], v19 offset:51712
    s_waitcnt lgkmcnt(3)
    v_mfma_f32_32x32x16_bf16 v[56:71], v[40:43], v[24:27], v[56:71]
    ds_read_b128 v[32:35], v16 offset:49152
    ds_read_b64_tr_b16 v[48:49], v19 offset:53248
    ds_read_b64_tr_b16 v[50:51], v19 offset:53760
    s_waitcnt lgkmcnt(3)
    v_mfma_f32_32x32x16_bf16 v[56:71], v[44:47], v[28:31], v[56:71]
    ds_read_b128 v[36:39], v17 offset:49152
    ds_read_b64_tr_b16 v[52:53], v19 offset:55296
    ds_read_b64_tr_b16 v[54:55], v19 offset:55808
    s_waitcnt lgkmcnt(3)
    v_mfma_f32_32x32x16_bf16 v[56:71], v[48:51], v[32:35], v[56:71]
    s_waitcnt lgkmcnt(0)
    v_mfma_f32_32x32x16_bf16 v[56:71], v[52:55], v[36:39], v[56:71]
    s_waitcnt vmcnt(0)
    s_nop 15
    v_cvt_pk_bf16_f32 v80, v56, v57
    v_cvt_pk_bf16_f32 v81, v58, v59
    v_cvt_pk_bf16_f32 v82, v60, v61
    v_cvt_pk_bf16_f32 v83, v62, v63
    v_cvt_pk_bf16_f32 v84, v64, v65
    v_cvt_pk_bf16_f32 v85, v66, v67
    v_cvt_pk_bf16_f32 v86, v68, v69
    v_cvt_pk_bf16_f32 v87, v70, v71
    s_nop 0
    v_permlane32_swap_b32 v80, v82
    v_permlane32_swap_b32 v81, v83
    v_permlane32_swap_b32 v84, v86
    v_permlane32_swap_b32 v85, v87
    v_lshlrev_b32 v2, 16, v80
    v_lshlrev_b32 v3, 16, v72
    v_add_f32 v2, v2, v3
    v_and_b32 v4, 0xffff0000, v80
    v_and_b32 v5, 0xffff0000, v72
    v_add_f32 v4, v4, v5
    v_cvt_pk_bf16_f32 v80, v2, v4
    v_lshlrev_b32 v2, 16, v81
    v_lshlrev_b32 v3, 16, v73
    v_add_f32 v2, v2, v3
    v_and_b32 v4, 0xffff0000, v81
    v_and_b32 v5, 0xffff0000, v73
    v_add_f32 v4, v4, v5
    v_cvt_pk_bf16_f32 v81, v2, v4
    v_lshlrev_b32 v2, 16, v82
    v_lshlrev_b32 v3, 16, v74
    v_add_f32 v2, v2, v3
    v_and_b32 v4, 0xffff0000, v82
    v_and_b32 v5, 0xffff0000, v74
    v_add_f32 v4, v4, v5
    v_cvt_pk_bf16_f32 v82, v2, v4
    v_lshlrev_b32 v2, 16, v83
    v_lshlrev_b32 v3, 16, v75
    v_add_f32 v2, v2, v3
    v_and_b32 v4, 0xffff0000, v83
    v_and_b32 v5, 0xffff0000, v75
    v_add_f32 v4, v4, v5
    v_cvt_pk_bf16_f32 v83, v2, v4
    buffer_store_dwordx4 v[80:83], v88, s[12:15], 0 offen offset:0
    v_lshlrev_b32 v2, 16, v84
    v_lshlrev_b32 v3, 16, v76
    v_add_f32 v2, v2, v3
    v_and_b32 v4, 0xffff0000, v84
    v_and_b32 v5, 0xffff0000, v76
    v_add_f32 v4, v4, v5
    v_cvt_pk_bf16_f32 v84, v2, v4
    v_lshlrev_b32 v2, 16, v85
    v_lshlrev_b32 v3, 16, v77
    v_add_f32 v2, v2, v3
    v_and_b32 v4, 0xffff0000, v85
    v_and_b32 v5, 0xffff0000, v77
    v_add_f32 v4, v4, v5
    v_cvt_pk_bf16_f32 v85, v2, v4
    v_lshlrev_b32 v2, 16, v86
    v_lshlrev_b32 v3, 16, v78
    v_add_f32 v2, v2, v3
    v_and_b32 v4, 0xffff0000, v86
    v_and_b32 v5, 0xffff0000, v78
    v_add_f32 v4, v4, v5
    v_cvt_pk_bf16_f32 v86, v2, v4
    v_lshlrev_b32 v2, 16, v87
    v_lshlrev_b32 v3, 16, v79
    v_add_f32 v2, v2, v3
    v_and_b32 v4, 0xffff0000, v87
    v_and_b32 v5, 0xffff0000, v79
    v_add_f32 v4, v4, v5
    v_cvt_pk_bf16_f32 v87, v2, v4
    buffer_store_dwordx4 v[84:87], v88, s[12:15], 0 offen offset:1024
    v_mov_b32 v90, 0
    v_mov_b32 v91, 0
    v_dot2c_f32_bf16 v90, v80, v20
    v_dot2c_f32_bf16 v91, v80, v80
    v_dot2c_f32_bf16 v90, v81, v20
    v_dot2c_f32_bf16 v91, v81, v81
    v_dot2c_f32_bf16 v90, v82, v20
    v_dot2c_f32_bf16 v91, v82, v82
    v_dot2c_f32_bf16 v90, v83, v20
    v_dot2c_f32_bf16 v91, v83, v83
    v_dot2c_f32_bf16 v90, v84, v20
    v_dot2c_f32_bf16 v91, v84, v84
    v_dot2c_f32_bf16 v90, v85, v20
    v_dot2c_f32_bf16 v91, v85, v85
    v_dot2c_f32_bf16 v90, v86, v20
    v_dot2c_f32_bf16 v91, v86, v86
    v_dot2c_f32_bf16 v90, v87, v20
    v_dot2c_f32_bf16 v91, v87, v87
    v_and_b32 v4, 31, v1
    v_lshlrev_b32 v4, 7, v4
    s_nop 1
    v_mov_b32 v2, v90
    s_nop 1
    v_permlane32_swap_b32 v90, v2
    v_add_f32 v90, v90, v2
    v_mov_b32 v2, v91
    s_nop 1
    v_permlane32_swap_b32 v91, v2
    v_add_f32 v91, v91, v2
    s_mov_b32 exec_hi, 0
    buffer_store_dwordx2 v[90:91], v4, s[40:43], s27 offen
    s_mov_b64 exec, -1
wo1_kernel_end:
    s_endpgm
.section .rodata,"a"
.p2align 6
.amdhsa_kernel wo1_kernel
  .amdhsa_next_free_vgpr 96
  .amdhsa_next_free_sgpr 96
  .amdhsa_accum_offset 96
  .amdhsa_group_segment_fixed_size 0
  .amdhsa_kernarg_size 80
  .amdhsa_user_sgpr_count 2
  .amdhsa_user_sgpr_kernarg_segment_ptr 1
  .amdhsa_system_sgpr_workgroup_id_x 1
.end_amdhsa_kernel
.text
.globl ffa1_kernel
.p2align 8
.type ffa1_kernel,@function
ffa1_kernel:
    s_cmp_ge_u32 s2, 224
    s_cbranch_scc1 ffa1_kernel_end
    s_load_dwordx2 s[28:29], s[0:1], 72
    s_load_dwordx2 s[30:31], s[0:1], 32
    s_load_dwordx2 s[32:33], s[0:1], 0
    s_load_dwordx2 s[34:35], s[0:1], 40
    v_and_b32 v1, 63, v0
    v_lshrrev_b32 v2, 6, v0
    s_bfe_u32 s20, s2, 0x20001
    v_readfirstlane_b32 s44, v2
    s_lshl_b32 s20, s20, 2
    s_bfe_u32 s22, s2, 0x20003
    s_add_u32 s20, s20, s22
    s_and_b32 s21, s2, 1
    s_mul_i32 s21, s21, 7
    s_lshr_b32 s22, s2, 5
    s_add_u32 s21, s21, s22
    s_and_b32 s3, s44, 3
    s_lshl_b32 s26, s3, 12
    s_lshl_b32 s22, s20, 7
    s_lshl_b32 s23, s3, 5
    s_add_u32 s22, s22, s23
    s_cmp_lt_u32 s44, 4
    s_cbranch_scc1 ffa1_kernel_comp
    s_lshl_b32 s24, s22, 10
    v_lshlrev_b32 v6, 4, v1
    v_add_u32 v6, s24, v6
    v_add_u32 v7, 1024, v6
    v_add_u32 v8, 2048, v6
    v_add_u32 v9, 3072, v6
    s_lshl_b32 s24, s3, 4
    s_lshl_b32 s23, s21, 8
    v_lshrrev_b32 v2, 4, v1
    v_bfe_u32 v3, v1, 2, 2
    v_xor_b32 v3, v3, v2
    v_lshlrev_b32 v3, 6, v3
    v_and_b32 v4, 3, v1
    v_lshlrev_b32 v4, 4, v4
    v_add3_u32 v3, v3, v4, s23
    v_add_u32 v4, s24, v2
    v_mul_u32_u24 v10, 3584, v4
    v_add_u32 v10, v10, v3
    v_add_u32 v11, 14336, v10
    v_add_u32 v12, 28672, v10
    v_add_u32 v13, 43008, v10
    s_mul_i32 s27, s3, 4096
    s_waitcnt lgkmcnt(0)
    s_add_u32 s4, s28, 0x800000
    s_addc_u32 s5, s29, 0
    s_and_b32 s5, s5, 0xffff
    s_mov_b32 s6, 0x200000
    s_mov_b32 s7, 0x00020000
    s_add_u32 s8, s28, 0x1900000
    s_addc_u32 s9, s29, 0
    s_and_b32 s9, s9, 0xffff
    s_mov_b32 s10, 0x1c0000
    s_mov_b32 s11, 0x00020000
    s_mul_i32 s23, s21, 131072
    s_add_u32 s23, s23, s27
    v_lshlrev_b32 v10, 4, v1
    v_add_u32 v10, s23, v10
    v_add_u32 v11, 1024, v10
    v_add_u32 v12, 2048, v10
    v_add_u32 v13, 3072, v10
    s_mov_b32 s24, 0
    s_add_u32 m0, s26, 0
    s_nop 0
    buffer_load_dwordx4 v6, s[4:7], s24 offen lds
    s_add_u32 m0, s26, 1024
    s_nop 0
    buffer_load_dwordx4 v7, s[4:7], s24 offen lds
    s_add_u32 m0, s26, 2048
    s_nop 0
    buffer_load_dwordx4 v8, s[4:7], s24 offen lds
    s_add_u32 m0, s26, 3072
    s_nop 0
    buffer_load_dwordx4 v9, s[4:7], s24 offen lds
    s_mov_b32 s25, 0
    s_add_u32 m0, s27, 16384
    s_nop 0
    buffer_load_dwordx4 v10, s[8:11], s25 offen lds
    s_add_u32 m0, s27, 17408
    s_nop 0
    buffer_load_dwordx4 v11, s[8:11], s25 offen lds
    s_add_u32 m0, s27, 18432
    s_nop 0
    buffer_load_dwordx4 v12, s[8:11], s25 offen lds
    s_add_u32 m0, s27, 19456
    s_nop 0
    buffer_load_dwordx4 v13, s[8:11], s25 offen lds
    s_mov_b32 s24, 4096
    s_add_u32 m0, s26, 32768
    s_nop 0
    buffer_load_dwordx4 v6, s[4:7], s24 offen lds
    s_add_u32 m0, s26, 33792
    s_nop 0
    buffer_load_dwordx4 v7, s[4:7], s24 offen lds
    s_add_u32 m0, s26, 34816
    s_nop 0
    buffer_load_dwordx4 v8, s[4:7], s24 offen lds
    s_add_u32 m0, s26, 35840
    s_nop 0
    buffer_load_dwordx4 v9, s[4:7], s24 offen lds
    s_mov_b32 s25, 16384
    s_add_u32 m0, s27, 49152
    s_nop 0
    buffer_load_dwordx4 v10, s[8:11], s25 offen lds
    s_add_u32 m0, s27, 50176
    s_nop 0
    buffer_load_dwordx4 v11, s[8:11], s25 offen lds
    s_add_u32 m0, s27, 51200
    s_nop 0
    buffer_load_dwordx4 v12, s[8:11], s25 offen lds
    s_add_u32 m0, s27, 52224
    s_nop 0
    buffer_load_dwordx4 v13, s[8:11], s25 offen lds
    s_mov_b32 s24, 8192
    s_add_u32 m0, s26, 65536
    s_nop 0
    buffer_load_dwordx4 v6, s[4:7], s24 offen lds
    s_add_u32 m0, s26, 66560
    s_nop 0
    buffer_load_dwordx4 v7, s[4:7], s24 offen lds
    s_add_u32 m0, s26, 67584
    s_nop 0
    buffer_load_dwordx4 v8, s[4:7], s24 offen lds
    s_add_u32 m0, s26, 68608
    s_nop 0
    buffer_load_dwordx4 v9, s[4:7], s24 offen lds
    s_mov_b32 s25, 32768
    s_add_u32 m0, s27, 81920
    s_nop 0
    buffer_load_dwordx4 v10, s[8:11], s25 offen lds
    s_add_u32 m0, s27, 82944
    s_nop 0
    buffer_load_dwordx4 v11, s[8:11], s25 offen lds
    s_add_u32 m0, s27, 83968
    s_nop 0
    buffer_load_dwordx4 v12, s[8:11], s25 offen lds
    s_add_u32 m0, s27, 84992
    s_nop 0
    buffer_load_dwordx4 v13, s[8:11], s25 offen lds
    s_waitcnt vmcnt(16)
    s_barrier
    s_mov_b32 s24, 12288
    s_add_u32 m0, s26, 98304
    s_nop 0
    buffer_load_dwordx4 v6, s[4:7], s24 offen lds
    s_add_u32 m0, s26, 99328
    s_nop 0
    buffer_load_dwordx4 v7, s[4:7], s24 offen lds
    s_add_u32 m0, s26, 100352
    s_nop 0
    buffer_load_dwordx4 v8, s[4:7], s24 offen lds
    s_add_u32 m0, s26, 101376
    s_nop 0
    buffer_load_dwordx4 v9, s[4:7], s24 offen lds
    s_mov_b32 s25, 49152
    s_add_u32 m0, s27, 114688
    s_nop 0
    buffer_load_dwordx4 v10, s[8:11], s25 offen lds
    s_add_u32 m0, s27, 115712
    s_nop 0
    buffer_load_dwordx4 v11, s[8:11], s25 offen lds
    s_add_u32 m0, s27, 116736
    s_nop 0
    buffer_load_dwordx4 v12, s[8:11], s25 offen lds
    s_add_u32 m0, s27, 117760
    s_nop 0
    buffer_load_dwordx4 v13, s[8:11], s25 offen lds
    s_waitcnt vmcnt(16)
    s_barrier
    s_mov_b32 s24, 16384
    s_add_u32 m0, s26, 0
    s_nop 0
    buffer_load_dwordx4 v6, s[4:7], s24 offen lds
    s_add_u32 m0, s26, 1024
    s_nop 0
    buffer_load_dwordx4 v7, s[4:7], s24 offen lds
    s_add_u32 m0, s26, 2048
    s_nop 0
    buffer_load_dwordx4 v8, s[4:7], s24 offen lds
    s_add_u32 m0, s26, 3072
    s_nop 0
    buffer_load_dwordx4 v9, s[4:7], s24 offen lds
    s_mov_b32 s25, 65536
    s_add_u32 m0, s27, 16384
    s_nop 0
    buffer_load_dwordx4 v10, s[8:11], s25 offen lds
    s_add_u32 m0, s27, 17408
    s_nop 0
    buffer_load_dwordx4 v11, s[8:11], s25 offen lds
    s_add_u32 m0, s27, 18432
    s_nop 0
    buffer_load_dwordx4 v12, s[8:11], s25 offen lds
    s_add_u32 m0, s27, 19456
    s_nop 0
    buffer_load_dwordx4 v13, s[8:11], s25 offen lds
    s_waitcnt vmcnt(16)
    s_barrier
    s_mov_b32 s24, 20480
    s_add_u32 m0, s26, 32768
    s_nop 0
    buffer_load_dwordx4 v6, s[4:7], s24 offen lds
    s_add_u32 m0, s26, 33792
    s_nop 0
    buffer_load_dwordx4 v7, s[4:7], s24 offen lds
    s_add_u32 m0, s26, 34816
    s_nop 0
    buffer_load_dwordx4 v8, s[4:7], s24 offen lds
    s_add_u32 m0, s26, 35840
    s_nop 0
    buffer_load_dwordx4 v9, s[4:7], s24 offen lds
    s_mov_b32 s25, 81920
    s_add_u32 m0, s27, 49152
    s_nop 0
    buffer_load_dwordx4 v10, s[8:11], s25 offen lds
    s_add_u32 m0, s27, 50176
    s_nop 0
    buffer_load_dwordx4 v11, s[8:11], s25 offen lds
    s_add_u32 m0, s27, 51200
    s_nop 0
    buffer_load_dwordx4 v12, s[8:11], s25 offen lds
    s_add_u32 m0, s27, 52224
    s_nop 0
    buffer_load_dwordx4 v13, s[8:11], s25 offen lds
    s_waitcnt vmcnt(16)
    s_barrier
    s_mov_b32 s24, 24576
    s_add_u32 m0, s26, 65536
    s_nop 0
    buffer_load_dwordx4 v6, s[4:7], s24 offen lds
    s_add_u32 m0, s26, 66560
    s_nop 0
    buffer_load_dwordx4 v7, s[4:7], s24 offen lds
    s_add_u32 m0, s26, 67584
    s_nop 0
    buffer_load_dwordx4 v8, s[4:7], s24 offen lds
    s_add_u32 m0, s26, 68608
    s_nop 0
    buffer_load_dwordx4 v9, s[4:7], s24 offen lds
    s_mov_b32 s25, 98304
    s_add_u32 m0, s27, 81920
    s_nop 0
    buffer_load_dwordx4 v10, s[8:11], s25 offen lds
    s_add_u32 m0, s27, 82944
    s_nop 0
    buffer_load_dwordx4 v11, s[8:11], s25 offen lds
    s_add_u32 m0, s27, 83968
    s_nop 0
    buffer_load_dwordx4 v12, s[8:11], s25 offen lds
    s_add_u32 m0, s27, 84992
    s_nop 0
    buffer_load_dwordx4 v13, s[8:11], s25 offen lds
    s_waitcnt vmcnt(16)
    s_barrier
    s_mov_b32 s24, 28672
    s_add_u32 m0, s26, 98304
    s_nop 0
    buffer_load_dwordx4 v6, s[4:7], s24 offen lds
    s_add_u32 m0, s26, 99328
    s_nop 0
    buffer_load_dwordx4 v7, s[4:7], s24 offen lds
    s_add_u32 m0, s26, 100352
    s_nop 0
    buffer_load_dwordx4 v8, s[4:7], s24 offen lds
    s_add_u32 m0, s26, 101376
    s_nop 0
    buffer_load_dwordx4 v9, s[4:7], s24 offen lds
    s_mov_b32 s25, 114688
    s_add_u32 m0, s27, 114688
    s_nop 0
    buffer_load_dwordx4 v10, s[8:11], s25 offen lds
    s_add_u32 m0, s27, 115712
    s_nop 0
    buffer_load_dwordx4 v11, s[8:11], s25 offen lds
    s_add_u32 m0, s27, 116736
    s_nop 0
    buffer_load_dwordx4 v12, s[8:11], s25 offen lds
    s_add_u32 m0, s27, 117760
    s_nop 0
    buffer_load_dwordx4 v13, s[8:11], s25 offen lds
    s_waitcnt vmcnt(16)
    s_barrier
    s_waitcnt vmcnt(8)
    s_barrier
    s_waitcnt vmcnt(0)
    s_barrier
    s_endpgm
ffa1_kernel_comp:
    v_and_b32 v2, 31, v1
    v_add_u32 v2, s22, v2
    v_lshlrev_b32 v2, 7, v2
    v_lshrrev_b32 v3, 5, v1
    v_lshl_add_u32 v196, v3, 6, v2
    v_and_b32 v3, 31, v1
    v_lshlrev_b32 v3, 1, v3
    s_lshl_b32 s24, s3, 6
    s_lshl_b32 s23, s21, 8
    s_add_u32 s24, s24, s23
    v_add_u32 v197, s24, v3
    v_lshlrev_b32 v14, 4, v1
    v_add_u32 v14, s26, v14
    v_add_u32 v15, 1024, v14
    v_add_u32 v16, 2048, v14
    v_add_u32 v17, 3072, v14
    v_bfe_u32 v2, v1, 2, 2
    v_lshrrev_b32 v3, 5, v1
    v_lshl_add_u32 v3, v3, 3, v2
    v_mul_u32_u24 v3, 256, v3
    v_bfe_u32 v4, v1, 4, 1
    v_lshl_add_u32 v3, v4, 5, v3
    v_and_b32 v4, 3, v1
    v_lshl_add_u32 v3, v4, 3, v3
    v_add_u32 v3, 16384, v3
    v_xor_b32 v4, 0, v2
    v_lshl_add_u32 v22, v4, 6, v3
    v_xor_b32 v4, 1, v2
    v_lshl_add_u32 v23, v4, 6, v3
    v_xor_b32 v4, 2, v2
    v_lshl_add_u32 v24, v4, 6, v3
    v_xor_b32 v4, 3, v2
    v_lshl_add_u32 v25, v4, 6, v3
    s_min_u32 s23, s3, 3
    v_xor_b32 v4, s23, v2
    v_lshl_add_u32 v30, v4, 6, v3
    v_add_u32 v18, 65536, v14
    v_add_u32 v19, 65536, v15
    v_add_u32 v20, 65536, v16
    v_add_u32 v21, 65536, v17
    v_add_u32 v26, 65536, v22
    v_add_u32 v27, 65536, v23
    v_add_u32 v28, 65536, v24
    v_add_u32 v29, 65536, v25
    v_add_u32 v31, 65536, v30
    v_mov_b32 v32, 0x3f803f80
    v_mov_b32 v33, 0
    v_mov_b32 v34, 0
    v_mov_b32 v35, 0
    v_mov_b32 v244, 0
    v_mov_b32 v245, 0
    v_mov_b32 v246, 0
    v_mov_b32 v247, 0
    v_mov_b32 v248, 0
    v_mov_b32 v249, 0
    s_mov_b32 s36, 2.0
    s_mov_b32 s37, 2.0
    s_mov_b32 s38, 0x3fb8aa3b
    s_mov_b32 s39, 0x3fb8aa3b
    s_waitcnt lgkmcnt(0)
    s_mov_b32 s12, s28
    s_mov_b32 s13, s29
    s_and_b32 s13, s13, 0xffff
    s_mov_b32 s14, 0x10000000
    s_mov_b32 s15, 0x00020000
    s_mov_b32 s16, s34
    s_mov_b32 s17, s35
    s_and_b32 s17, s17, 0xffff
    s_mov_b32 s18, 0xe00
    s_mov_b32 s19, 0x00020000
    s_mov_b32 s24, 14680064
    buffer_load_dwordx4 v[44:47], v196, s[12:15], s24 offen offset:0
    buffer_load_dwordx4 v[48:51], v196, s[12:15], s24 offen offset:16
    buffer_load_dwordx4 v[52:55], v196, s[12:15], s24 offen offset:32
    buffer_load_dwordx4 v[56:59], v196, s[12:15], s24 offen offset:48
    buffer_load_ushort v36, v197, s[16:19], 0 offen
    s_barrier
    ds_read_b128 v[60:63], v14 offset:0
    ds_read_b64_tr_b16 v[72:73], v22 offset:0
    ds_read_b64_tr_b16 v[74:75], v22 offset:1024
    ds_read_b64_tr_b16 v[76:77], v23 offset:0
    ds_read_b64_tr_b16 v[78:79], v23 offset:1024
    ds_read_b64_tr_b16 v[80:81], v24 offset:0
    ds_read_b64_tr_b16 v[82:83], v24 offset:1024
    ds_read_b64_tr_b16 v[84:85], v25 offset:0
    ds_read_b64_tr_b16 v[86:87], v25 offset:1024
    ds_read_b64_tr_b16 v[120:121], v30 offset:0
    ds_read_b64_tr_b16 v[122:123], v30 offset:1024
    ds_read_b128 v[64:67], v15 offset:0
    ds_read_b64_tr_b16 v[88:89], v22 offset:4096
    ds_read_b64_tr_b16 v[90:91], v22 offset:5120
    ds_read_b64_tr_b16 v[92:93], v23 offset:4096
    ds_read_b64_tr_b16 v[94:95], v23 offset:5120
    ds_read_b64_tr_b16 v[96:97], v24 offset:4096
    ds_read_b64_tr_b16 v[98:99], v24 offset:5120
    ds_read_b64_tr_b16 v[100:101], v25 offset:4096
    ds_read_b64_tr_b16 v[102:103], v25 offset:5120
    ds_read_b64_tr_b16 v[124:125], v30 offset:4096
    ds_read_b64_tr_b16 v[126:127], v30 offset:5120
    s_waitcnt lgkmcnt(11)
    v_mfma_f32_32x32x16_bf16 v[132:147], v[72:75], v[60:63], 0
    ds_read_b128 v[68:71], v16 offset:0
    ds_read_b64_tr_b16 v[104:105], v22 offset:8192
    ds_read_b64_tr_b16 v[106:107], v22 offset:9216
    v_mfma_f32_32x32x16_bf16 v[148:163], v[76:79], v[60:63], 0
    ds_read_b64_tr_b16 v[108:109], v23 offset:8192
    ds_read_b64_tr_b16 v[110:111], v23 offset:9216
    ds_read_b64_tr_b16 v[112:113], v24 offset:8192
    ds_read_b64_tr_b16 v[114:115], v24 offset:9216
    v_mfma_f32_32x32x16_bf16 v[164:179], v[80:83], v[60:63], 0
    ds_read_b64_tr_b16 v[116:117], v25 offset:8192
    ds_read_b64_tr_b16 v[118:119], v25 offset:9216
    ds_read_b64_tr_b16 v[128:129], v30 offset:8192
    ds_read_b64_tr_b16 v[130:131], v30 offset:9216
    v_mfma_f32_32x32x16_bf16 v[180:195], v[84:87], v[60:63], 0
    v_lshlrev_b32 v204, 16, v120
    v_and_b32 v205, 0xffff0000, v120
    v_lshlrev_b32 v206, 16, v121
    v_and_b32 v207, 0xffff0000, v121
    v_lshlrev_b32 v208, 16, v122
    v_and_b32 v209, 0xffff0000, v122
    v_lshlrev_b32 v210, 16, v123
    v_and_b32 v211, 0xffff0000, v123
    v_pk_add_f32 v[244:245], v[244:245], v[204:205]
    v_pk_add_f32 v[244:245], v[244:245], v[206:207]
    v_pk_add_f32 v[244:245], v[244:245], v[208:209]
    v_pk_add_f32 v[244:245], v[244:245], v[210:211]
    s_waitcnt lgkmcnt(11)
    v_mfma_f32_32x32x16_bf16 v[132:147], v[88:91], v[64:67], v[132:147]
    ds_read_b128 v[60:63], v17 offset:0
    ds_read_b64_tr_b16 v[72:73], v22 offset:12288
    ds_read_b64_tr_b16 v[74:75], v22 offset:13312
    v_mfma_f32_32x32x16_bf16 v[148:163], v[92:95], v[64:67], v[148:163]
    ds_read_b64_tr_b16 v[76:77], v23 offset:12288
    ds_read_b64_tr_b16 v[78:79], v23 offset:13312
    ds_read_b64_tr_b16 v[80:81], v24 offset:12288
    ds_read_b64_tr_b16 v[82:83], v24 offset:13312
    v_mfma_f32_32x32x16_bf16 v[164:179], v[96:99], v[64:67], v[164:179]
    ds_read_b64_tr_b16 v[84:85], v25 offset:12288
    ds_read_b64_tr_b16 v[86:87], v25 offset:13312
    ds_read_b64_tr_b16 v[120:121], v30 offset:12288
    ds_read_b64_tr_b16 v[122:123], v30 offset:13312
    v_mfma_f32_32x32x16_bf16 v[180:195], v[100:103], v[64:67], v[180:195]
    v_lshlrev_b32 v204, 16, v124
    v_and_b32 v205, 0xffff0000, v124
    v_lshlrev_b32 v206, 16, v125
    v_and_b32 v207, 0xffff0000, v125
    v_lshlrev_b32 v208, 16, v126
    v_and_b32 v209, 0xffff0000, v126
    v_lshlrev_b32 v210, 16, v127
    v_and_b32 v211, 0xffff0000, v127
    v_pk_add_f32 v[244:245], v[244:245], v[204:205]
    v_pk_add_f32 v[244:245], v[244:245], v[206:207]
    v_pk_add_f32 v[244:245], v[244:245], v[208:209]
    v_pk_add_f32 v[244:245], v[244:245], v[210:211]
    s_waitcnt lgkmcnt(0)
    s_barrier
    v_mfma_f32_32x32x16_bf16 v[132:147], v[104:107], v[68:71], v[132:147]
    ds_read_b128 v[64:67], v14 offset:32768
    ds_read_b64_tr_b16 v[88:89], v22 offset:32768
    ds_read_b64_tr_b16 v[90:91], v22 offset:33792
    v_mfma_f32_32x32x16_bf16 v[148:163], v[108:111], v[68:71], v[148:163]
    ds_read_b64_tr_b16 v[92:93], v23 offset:32768
    ds_read_b64_tr_b16 v[94:95], v23 offset:33792
    ds_read_b64_tr_b16 v[96:97], v24 offset:32768
    ds_read_b64_tr_b16 v[98:99], v24 offset:33792
    v_mfma_f32_32x32x16_bf16 v[164:179], v[112:115], v[68:71], v[164:179]
    ds_read_b64_tr_b16 v[100:101], v25 offset:32768
    ds_read_b64_tr_b16 v[102:103], v25 offset:33792
    ds_read_b64_tr_b16 v[124:125], v30 offset:32768
    ds_read_b64_tr_b16 v[126:127], v30 offset:33792
    v_mfma_f32_32x32x16_bf16 v[180:195], v[116:119], v[68:71], v[180:195]
    v_lshlrev_b32 v204, 16, v128
    v_and_b32 v205, 0xffff0000, v128
    v_lshlrev_b32 v206, 16, v129
    v_and_b32 v207, 0xffff0000, v129
    v_lshlrev_b32 v208, 16, v130
    v_and_b32 v209, 0xffff0000, v130
    v_lshlrev_b32 v210, 16, v131
    v_and_b32 v211, 0xffff0000, v131
    v_pk_add_f32 v[244:245], v[244:245], v[204:205]
    v_pk_add_f32 v[244:245], v[244:245], v[206:207]
    v_pk_add_f32 v[244:245], v[244:245], v[208:209]
    v_pk_add_f32 v[244:245], v[244:245], v[210:211]
    s_waitcnt lgkmcnt(11)
    v_mfma_f32_32x32x16_bf16 v[132:147], v[72:75], v[60:63], v[132:147]
    ds_read_b128 v[68:71], v15 offset:32768
    ds_read_b64_tr_b16 v[104:105], v22 offset:36864
    ds_read_b64_tr_b16 v[106:107], v22 offset:37888
    v_mfma_f32_32x32x16_bf16 v[148:163], v[76:79], v[60:63], v[148:163]
    ds_read_b64_tr_b16 v[108:109], v23 offset:36864
    ds_read_b64_tr_b16 v[110:111], v23 offset:37888
    ds_read_b64_tr_b16 v[112:113], v24 offset:36864
    ds_read_b64_tr_b16 v[114:115], v24 offset:37888
    v_mfma_f32_32x32x16_bf16 v[164:179], v[80:83], v[60:63], v[164:179]
    ds_read_b64_tr_b16 v[116:117], v25 offset:36864
    ds_read_b64_tr_b16 v[118:119], v25 offset:37888
    ds_read_b64_tr_b16 v[128:129], v30 offset:36864
    ds_read_b64_tr_b16 v[130:131], v30 offset:37888
    v_mfma_f32_32x32x16_bf16 v[180:195], v[84:87], v[60:63], v[180:195]
    v_lshlrev_b32 v204, 16, v120
    v_and_b32 v205, 0xffff0000, v120
    v_lshlrev_b32 v206, 16, v121
    v_and_b32 v207, 0xffff0000, v121
    v_lshlrev_b32 v208, 16, v122
    v_and_b32 v209, 0xffff0000, v122
    v_lshlrev_b32 v210, 16, v123
    v_and_b32 v211, 0xffff0000, v123
    v_pk_add_f32 v[244:245], v[244:245], v[204:205]
    v_pk_add_f32 v[244:245], v[244:245], v[206:207]
    v_pk_add_f32 v[244:245], v[244:245], v[208:209]
    v_pk_add_f32 v[244:245], v[244:245], v[210:211]
    s_waitcnt lgkmcnt(11)
    v_mfma_f32_32x32x16_bf16 v[132:147], v[88:91], v[64:67], v[132:147]
    ds_read_b128 v[60:63], v16 offset:32768
    ds_read_b64_tr_b16 v[72:73], v22 offset:40960
    ds_read_b64_tr_b16 v[74:75], v22 offset:41984
    v_mfma_f32_32x32x16_bf16 v[148:163], v[92:95], v[64:67], v[148:163]
    ds_read_b64_tr_b16 v[76:77], v23 offset:40960
    ds_read_b64_tr_b16 v[78:79], v23 offset:41984
    ds_read_b64_tr_b16 v[80:81], v24 offset:40960
    ds_read_b64_tr_b16 v[82:83], v24 offset:41984
    v_mfma_f32_32x32x16_bf16 v[164:179], v[96:99], v[64:67], v[164:179]
    ds_read_b64_tr_b16 v[84:85], v25 offset:40960
    ds_read_b64_tr_b16 v[86:87], v25 offset:41984
    ds_read_b64_tr_b16 v[120:121], v30 offset:40960
    ds_read_b64_tr_b16 v[122:123], v30 offset:41984
    v_mfma_f32_32x32x16_bf16 v[180:195], v[100:103], v[64:67], v[180:195]
    v_lshlrev_b32 v204, 16, v124
    v_and_b32 v205, 0xffff0000, v124
    v_lshlrev_b32 v206, 16, v125
    v_and_b32 v207, 0xffff0000, v125
    v_lshlrev_b32 v208, 16, v126
    v_and_b32 v209, 0xffff0000, v126
    v_lshlrev_b32 v210, 16, v127
    v_and_b32 v211, 0xffff0000, v127
    v_pk_add_f32 v[244:245], v[244:245], v[204:205]
    v_pk_add_f32 v[244:245], v[244:245], v[206:207]
    v_pk_add_f32 v[244:245], v[244:245], v[208:209]
    v_pk_add_f32 v[244:245], v[244:245], v[210:211]
    s_waitcnt lgkmcnt(11)
    v_mfma_f32_32x32x16_bf16 v[132:147], v[104:107], v[68:71], v[132:147]
    ds_read_b128 v[64:67], v17 offset:32768
    ds_read_b64_tr_b16 v[88:89], v22 offset:45056
    ds_read_b64_tr_b16 v[90:91], v22 offset:46080
    v_mfma_f32_32x32x16_bf16 v[148:163], v[108:111], v[68:71], v[148:163]
    ds_read_b64_tr_b16 v[92:93], v23 offset:45056
    ds_read_b64_tr_b16 v[94:95], v23 offset:46080
    ds_read_b64_tr_b16 v[96:97], v24 offset:45056
    ds_read_b64_tr_b16 v[98:99], v24 offset:46080
    v_mfma_f32_32x32x16_bf16 v[164:179], v[112:115], v[68:71], v[164:179]
    ds_read_b64_tr_b16 v[100:101], v25 offset:45056
    ds_read_b64_tr_b16 v[102:103], v25 offset:46080
    ds_read_b64_tr_b16 v[124:125], v30 offset:45056
    ds_read_b64_tr_b16 v[126:127], v30 offset:46080
    v_mfma_f32_32x32x16_bf16 v[180:195], v[116:119], v[68:71], v[180:195]
    v_lshlrev_b32 v204, 16, v128
    v_and_b32 v205, 0xffff0000, v128
    v_lshlrev_b32 v206, 16, v129
    v_and_b32 v207, 0xffff0000, v129
    v_lshlrev_b32 v208, 16, v130
    v_and_b32 v209, 0xffff0000, v130
    v_lshlrev_b32 v210, 16, v131
    v_and_b32 v211, 0xffff0000, v131
    v_pk_add_f32 v[244:245], v[244:245], v[204:205]
    v_pk_add_f32 v[244:245], v[244:245], v[206:207]
    v_pk_add_f32 v[244:245], v[244:245], v[208:209]
    v_pk_add_f32 v[244:245], v[244:245], v[210:211]
    s_waitcnt lgkmcnt(0)
    s_barrier
    v_mfma_f32_32x32x16_bf16 v[132:147], v[72:75], v[60:63], v[132:147]
    ds_read_b128 v[68:71], v18 offset:0
    ds_read_b64_tr_b16 v[104:105], v26 offset:0
    ds_read_b64_tr_b16 v[106:107], v26 offset:1024
    v_mfma_f32_32x32x16_bf16 v[148:163], v[76:79], v[60:63], v[148:163]
    ds_read_b64_tr_b16 v[108:109], v27 offset:0
    ds_read_b64_tr_b16 v[110:111], v27 offset:1024
    ds_read_b64_tr_b16 v[112:113], v28 offset:0
    ds_read_b64_tr_b16 v[114:115], v28 offset:1024
    v_mfma_f32_32x32x16_bf16 v[164:179], v[80:83], v[60:63], v[164:179]
    ds_read_b64_tr_b16 v[116:117], v29 offset:0
    ds_read_b64_tr_b16 v[118:119], v29 offset:1024
    ds_read_b64_tr_b16 v[128:129], v31 offset:0
    ds_read_b64_tr_b16 v[130:131], v31 offset:1024
    v_mfma_f32_32x32x16_bf16 v[180:195], v[84:87], v[60:63], v[180:195]
    v_lshlrev_b32 v204, 16, v120
    v_and_b32 v205, 0xffff0000, v120
    v_lshlrev_b32 v206, 16, v121
    v_and_b32 v207, 0xffff0000, v121
    v_lshlrev_b32 v208, 16, v122
    v_and_b32 v209, 0xffff0000, v122
    v_lshlrev_b32 v210, 16, v123
    v_and_b32 v211, 0xffff0000, v123
    v_pk_add_f32 v[244:245], v[244:245], v[204:205]
    v_pk_add_f32 v[244:245], v[244:245], v[206:207]
    v_pk_add_f32 v[244:245], v[244:245], v[208:209]
    v_pk_add_f32 v[244:245], v[244:245], v[210:211]
    s_waitcnt lgkmcnt(11)
    v_mfma_f32_32x32x16_bf16 v[132:147], v[88:91], v[64:67], v[132:147]
    ds_read_b128 v[60:63], v19 offset:0
    ds_read_b64_tr_b16 v[72:73], v26 offset:4096
    ds_read_b64_tr_b16 v[74:75], v26 offset:5120
    v_mfma_f32_32x32x16_bf16 v[148:163], v[92:95], v[64:67], v[148:163]
    ds_read_b64_tr_b16 v[76:77], v27 offset:4096
    ds_read_b64_tr_b16 v[78:79], v27 offset:5120
    ds_read_b64_tr_b16 v[80:81], v28 offset:4096
    ds_read_b64_tr_b16 v[82:83], v28 offset:5120
    v_mfma_f32_32x32x16_bf16 v[164:179], v[96:99], v[64:67], v[164:179]
    ds_read_b64_tr_b16 v[84:85], v29 offset:4096
    ds_read_b64_tr_b16 v[86:87], v29 offset:5120
    ds_read_b64_tr_b16 v[120:121], v31 offset:4096
    ds_read_b64_tr_b16 v[122:123], v31 offset:5120
    v_mfma_f32_32x32x16_bf16 v[180:195], v[100:103], v[64:67], v[180:195]
    v_lshlrev_b32 v204, 16, v124
    v_and_b32 v205, 0xffff0000, v124
    v_lshlrev_b32 v206, 16, v125
    v_and_b32 v207, 0xffff0000, v125
    v_lshlrev_b32 v208, 16, v126
    v_and_b32 v209, 0xffff0000, v126
    v_lshlrev_b32 v210, 16, v127
    v_and_b32 v211, 0xffff0000, v127
    v_pk_add_f32 v[244:245], v[244:245], v[204:205]
    v_pk_add_f32 v[244:245], v[244:245], v[206:207]
    v_pk_add_f32 v[244:245], v[244:245], v[208:209]
    v_pk_add_f32 v[244:245], v[244:245], v[210:211]
    s_waitcnt lgkmcnt(11)
    v_mfma_f32_32x32x16_bf16 v[132:147], v[104:107], v[68:71], v[132:147]
    ds_read_b128 v[64:67], v20 offset:0
    ds_read_b64_tr_b16 v[88:89], v26 offset:8192
    ds_read_b64_tr_b16 v[90:91], v26 offset:9216
    v_mfma_f32_32x32x16_bf16 v[148:163], v[108:111], v[68:71], v[148:163]
    ds_read_b64_tr_b16 v[92:93], v27 offset:8192
    ds_read_b64_tr_b16 v[94:95], v27 offset:9216
    ds_read_b64_tr_b16 v[96:97], v28 offset:8192
    ds_read_b64_tr_b16 v[98:99], v28 offset:9216
    v_mfma_f32_32x32x16_bf16 v[164:179], v[112:115], v[68:71], v[164:179]
    ds_read_b64_tr_b16 v[100:101], v29 offset:8192
    ds_read_b64_tr_b16 v[102:103], v29 offset:9216
    ds_read_b64_tr_b16 v[124:125], v31 offset:8192
    ds_read_b64_tr_b16 v[126:127], v31 offset:9216
    v_mfma_f32_32x32x16_bf16 v[180:195], v[116:119], v[68:71], v[180:195]
    v_lshlrev_b32 v204, 16, v128
    v_and_b32 v205, 0xffff0000, v128
    v_lshlrev_b32 v206, 16, v129
    v_and_b32 v207, 0xffff0000, v129
    v_lshlrev_b32 v208, 16, v130
    v_and_b32 v209, 0xffff0000, v130
    v_lshlrev_b32 v210, 16, v131
    v_and_b32 v211, 0xffff0000, v131
    v_pk_add_f32 v[244:245], v[244:245], v[204:205]
    v_pk_add_f32 v[244:245], v[244:245], v[206:207]
    v_pk_add_f32 v[244:245], v[244:245], v[208:209]
    v_pk_add_f32 v[244:245], v[244:245], v[210:211]
    s_waitcnt lgkmcnt(11)
    v_mfma_f32_32x32x16_bf16 v[132:147], v[72:75], v[60:63], v[132:147]
    ds_read_b128 v[68:71], v21 offset:0
    ds_read_b64_tr_b16 v[104:105], v26 offset:12288
    ds_read_b64_tr_b16 v[106:107], v26 offset:13312
    v_mfma_f32_32x32x16_bf16 v[148:163], v[76:79], v[60:63], v[148:163]
    ds_read_b64_tr_b16 v[108:109], v27 offset:12288
    ds_read_b64_tr_b16 v[110:111], v27 offset:13312
    ds_read_b64_tr_b16 v[112:113], v28 offset:12288
    ds_read_b64_tr_b16 v[114:115], v28 offset:13312
    v_mfma_f32_32x32x16_bf16 v[164:179], v[80:83], v[60:63], v[164:179]
    ds_read_b64_tr_b16 v[116:117], v29 offset:12288
    ds_read_b64_tr_b16 v[118:119], v29 offset:13312
    ds_read_b64_tr_b16 v[128:129], v31 offset:12288
    ds_read_b64_tr_b16 v[130:131], v31 offset:13312
    v_mfma_f32_32x32x16_bf16 v[180:195], v[84:87], v[60:63], v[180:195]
    v_lshlrev_b32 v204, 16, v120
    v_and_b32 v205, 0xffff0000, v120
    v_lshlrev_b32 v206, 16, v121
    v_and_b32 v207, 0xffff0000, v121
    v_lshlrev_b32 v208, 16, v122
    v_and_b32 v209, 0xffff0000, v122
    v_lshlrev_b32 v210, 16, v123
    v_and_b32 v211, 0xffff0000, v123
    v_pk_add_f32 v[244:245], v[244:245], v[204:205]
    v_pk_add_f32 v[244:245], v[244:245], v[206:207]
    v_pk_add_f32 v[244:245], v[244:245], v[208:209]
    v_pk_add_f32 v[244:245], v[244:245], v[210:211]
    s_waitcnt lgkmcnt(0)
    s_barrier
    v_mfma_f32_32x32x16_bf16 v[132:147], v[88:91], v[64:67], v[132:147]
    ds_read_b128 v[60:63], v18 offset:32768
    ds_read_b64_tr_b16 v[72:73], v26 offset:32768
    ds_read_b64_tr_b16 v[74:75], v26 offset:33792
    v_mfma_f32_32x32x16_bf16 v[148:163], v[92:95], v[64:67], v[148:163]
    ds_read_b64_tr_b16 v[76:77], v27 offset:32768
    ds_read_b64_tr_b16 v[78:79], v27 offset:33792
    ds_read_b64_tr_b16 v[80:81], v28 offset:32768
    ds_read_b64_tr_b16 v[82:83], v28 offset:33792
    v_mfma_f32_32x32x16_bf16 v[164:179], v[96:99], v[64:67], v[164:179]
    ds_read_b64_tr_b16 v[84:85], v29 offset:32768
    ds_read_b64_tr_b16 v[86:87], v29 offset:33792
    ds_read_b64_tr_b16 v[120:121], v31 offset:32768
    ds_read_b64_tr_b16 v[122:123], v31 offset:33792
    v_mfma_f32_32x32x16_bf16 v[180:195], v[100:103], v[64:67], v[180:195]
    v_lshlrev_b32 v204, 16, v124
    v_and_b32 v205, 0xffff0000, v124
    v_lshlrev_b32 v206, 16, v125
    v_and_b32 v207, 0xffff0000, v125
    v_lshlrev_b32 v208, 16, v126
    v_and_b32 v209, 0xffff0000, v126
    v_lshlrev_b32 v210, 16, v127
    v_and_b32 v211, 0xffff0000, v127
    v_pk_add_f32 v[244:245], v[244:245], v[204:205]
    v_pk_add_f32 v[244:245], v[244:245], v[206:207]
    v_pk_add_f32 v[244:245], v[244:245], v[208:209]
    v_pk_add_f32 v[244:245], v[244:245], v[210:211]
    s_waitcnt lgkmcnt(11)
    v_mfma_f32_32x32x16_bf16 v[132:147], v[104:107], v[68:71], v[132:147]
    ds_read_b128 v[64:67], v19 offset:32768
    ds_read_b64_tr_b16 v[88:89], v26 offset:36864
    ds_read_b64_tr_b16 v[90:91], v26 offset:37888
    v_mfma_f32_32x32x16_bf16 v[148:163], v[108:111], v[68:71], v[148:163]
    ds_read_b64_tr_b16 v[92:93], v27 offset:36864
    ds_read_b64_tr_b16 v[94:95], v27 offset:37888
    ds_read_b64_tr_b16 v[96:97], v28 offset:36864
    ds_read_b64_tr_b16 v[98:99], v28 offset:37888
    v_mfma_f32_32x32x16_bf16 v[164:179], v[112:115], v[68:71], v[164:179]
    ds_read_b64_tr_b16 v[100:101], v29 offset:36864
    ds_read_b64_tr_b16 v[102:103], v29 offset:37888
    ds_read_b64_tr_b16 v[124:125], v31 offset:36864
    ds_read_b64_tr_b16 v[126:127], v31 offset:37888
    v_mfma_f32_32x32x16_bf16 v[180:195], v[116:119], v[68:71], v[180:195]
    v_lshlrev_b32 v204, 16, v128
    v_and_b32 v205, 0xffff0000, v128
    v_lshlrev_b32 v206, 16, v129
    v_and_b32 v207, 0xffff0000, v129
    v_lshlrev_b32 v208, 16, v130
    v_and_b32 v209, 0xffff0000, v130
    v_lshlrev_b32 v210, 16, v131
    v_and_b32 v211, 0xffff0000, v131
    v_pk_add_f32 v[244:245], v[244:245], v[204:205]
    v_pk_add_f32 v[244:245], v[244:245], v[206:207]
    v_pk_add_f32 v[244:245], v[244:245], v[208:209]
    v_pk_add_f32 v[244:245], v[244:245], v[210:211]
    s_waitcnt lgkmcnt(11)
    v_mfma_f32_32x32x16_bf16 v[132:147], v[72:75], v[60:63], v[132:147]
    ds_read_b128 v[68:71], v20 offset:32768
    ds_read_b64_tr_b16 v[104:105], v26 offset:40960
    ds_read_b64_tr_b16 v[106:107], v26 offset:41984
    v_mfma_f32_32x32x16_bf16 v[148:163], v[76:79], v[60:63], v[148:163]
    ds_read_b64_tr_b16 v[108:109], v27 offset:40960
    ds_read_b64_tr_b16 v[110:111], v27 offset:41984
    ds_read_b64_tr_b16 v[112:113], v28 offset:40960
    ds_read_b64_tr_b16 v[114:115], v28 offset:41984
    v_mfma_f32_32x32x16_bf16 v[164:179], v[80:83], v[60:63], v[164:179]
    ds_read_b64_tr_b16 v[116:117], v29 offset:40960
    ds_read_b64_tr_b16 v[118:119], v29 offset:41984
    ds_read_b64_tr_b16 v[128:129], v31 offset:40960
    ds_read_b64_tr_b16 v[130:131], v31 offset:41984
    v_mfma_f32_32x32x16_bf16 v[180:195], v[84:87], v[60:63], v[180:195]
    v_lshlrev_b32 v204, 16, v120
    v_and_b32 v205, 0xffff0000, v120
    v_lshlrev_b32 v206, 16, v121
    v_and_b32 v207, 0xffff0000, v121
    v_lshlrev_b32 v208, 16, v122
    v_and_b32 v209, 0xffff0000, v122
    v_lshlrev_b32 v210, 16, v123
    v_and_b32 v211, 0xffff0000, v123
    v_pk_add_f32 v[244:245], v[244:245], v[204:205]
    v_pk_add_f32 v[244:245], v[244:245], v[206:207]
    v_pk_add_f32 v[244:245], v[244:245], v[208:209]
    v_pk_add_f32 v[244:245], v[244:245], v[210:211]
    s_waitcnt lgkmcnt(11)
    v_mfma_f32_32x32x16_bf16 v[132:147], v[88:91], v[64:67], v[132:147]
    ds_read_b128 v[60:63], v21 offset:32768
    ds_read_b64_tr_b16 v[72:73], v26 offset:45056
    ds_read_b64_tr_b16 v[74:75], v26 offset:46080
    v_mfma_f32_32x32x16_bf16 v[148:163], v[92:95], v[64:67], v[148:163]
    ds_read_b64_tr_b16 v[76:77], v27 offset:45056
    ds_read_b64_tr_b16 v[78:79], v27 offset:46080
    ds_read_b64_tr_b16 v[80:81], v28 offset:45056
    ds_read_b64_tr_b16 v[82:83], v28 offset:46080
    v_mfma_f32_32x32x16_bf16 v[164:179], v[96:99], v[64:67], v[164:179]
    ds_read_b64_tr_b16 v[84:85], v29 offset:45056
    ds_read_b64_tr_b16 v[86:87], v29 offset:46080
    ds_read_b64_tr_b16 v[120:121], v31 offset:45056
    ds_read_b64_tr_b16 v[122:123], v31 offset:46080
    v_mfma_f32_32x32x16_bf16 v[180:195], v[100:103], v[64:67], v[180:195]
    v_lshlrev_b32 v204, 16, v124
    v_and_b32 v205, 0xffff0000, v124
    v_lshlrev_b32 v206, 16, v125
    v_and_b32 v207, 0xffff0000, v125
    v_lshlrev_b32 v208, 16, v126
    v_and_b32 v209, 0xffff0000, v126
    v_lshlrev_b32 v210, 16, v127
    v_and_b32 v211, 0xffff0000, v127
    v_pk_add_f32 v[244:245], v[244:245], v[204:205]
    v_pk_add_f32 v[244:245], v[244:245], v[206:207]
    v_pk_add_f32 v[244:245], v[244:245], v[208:209]
    v_pk_add_f32 v[244:245], v[244:245], v[210:211]
    s_waitcnt lgkmcnt(0)
    s_barrier
    v_mfma_f32_32x32x16_bf16 v[132:147], v[104:107], v[68:71], v[132:147]
    ds_read_b128 v[64:67], v14 offset:0
    ds_read_b64_tr_b16 v[88:89], v22 offset:0
    ds_read_b64_tr_b16 v[90:91], v22 offset:1024
    v_mfma_f32_32x32x16_bf16 v[148:163], v[108:111], v[68:71], v[148:163]
    ds_read_b64_tr_b16 v[92:93], v23 offset:0
    ds_read_b64_tr_b16 v[94:95], v23 offset:1024
    ds_read_b64_tr_b16 v[96:97], v24 offset:0
    ds_read_b64_tr_b16 v[98:99], v24 offset:1024
    v_mfma_f32_32x32x16_bf16 v[164:179], v[112:115], v[68:71], v[164:179]
    ds_read_b64_tr_b16 v[100:101], v25 offset:0
    ds_read_b64_tr_b16 v[102:103], v25 offset:1024
    ds_read_b64_tr_b16 v[124:125], v30 offset:0
    ds_read_b64_tr_b16 v[126:127], v30 offset:1024
    v_mfma_f32_32x32x16_bf16 v[180:195], v[116:119], v[68:71], v[180:195]
    v_lshlrev_b32 v204, 16, v128
    v_and_b32 v205, 0xffff0000, v128
    v_lshlrev_b32 v206, 16, v129
    v_and_b32 v207, 0xffff0000, v129
    v_lshlrev_b32 v208, 16, v130
    v_and_b32 v209, 0xffff0000, v130
    v_lshlrev_b32 v210, 16, v131
    v_and_b32 v211, 0xffff0000, v131
    v_pk_add_f32 v[244:245], v[244:245], v[204:205]
    v_pk_add_f32 v[244:245], v[244:245], v[206:207]
    v_pk_add_f32 v[244:245], v[244:245], v[208:209]
    v_pk_add_f32 v[244:245], v[244:245], v[210:211]
    s_waitcnt lgkmcnt(11)
    v_mfma_f32_32x32x16_bf16 v[132:147], v[72:75], v[60:63], v[132:147]
    ds_read_b128 v[68:71], v15 offset:0
    ds_read_b64_tr_b16 v[104:105], v22 offset:4096
    ds_read_b64_tr_b16 v[106:107], v22 offset:5120
    v_mfma_f32_32x32x16_bf16 v[148:163], v[76:79], v[60:63], v[148:163]
    ds_read_b64_tr_b16 v[108:109], v23 offset:4096
    ds_read_b64_tr_b16 v[110:111], v23 offset:5120
    ds_read_b64_tr_b16 v[112:113], v24 offset:4096
    ds_read_b64_tr_b16 v[114:115], v24 offset:5120
    v_mfma_f32_32x32x16_bf16 v[164:179], v[80:83], v[60:63], v[164:179]
    ds_read_b64_tr_b16 v[116:117], v25 offset:4096
    ds_read_b64_tr_b16 v[118:119], v25 offset:5120
    ds_read_b64_tr_b16 v[128:129], v30 offset:4096
    ds_read_b64_tr_b16 v[130:131], v30 offset:5120
    v_mfma_f32_32x32x16_bf16 v[180:195], v[84:87], v[60:63], v[180:195]
    v_lshlrev_b32 v204, 16, v120
    v_and_b32 v205, 0xffff0000, v120
    v_lshlrev_b32 v206, 16, v121
    v_and_b32 v207, 0xffff0000, v121
    v_lshlrev_b32 v208, 16, v122
    v_and_b32 v209, 0xffff0000, v122
    v_lshlrev_b32 v210, 16, v123
    v_and_b32 v211, 0xffff0000, v123
    v_pk_add_f32 v[244:245], v[244:245], v[204:205]
    v_pk_add_f32 v[244:245], v[244:245], v[206:207]
    v_pk_add_f32 v[244:245], v[244:245], v[208:209]
    v_pk_add_f32 v[244:245], v[244:245], v[210:211]
    s_waitcnt lgkmcnt(11)
    v_mfma_f32_32x32x16_bf16 v[132:147], v[88:91], v[64:67], v[132:147]
    ds_read_b128 v[60:63], v16 offset:0
    ds_read_b64_tr_b16 v[72:73], v22 offset:8192
    ds_read_b64_tr_b16 v[74:75], v22 offset:9216
    v_mfma_f32_32x32x16_bf16 v[148:163], v[92:95], v[64:67], v[148:163]
    ds_read_b64_tr_b16 v[76:77], v23 offset:8192
    ds_read_b64_tr_b16 v[78:79], v23 offset:9216
    ds_read_b64_tr_b16 v[80:81], v24 offset:8192
    ds_read_b64_tr_b16 v[82:83], v24 offset:9216
    v_mfma_f32_32x32x16_bf16 v[164:179], v[96:99], v[64:67], v[164:179]
    ds_read_b64_tr_b16 v[84:85], v25 offset:8192
    ds_read_b64_tr_b16 v[86:87], v25 offset:9216
    ds_read_b64_tr_b16 v[120:121], v30 offset:8192
    ds_read_b64_tr_b16 v[122:123], v30 offset:9216
    v_mfma_f32_32x32x16_bf16 v[180:195], v[100:103], v[64:67], v[180:195]
    v_lshlrev_b32 v204, 16, v124
    v_and_b32 v205, 0xffff0000, v124
    v_lshlrev_b32 v206, 16, v125
    v_and_b32 v207, 0xffff0000, v125
    v_lshlrev_b32 v208, 16, v126
    v_and_b32 v209, 0xffff0000, v126
    v_lshlrev_b32 v210, 16, v127
    v_and_b32 v211, 0xffff0000, v127
    v_pk_add_f32 v[244:245], v[244:245], v[204:205]
    v_pk_add_f32 v[244:245], v[244:245], v[206:207]
    v_pk_add_f32 v[244:245], v[244:245], v[208:209]
    v_pk_add_f32 v[244:245], v[244:245], v[210:211]
    s_waitcnt lgkmcnt(11)
    v_mfma_f32_32x32x16_bf16 v[132:147], v[104:107], v[68:71], v[132:147]
    ds_read_b128 v[64:67], v17 offset:0
    ds_read_b64_tr_b16 v[88:89], v22 offset:12288
    ds_read_b64_tr_b16 v[90:91], v22 offset:13312
    v_mfma_f32_32x32x16_bf16 v[148:163], v[108:111], v[68:71], v[148:163]
    ds_read_b64_tr_b16 v[92:93], v23 offset:12288
    ds_read_b64_tr_b16 v[94:95], v23 offset:13312
    ds_read_b64_tr_b16 v[96:97], v24 offset:12288
    ds_read_b64_tr_b16 v[98:99], v24 offset:13312
    v_mfma_f32_32x32x16_bf16 v[164:179], v[112:115], v[68:71], v[164:179]
    ds_read_b64_tr_b16 v[100:101], v25 offset:12288
    ds_read_b64_tr_b16 v[102:103], v25 offset:13312
    ds_read_b64_tr_b16 v[124:125], v30 offset:12288
    ds_read_b64_tr_b16 v[126:127], v30 offset:13312
    v_mfma_f32_32x32x16_bf16 v[180:195], v[116:119], v[68:71], v[180:195]
    v_lshlrev_b32 v204, 16, v128
    v_and_b32 v205, 0xffff0000, v128
    v_lshlrev_b32 v206, 16, v129
    v_and_b32 v207, 0xffff0000, v129
    v_lshlrev_b32 v208, 16, v130
    v_and_b32 v209, 0xffff0000, v130
    v_lshlrev_b32 v210, 16, v131
    v_and_b32 v211, 0xffff0000, v131
    v_pk_add_f32 v[244:245], v[244:245], v[204:205]
    v_pk_add_f32 v[244:245], v[244:245], v[206:207]
    v_pk_add_f32 v[244:245], v[244:245], v[208:209]
    v_pk_add_f32 v[244:245], v[244:245], v[210:211]
    s_waitcnt lgkmcnt(0)
    s_barrier
    v_mfma_f32_32x32x16_bf16 v[132:147], v[72:75], v[60:63], v[132:147]
    ds_read_b128 v[68:71], v14 offset:32768
    ds_read_b64_tr_b16 v[104:105], v22 offset:32768
    ds_read_b64_tr_b16 v[106:107], v22 offset:33792
    v_mfma_f32_32x32x16_bf16 v[148:163], v[76:79], v[60:63], v[148:163]
    ds_read_b64_tr_b16 v[108:109], v23 offset:32768
    ds_read_b64_tr_b16 v[110:111], v23 offset:33792
    ds_read_b64_tr_b16 v[112:113], v24 offset:32768
    ds_read_b64_tr_b16 v[114:115], v24 offset:33792
    v_mfma_f32_32x32x16_bf16 v[164:179], v[80:83], v[60:63], v[164:179]
    ds_read_b64_tr_b16 v[116:117], v25 offset:32768
    ds_read_b64_tr_b16 v[118:119], v25 offset:33792
    ds_read_b64_tr_b16 v[128:129], v30 offset:32768
    ds_read_b64_tr_b16 v[130:131], v30 offset:33792
    v_mfma_f32_32x32x16_bf16 v[180:195], v[84:87], v[60:63], v[180:195]
    v_lshlrev_b32 v204, 16, v120
    v_and_b32 v205, 0xffff0000, v120
    v_lshlrev_b32 v206, 16, v121
    v_and_b32 v207, 0xffff0000, v121
    v_lshlrev_b32 v208, 16, v122
    v_and_b32 v209, 0xffff0000, v122
    v_lshlrev_b32 v210, 16, v123
    v_and_b32 v211, 0xffff0000, v123
    v_pk_add_f32 v[244:245], v[244:245], v[204:205]
    v_pk_add_f32 v[244:245], v[244:245], v[206:207]
    v_pk_add_f32 v[244:245], v[244:245], v[208:209]
    v_pk_add_f32 v[244:245], v[244:245], v[210:211]
    s_waitcnt lgkmcnt(11)
    v_mfma_f32_32x32x16_bf16 v[132:147], v[88:91], v[64:67], v[132:147]
    ds_read_b128 v[60:63], v15 offset:32768
    ds_read_b64_tr_b16 v[72:73], v22 offset:36864
    ds_read_b64_tr_b16 v[74:75], v22 offset:37888
    v_mfma_f32_32x32x16_bf16 v[148:163], v[92:95], v[64:67], v[148:163]
    ds_read_b64_tr_b16 v[76:77], v23 offset:36864
    ds_read_b64_tr_b16 v[78:79], v23 offset:37888
    ds_read_b64_tr_b16 v[80:81], v24 offset:36864
    ds_read_b64_tr_b16 v[82:83], v24 offset:37888
    v_mfma_f32_32x32x16_bf16 v[164:179], v[96:99], v[64:67], v[164:179]
    ds_read_b64_tr_b16 v[84:85], v25 offset:36864
    ds_read_b64_tr_b16 v[86:87], v25 offset:37888
    ds_read_b64_tr_b16 v[120:121], v30 offset:36864
    ds_read_b64_tr_b16 v[122:123], v30 offset:37888
    v_mfma_f32_32x32x16_bf16 v[180:195], v[100:103], v[64:67], v[180:195]
    v_lshlrev_b32 v204, 16, v124
    v_and_b32 v205, 0xffff0000, v124
    v_lshlrev_b32 v206, 16, v125
    v_and_b32 v207, 0xffff0000, v125
    v_lshlrev_b32 v208, 16, v126
    v_and_b32 v209, 0xffff0000, v126
    v_lshlrev_b32 v210, 16, v127
    v_and_b32 v211, 0xffff0000, v127
    v_pk_add_f32 v[244:245], v[244:245], v[204:205]
    v_pk_add_f32 v[244:245], v[244:245], v[206:207]
    v_pk_add_f32 v[244:245], v[244:245], v[208:209]
    v_pk_add_f32 v[244:245], v[244:245], v[210:211]
    s_waitcnt lgkmcnt(11)
    v_mfma_f32_32x32x16_bf16 v[132:147], v[104:107], v[68:71], v[132:147]
    ds_read_b128 v[64:67], v16 offset:32768
    ds_read_b64_tr_b16 v[88:89], v22 offset:40960
    ds_read_b64_tr_b16 v[90:91], v22 offset:41984
    v_mfma_f32_32x32x16_bf16 v[148:163], v[108:111], v[68:71], v[148:163]
    ds_read_b64_tr_b16 v[92:93], v23 offset:40960
    ds_read_b64_tr_b16 v[94:95], v23 offset:41984
    ds_read_b64_tr_b16 v[96:97], v24 offset:40960
    ds_read_b64_tr_b16 v[98:99], v24 offset:41984
    v_mfma_f32_32x32x16_bf16 v[164:179], v[112:115], v[68:71], v[164:179]
    ds_read_b64_tr_b16 v[100:101], v25 offset:40960
    ds_read_b64_tr_b16 v[102:103], v25 offset:41984
    ds_read_b64_tr_b16 v[124:125], v30 offset:40960
    ds_read_b64_tr_b16 v[126:127], v30 offset:41984
    v_mfma_f32_32x32x16_bf16 v[180:195], v[116:119], v[68:71], v[180:195]
    v_lshlrev_b32 v204, 16, v128
    v_and_b32 v205, 0xffff0000, v128
    v_lshlrev_b32 v206, 16, v129
    v_and_b32 v207, 0xffff0000, v129
    v_lshlrev_b32 v208, 16, v130
    v_and_b32 v209, 0xffff0000, v130
    v_lshlrev_b32 v210, 16, v131
    v_and_b32 v211, 0xffff0000, v131
    v_pk_add_f32 v[244:245], v[244:245], v[204:205]
    v_pk_add_f32 v[244:245], v[244:245], v[206:207]
    v_pk_add_f32 v[244:245], v[244:245], v[208:209]
    v_pk_add_f32 v[244:245], v[244:245], v[210:211]
    s_waitcnt lgkmcnt(11)
    v_mfma_f32_32x32x16_bf16 v[132:147], v[72:75], v[60:63], v[132:147]
    ds_read_b128 v[68:71], v17 offset:32768
    ds_read_b64_tr_b16 v[104:105], v22 offset:45056
    ds_read_b64_tr_b16 v[106:107], v22 offset:46080
    v_mfma_f32_32x32x16_bf16 v[148:163], v[76:79], v[60:63], v[148:163]
    ds_read_b64_tr_b16 v[108:109], v23 offset:45056
    ds_read_b64_tr_b16 v[110:111], v23 offset:46080
    ds_read_b64_tr_b16 v[112:113], v24 offset:45056
    ds_read_b64_tr_b16 v[114:115], v24 offset:46080
    v_mfma_f32_32x32x16_bf16 v[164:179], v[80:83], v[60:63], v[164:179]
    ds_read_b64_tr_b16 v[116:117], v25 offset:45056
    ds_read_b64_tr_b16 v[118:119], v25 offset:46080
    ds_read_b64_tr_b16 v[128:129], v30 offset:45056
    ds_read_b64_tr_b16 v[130:131], v30 offset:46080
    v_mfma_f32_32x32x16_bf16 v[180:195], v[84:87], v[60:63], v[180:195]
    v_lshlrev_b32 v204, 16, v120
    v_and_b32 v205, 0xffff0000, v120
    v_lshlrev_b32 v206, 16, v121
    v_and_b32 v207, 0xffff0000, v121
    v_lshlrev_b32 v208, 16, v122
    v_and_b32 v209, 0xffff0000, v122
    v_lshlrev_b32 v210, 16, v123
    v_and_b32 v211, 0xffff0000, v123
    v_pk_add_f32 v[244:245], v[244:245], v[204:205]
    v_pk_add_f32 v[244:245], v[244:245], v[206:207]
    v_pk_add_f32 v[244:245], v[244:245], v[208:209]
    v_pk_add_f32 v[244:245], v[244:245], v[210:211]
    s_waitcnt lgkmcnt(0)
    s_barrier
    v_mfma_f32_32x32x16_bf16 v[132:147], v[88:91], v[64:67], v[132:147]
    ds_read_b128 v[60:63], v18 offset:0
    ds_read_b64_tr_b16 v[72:73], v26 offset:0
    ds_read_b64_tr_b16 v[74:75], v26 offset:1024
    v_mfma_f32_32x32x16_bf16 v[148:163], v[92:95], v[64:67], v[148:163]
    ds_read_b64_tr_b16 v[76:77], v27 offset:0
    ds_read_b64_tr_b16 v[78:79], v27 offset:1024
    ds_read_b64_tr_b16 v[80:81], v28 offset:0
    ds_read_b64_tr_b16 v[82:83], v28 offset:1024
    v_mfma_f32_32x32x16_bf16 v[164:179], v[96:99], v[64:67], v[164:179]
    ds_read_b64_tr_b16 v[84:85], v29 offset:0
    ds_read_b64_tr_b16 v[86:87], v29 offset:1024
    ds_read_b64_tr_b16 v[120:121], v31 offset:0
    ds_read_b64_tr_b16 v[122:123], v31 offset:1024
    v_mfma_f32_32x32x16_bf16 v[180:195], v[100:103], v[64:67], v[180:195]
    v_lshlrev_b32 v204, 16, v124
    v_and_b32 v205, 0xffff0000, v124
    v_lshlrev_b32 v206, 16, v125
    v_and_b32 v207, 0xffff0000, v125
    v_lshlrev_b32 v208, 16, v126
    v_and_b32 v209, 0xffff0000, v126
    v_lshlrev_b32 v210, 16, v127
    v_and_b32 v211, 0xffff0000, v127
    v_pk_add_f32 v[244:245], v[244:245], v[204:205]
    v_pk_add_f32 v[244:245], v[244:245], v[206:207]
    v_pk_add_f32 v[244:245], v[244:245], v[208:209]
    v_pk_add_f32 v[244:245], v[244:245], v[210:211]
    s_waitcnt lgkmcnt(11)
    v_mfma_f32_32x32x16_bf16 v[132:147], v[104:107], v[68:71], v[132:147]
    ds_read_b128 v[64:67], v19 offset:0
    ds_read_b64_tr_b16 v[88:89], v26 offset:4096
    ds_read_b64_tr_b16 v[90:91], v26 offset:5120
    v_mfma_f32_32x32x16_bf16 v[148:163], v[108:111], v[68:71], v[148:163]
    ds_read_b64_tr_b16 v[92:93], v27 offset:4096
    ds_read_b64_tr_b16 v[94:95], v27 offset:5120
    ds_read_b64_tr_b16 v[96:97], v28 offset:4096
    ds_read_b64_tr_b16 v[98:99], v28 offset:5120
    v_mfma_f32_32x32x16_bf16 v[164:179], v[112:115], v[68:71], v[164:179]
    ds_read_b64_tr_b16 v[100:101], v29 offset:4096
    ds_read_b64_tr_b16 v[102:103], v29 offset:5120
    ds_read_b64_tr_b16 v[124:125], v31 offset:4096
    ds_read_b64_tr_b16 v[126:127], v31 offset:5120
    v_mfma_f32_32x32x16_bf16 v[180:195], v[116:119], v[68:71], v[180:195]
    v_lshlrev_b32 v204, 16, v128
    v_and_b32 v205, 0xffff0000, v128
    v_lshlrev_b32 v206, 16, v129
    v_and_b32 v207, 0xffff0000, v129
    v_lshlrev_b32 v208, 16, v130
    v_and_b32 v209, 0xffff0000, v130
    v_lshlrev_b32 v210, 16, v131
    v_and_b32 v211, 0xffff0000, v131
    v_pk_add_f32 v[244:245], v[244:245], v[204:205]
    v_pk_add_f32 v[244:245], v[244:245], v[206:207]
    v_pk_add_f32 v[244:245], v[244:245], v[208:209]
    v_pk_add_f32 v[244:245], v[244:245], v[210:211]
    s_waitcnt lgkmcnt(11)
    v_mfma_f32_32x32x16_bf16 v[132:147], v[72:75], v[60:63], v[132:147]
    ds_read_b128 v[68:71], v20 offset:0
    ds_read_b64_tr_b16 v[104:105], v26 offset:8192
    ds_read_b64_tr_b16 v[106:107], v26 offset:9216
    v_mfma_f32_32x32x16_bf16 v[148:163], v[76:79], v[60:63], v[148:163]
    ds_read_b64_tr_b16 v[108:109], v27 offset:8192
    ds_read_b64_tr_b16 v[110:111], v27 offset:9216
    ds_read_b64_tr_b16 v[112:113], v28 offset:8192
    ds_read_b64_tr_b16 v[114:115], v28 offset:9216
    v_mfma_f32_32x32x16_bf16 v[164:179], v[80:83], v[60:63], v[164:179]
    ds_read_b64_tr_b16 v[116:117], v29 offset:8192
    ds_read_b64_tr_b16 v[118:119], v29 offset:9216
    ds_read_b64_tr_b16 v[128:129], v31 offset:8192
    ds_read_b64_tr_b16 v[130:131], v31 offset:9216
    v_mfma_f32_32x32x16_bf16 v[180:195], v[84:87], v[60:63], v[180:195]
    v_lshlrev_b32 v204, 16, v120
    v_and_b32 v205, 0xffff0000, v120
    v_lshlrev_b32 v206, 16, v121
    v_and_b32 v207, 0xffff0000, v121
    v_lshlrev_b32 v208, 16, v122
    v_and_b32 v209, 0xffff0000, v122
    v_lshlrev_b32 v210, 16, v123
    v_and_b32 v211, 0xffff0000, v123
    v_pk_add_f32 v[244:245], v[244:245], v[204:205]
    v_pk_add_f32 v[244:245], v[244:245], v[206:207]
    v_pk_add_f32 v[244:245], v[244:245], v[208:209]
    v_pk_add_f32 v[244:245], v[244:245], v[210:211]
    s_waitcnt lgkmcnt(11)
    v_mfma_f32_32x32x16_bf16 v[132:147], v[88:91], v[64:67], v[132:147]
    ds_read_b128 v[60:63], v21 offset:0
    ds_read_b64_tr_b16 v[72:73], v26 offset:12288
    ds_read_b64_tr_b16 v[74:75], v26 offset:13312
    v_mfma_f32_32x32x16_bf16 v[148:163], v[92:95], v[64:67], v[148:163]
    ds_read_b64_tr_b16 v[76:77], v27 offset:12288
    ds_read_b64_tr_b16 v[78:79], v27 offset:13312
    ds_read_b64_tr_b16 v[80:81], v28 offset:12288
    ds_read_b64_tr_b16 v[82:83], v28 offset:13312
    v_mfma_f32_32x32x16_bf16 v[164:179], v[96:99], v[64:67], v[164:179]
    ds_read_b64_tr_b16 v[84:85], v29 offset:12288
    ds_read_b64_tr_b16 v[86:87], v29 offset:13312
    ds_read_b64_tr_b16 v[120:121], v31 offset:12288
    ds_read_b64_tr_b16 v[122:123], v31 offset:13312
    v_mfma_f32_32x32x16_bf16 v[180:195], v[100:103], v[64:67], v[180:195]
    v_lshlrev_b32 v204, 16, v124
    v_and_b32 v205, 0xffff0000, v124
    v_lshlrev_b32 v206, 16, v125
    v_and_b32 v207, 0xffff0000, v125
    v_lshlrev_b32 v208, 16, v126
    v_and_b32 v209, 0xffff0000, v126
    v_lshlrev_b32 v210, 16, v127
    v_and_b32 v211, 0xffff0000, v127
    v_pk_add_f32 v[244:245], v[244:245], v[204:205]
    v_pk_add_f32 v[244:245], v[244:245], v[206:207]
    v_pk_add_f32 v[244:245], v[244:245], v[208:209]
    v_pk_add_f32 v[244:245], v[244:245], v[210:211]
    s_waitcnt lgkmcnt(0)
    s_barrier
    v_mfma_f32_32x32x16_bf16 v[132:147], v[104:107], v[68:71], v[132:147]
    ds_read_b128 v[64:67], v18 offset:32768
    ds_read_b64_tr_b16 v[88:89], v26 offset:32768
    ds_read_b64_tr_b16 v[90:91], v26 offset:33792
    v_mfma_f32_32x32x16_bf16 v[148:163], v[108:111], v[68:71], v[148:163]
    ds_read_b64_tr_b16 v[92:93], v27 offset:32768
    ds_read_b64_tr_b16 v[94:95], v27 offset:33792
    ds_read_b64_tr_b16 v[96:97], v28 offset:32768
    ds_read_b64_tr_b16 v[98:99], v28 offset:33792
    v_mfma_f32_32x32x16_bf16 v[164:179], v[112:115], v[68:71], v[164:179]
    ds_read_b64_tr_b16 v[100:101], v29 offset:32768
    ds_read_b64_tr_b16 v[102:103], v29 offset:33792
    ds_read_b64_tr_b16 v[124:125], v31 offset:32768
    ds_read_b64_tr_b16 v[126:127], v31 offset:33792
    v_mfma_f32_32x32x16_bf16 v[180:195], v[116:119], v[68:71], v[180:195]
    v_lshlrev_b32 v204, 16, v128
    v_and_b32 v205, 0xffff0000, v128
    v_lshlrev_b32 v206, 16, v129
    v_and_b32 v207, 0xffff0000, v129
    v_lshlrev_b32 v208, 16, v130
    v_and_b32 v209, 0xffff0000, v130
    v_lshlrev_b32 v210, 16, v131
    v_and_b32 v211, 0xffff0000, v131
    v_pk_add_f32 v[244:245], v[244:245], v[204:205]
    v_pk_add_f32 v[244:245], v[244:245], v[206:207]
    v_pk_add_f32 v[244:245], v[244:245], v[208:209]
    v_pk_add_f32 v[244:245], v[244:245], v[210:211]
    s_waitcnt lgkmcnt(11)
    v_mfma_f32_32x32x16_bf16 v[132:147], v[72:75], v[60:63], v[132:147]
    ds_read_b128 v[68:71], v19 offset:32768
    ds_read_b64_tr_b16 v[104:105], v26 offset:36864
    ds_read_b64_tr_b16 v[106:107], v26 offset:37888
    v_mfma_f32_32x32x16_bf16 v[148:163], v[76:79], v[60:63], v[148:163]
    ds_read_b64_tr_b16 v[108:109], v27 offset:36864
    ds_read_b64_tr_b16 v[110:111], v27 offset:37888
    ds_read_b64_tr_b16 v[112:113], v28 offset:36864
    ds_read_b64_tr_b16 v[114:115], v28 offset:37888
    v_mfma_f32_32x32x16_bf16 v[164:179], v[80:83], v[60:63], v[164:179]
    ds_read_b64_tr_b16 v[116:117], v29 offset:36864
    ds_read_b64_tr_b16 v[118:119], v29 offset:37888
    ds_read_b64_tr_b16 v[128:129], v31 offset:36864
    ds_read_b64_tr_b16 v[130:131], v31 offset:37888
    v_mfma_f32_32x32x16_bf16 v[180:195], v[84:87], v[60:63], v[180:195]
    v_lshlrev_b32 v204, 16, v120
    v_and_b32 v205, 0xffff0000, v120
    v_lshlrev_b32 v206, 16, v121
    v_and_b32 v207, 0xffff0000, v121
    v_lshlrev_b32 v208, 16, v122
    v_and_b32 v209, 0xffff0000, v122
    v_lshlrev_b32 v210, 16, v123
    v_and_b32 v211, 0xffff0000, v123
    v_pk_add_f32 v[244:245], v[244:245], v[204:205]
    v_pk_add_f32 v[244:245], v[244:245], v[206:207]
    v_pk_add_f32 v[244:245], v[244:245], v[208:209]
    v_pk_add_f32 v[244:245], v[244:245], v[210:211]
    s_waitcnt lgkmcnt(11)
    v_mfma_f32_32x32x16_bf16 v[132:147], v[88:91], v[64:67], v[132:147]
    ds_read_b128 v[60:63], v20 offset:32768
    ds_read_b64_tr_b16 v[72:73], v26 offset:40960
    ds_read_b64_tr_b16 v[74:75], v26 offset:41984
    v_mfma_f32_32x32x16_bf16 v[148:163], v[92:95], v[64:67], v[148:163]
    ds_read_b64_tr_b16 v[76:77], v27 offset:40960
    ds_read_b64_tr_b16 v[78:79], v27 offset:41984
    ds_read_b64_tr_b16 v[80:81], v28 offset:40960
    ds_read_b64_tr_b16 v[82:83], v28 offset:41984
    v_mfma_f32_32x32x16_bf16 v[164:179], v[96:99], v[64:67], v[164:179]
    ds_read_b64_tr_b16 v[84:85], v29 offset:40960
    ds_read_b64_tr_b16 v[86:87], v29 offset:41984
    ds_read_b64_tr_b16 v[120:121], v31 offset:40960
    ds_read_b64_tr_b16 v[122:123], v31 offset:41984
    v_mfma_f32_32x32x16_bf16 v[180:195], v[100:103], v[64:67], v[180:195]
    v_lshlrev_b32 v204, 16, v124
    v_and_b32 v205, 0xffff0000, v124
    v_lshlrev_b32 v206, 16, v125
    v_and_b32 v207, 0xffff0000, v125
    v_lshlrev_b32 v208, 16, v126
    v_and_b32 v209, 0xffff0000, v126
    v_lshlrev_b32 v210, 16, v127
    v_and_b32 v211, 0xffff0000, v127
    v_pk_add_f32 v[244:245], v[244:245], v[204:205]
    v_pk_add_f32 v[244:245], v[244:245], v[206:207]
    v_pk_add_f32 v[244:245], v[244:245], v[208:209]
    v_pk_add_f32 v[244:245], v[244:245], v[210:211]
    s_waitcnt lgkmcnt(11)
    v_mfma_f32_32x32x16_bf16 v[132:147], v[104:107], v[68:71], v[132:147]
    ds_read_b128 v[64:67], v21 offset:32768
    ds_read_b64_tr_b16 v[88:89], v26 offset:45056
    ds_read_b64_tr_b16 v[90:91], v26 offset:46080
    v_mfma_f32_32x32x16_bf16 v[148:163], v[108:111], v[68:71], v[148:163]
    ds_read_b64_tr_b16 v[92:93], v27 offset:45056
    ds_read_b64_tr_b16 v[94:95], v27 offset:46080
    ds_read_b64_tr_b16 v[96:97], v28 offset:45056
    ds_read_b64_tr_b16 v[98:99], v28 offset:46080
    v_mfma_f32_32x32x16_bf16 v[164:179], v[112:115], v[68:71], v[164:179]
    ds_read_b64_tr_b16 v[100:101], v29 offset:45056
    ds_read_b64_tr_b16 v[102:103], v29 offset:46080
    ds_read_b64_tr_b16 v[124:125], v31 offset:45056
    ds_read_b64_tr_b16 v[126:127], v31 offset:46080
    v_mfma_f32_32x32x16_bf16 v[180:195], v[116:119], v[68:71], v[180:195]
    v_lshlrev_b32 v204, 16, v128
    v_and_b32 v205, 0xffff0000, v128
    v_lshlrev_b32 v206, 16, v129
    v_and_b32 v207, 0xffff0000, v129
    v_lshlrev_b32 v208, 16, v130
    v_and_b32 v209, 0xffff0000, v130
    v_lshlrev_b32 v210, 16, v131
    v_and_b32 v211, 0xffff0000, v131
    v_pk_add_f32 v[244:245], v[244:245], v[204:205]
    v_pk_add_f32 v[244:245], v[244:245], v[206:207]
    v_pk_add_f32 v[244:245], v[244:245], v[208:209]
    v_pk_add_f32 v[244:245], v[244:245], v[210:211]
    s_waitcnt lgkmcnt(11)
    v_mfma_f32_32x32x16_bf16 v[132:147], v[72:75], v[60:63], v[132:147]
    v_lshlrev_b32 v204, 16, v120
    v_and_b32 v205, 0xffff0000, v120
    v_lshlrev_b32 v206, 16, v121
    v_and_b32 v207, 0xffff0000, v121
    v_lshlrev_b32 v208, 16, v122
    v_and_b32 v209, 0xffff0000, v122
    v_lshlrev_b32 v210, 16, v123
    v_and_b32 v211, 0xffff0000, v123
    v_mfma_f32_32x32x16_bf16 v[148:163], v[76:79], v[60:63], v[148:163]
    v_mfma_f32_32x32x16_bf16 v[164:179], v[80:83], v[60:63], v[164:179]
    v_pk_add_f32 v[244:245], v[244:245], v[204:205]
    v_pk_add_f32 v[244:245], v[244:245], v[206:207]
    v_pk_add_f32 v[244:245], v[244:245], v[208:209]
    v_pk_add_f32 v[244:245], v[244:245], v[210:211]
    v_mfma_f32_32x32x16_bf16 v[180:195], v[84:87], v[60:63], v[180:195]
    s_waitcnt lgkmcnt(0)
    v_mfma_f32_32x32x16_bf16 v[132:147], v[88:91], v[64:67], v[132:147]
    v_lshlrev_b32 v204, 16, v124
    v_and_b32 v205, 0xffff0000, v124
    v_lshlrev_b32 v206, 16, v125
    v_and_b32 v207, 0xffff0000, v125
    v_lshlrev_b32 v208, 16, v126
    v_and_b32 v209, 0xffff0000, v126
    v_lshlrev_b32 v210, 16, v127
    v_and_b32 v211, 0xffff0000, v127
    v_mfma_f32_32x32x16_bf16 v[148:163], v[92:95], v[64:67], v[148:163]
    v_mfma_f32_32x32x16_bf16 v[164:179], v[96:99], v[64:67], v[164:179]
    v_pk_add_f32 v[244:245], v[244:245], v[204:205]
    v_pk_add_f32 v[244:245], v[244:245], v[206:207]
    v_pk_add_f32 v[244:245], v[244:245], v[208:209]
    v_pk_add_f32 v[244:245], v[244:245], v[210:211]
    v_mfma_f32_32x32x16_bf16 v[180:195], v[100:103], v[64:67], v[180:195]
    s_waitcnt vmcnt(0)
    v_pk_add_f32 v[44:45], v[44:45], v[46:47]
    v_pk_add_f32 v[48:49], v[48:49], v[50:51]
    v_pk_add_f32 v[52:53], v[52:53], v[54:55]
    v_pk_add_f32 v[56:57], v[56:57], v[58:59]
    v_pk_add_f32 v[44:45], v[44:45], v[48:49]
    v_pk_add_f32 v[52:53], v[52:53], v[56:57]
    v_pk_add_f32 v[44:45], v[44:45], v[52:53]
    v_mov_b32 v33, v44
    v_mov_b32 v34, v45
    v_mov_b32 v2, v33
    s_nop 1
    v_permlane32_swap_b32 v33, v2
    v_add_f32 v33, v33, v2
    v_mov_b32 v2, v34
    s_nop 1
    v_permlane32_swap_b32 v34, v2
    v_add_f32 v34, v34, v2
    v_add_f32 v35, v244, v245
    v_mov_b32 v2, v35
    s_nop 1
    v_permlane32_swap_b32 v35, v2
    v_add_f32 v35, v35, v2
    v_and_b32 v2, 31, v1
    v_lshlrev_b32 v2, 2, v2
    s_min_u32 s23, s3, 3
    s_lshl_b32 s23, s23, 7
    s_lshl_b32 s22, s21, 9
    s_add_u32 s23, s23, s22
    s_add_u32 s23, s23, 15736832
    buffer_store_dword v35, v2, s[12:15], s23 offen
    v_mul_f32 v37, 0x3b000000, v33
    v_mul_f32 v2, 0x3b000000, v34
    v_fma_f32 v2, -v37, v37, v2
    v_max_f32 v2, 0, v2
    v_cvt_pk_bf16_f32 v3, v2, v2
    v_and_b32 v2, 0xffff0000, v3
    v_add_f32 v2, 0x3727c5ac, v2
    v_cvt_pk_bf16_f32 v3, v2, v2
    v_and_b32 v2, 0xffff0000, v3
    v_sqrt_f32 v2, v2
    s_nop 0
    v_cvt_pk_bf16_f32 v3, v2, v2
    v_and_b32 v2, 0xffff0000, v3
    v_rcp_f32 v38, v2
    v_cvt_pk_bf16_f32 v3, v37, v37
    v_and_b32 v37, 0xffff0000, v3
    v_mov_b32 v39, v38
    v_mul_f32 v40, v37, v38
    v_sub_f32 v40, 0, v40
    v_mov_b32 v41, v40
    v_and_b32 v2, 31, v1
    v_lshlrev_b32 v2, 2, v2
    s_lshl_b32 s22, s3, 7
    v_add_u32 v3, s22, v2
    v_add_u32 v3, 131072, v3
    ds_write_b32 v3, v35
    v_lshlrev_b32 v36, 16, v36
    ds_write_b32 v3, v36 offset:512
    s_waitcnt lgkmcnt(0)
    s_barrier
    v_lshrrev_b32 v5, 5, v1
    v_lshlrev_b32 v5, 4, v5
    v_add_u32 v5, 131072, v5
    s_lshl_b32 s22, s20, 2
    s_add_u32 s22, s22, s3
    s_mul_i32 s22, s22, 114688
    s_lshl_b32 s23, s21, 13
    s_add_u32 s22, s22, s23
    s_add_u32 s25, s22, 16777216
    s_add_u32 s24, s25, 4096
    v_lshlrev_b32 v34, 4, v1
    ds_read_b128 v[196:199], v5 offset:0
    ds_read_b128 v[212:215], v5 offset:512
    ds_read_b128 v[200:203], v5 offset:32
    ds_read_b128 v[216:219], v5 offset:544
    ds_read_b128 v[204:207], v5 offset:64
    ds_read_b128 v[220:223], v5 offset:576
    ds_read_b128 v[208:211], v5 offset:96
    ds_read_b128 v[224:227], v5 offset:608
    s_waitcnt lgkmcnt(0)
    v_pk_fma_f32 v[196:197], v[196:197], v[40:41], v[212:213]
    v_pk_fma_f32 v[198:199], v[198:199], v[40:41], v[214:215]
    v_pk_fma_f32 v[200:201], v[200:201], v[40:41], v[216:217]
    v_pk_fma_f32 v[202:203], v[202:203], v[40:41], v[218:219]
    v_pk_fma_f32 v[204:205], v[204:205], v[40:41], v[220:221]
    v_pk_fma_f32 v[206:207], v[206:207], v[40:41], v[222:223]
    v_pk_fma_f32 v[208:209], v[208:209], v[40:41], v[224:225]
    v_pk_fma_f32 v[210:211], v[210:211], v[40:41], v[226:227]
    v_pk_fma_f32 v[132:133], v[132:133], v[38:39], v[196:197]
    v_pk_fma_f32 v[134:135], v[134:135], v[38:39], v[198:199]
    v_pk_fma_f32 v[136:137], v[136:137], v[38:39], v[200:201]
    v_pk_fma_f32 v[138:139], v[138:139], v[38:39], v[202:203]
    v_pk_fma_f32 v[140:141], v[140:141], v[38:39], v[204:205]
    v_pk_fma_f32 v[142:143], v[142:143], v[38:39], v[206:207]
    v_pk_fma_f32 v[144:145], v[144:145], v[38:39], v[208:209]
    v_pk_fma_f32 v[146:147], v[146:147], v[38:39], v[210:211]
    v_pk_mul_f32 v[228:229], v[132:133], s[38:39]
    v_pk_mul_f32 v[230:231], v[134:135], s[38:39]
    v_pk_mul_f32 v[232:233], v[136:137], s[38:39]
    v_pk_mul_f32 v[234:235], v[138:139], s[38:39]
    v_pk_mul_f32 v[236:237], v[140:141], s[38:39]
    v_pk_mul_f32 v[238:239], v[142:143], s[38:39]
    v_pk_mul_f32 v[240:241], v[144:145], s[38:39]
    v_pk_mul_f32 v[242:243], v[146:147], s[38:39]
    v_min_f32 v228, 0x41e6d4ca, v228
    v_min_f32 v229, 0x41e6d4ca, v229
    v_min_f32 v230, 0x41e6d4ca, v230
    v_min_f32 v231, 0x41e6d4ca, v231
    v_min_f32 v232, 0x41e6d4ca, v232
    v_min_f32 v233, 0x41e6d4ca, v233
    v_min_f32 v234, 0x41e6d4ca, v234
    v_min_f32 v235, 0x41e6d4ca, v235
    v_min_f32 v236, 0x41e6d4ca, v236
    v_min_f32 v237, 0x41e6d4ca, v237
    v_min_f32 v238, 0x41e6d4ca, v238
    v_min_f32 v239, 0x41e6d4ca, v239
    v_min_f32 v240, 0x41e6d4ca, v240
    v_min_f32 v241, 0x41e6d4ca, v241
    v_min_f32 v242, 0x41e6d4ca, v242
    v_min_f32 v243, 0x41e6d4ca, v243
    v_exp_f32 v228, v228
    v_exp_f32 v229, v229
    v_exp_f32 v230, v230
    v_exp_f32 v231, v231
    v_exp_f32 v232, v232
    v_exp_f32 v233, v233
    v_exp_f32 v234, v234
    v_exp_f32 v235, v235
    v_exp_f32 v236, v236
    v_exp_f32 v237, v237
    v_exp_f32 v238, v238
    v_exp_f32 v239, v239
    v_exp_f32 v240, v240
    v_exp_f32 v241, v241
    v_exp_f32 v242, v242
    v_exp_f32 v243, v243
    v_pk_add_f32 v[72:73], v[228:229], s[36:37]
    v_pk_add_f32 v[74:75], v[230:231], s[36:37]
    v_pk_add_f32 v[76:77], v[232:233], s[36:37]
    v_pk_add_f32 v[78:79], v[234:235], s[36:37]
    v_pk_add_f32 v[80:81], v[236:237], s[36:37]
    v_pk_add_f32 v[82:83], v[238:239], s[36:37]
    v_pk_add_f32 v[84:85], v[240:241], s[36:37]
    v_pk_add_f32 v[86:87], v[242:243], s[36:37]
    v_pk_mul_f32 v[228:229], v[228:229], v[72:73]
    v_pk_mul_f32 v[230:231], v[230:231], v[74:75]
    v_pk_mul_f32 v[232:233], v[232:233], v[76:77]
    v_pk_mul_f32 v[234:235], v[234:235], v[78:79]
    v_pk_mul_f32 v[236:237], v[236:237], v[80:81]
    v_pk_mul_f32 v[238:239], v[238:239], v[82:83]
    v_pk_mul_f32 v[240:241], v[240:241], v[84:85]
    v_pk_mul_f32 v[242:243], v[242:243], v[86:87]
    v_pk_add_f32 v[72:73], v[228:229], s[36:37]
    v_pk_add_f32 v[74:75], v[230:231], s[36:37]
    v_pk_add_f32 v[76:77], v[232:233], s[36:37]
    v_pk_add_f32 v[78:79], v[234:235], s[36:37]
    v_pk_add_f32 v[80:81], v[236:237], s[36:37]
    v_pk_add_f32 v[82:83], v[238:239], s[36:37]
    v_pk_add_f32 v[84:85], v[240:241], s[36:37]
    v_pk_add_f32 v[86:87], v[242:243], s[36:37]
    v_rcp_f32 v72, v72
    v_rcp_f32 v73, v73
    v_rcp_f32 v74, v74
    v_rcp_f32 v75, v75
    v_rcp_f32 v76, v76
    v_rcp_f32 v77, v77
    v_rcp_f32 v78, v78
    v_rcp_f32 v79, v79
    v_rcp_f32 v80, v80
    v_rcp_f32 v81, v81
    v_rcp_f32 v82, v82
    v_rcp_f32 v83, v83
    v_rcp_f32 v84, v84
    v_rcp_f32 v85, v85
    v_rcp_f32 v86, v86
    v_rcp_f32 v87, v87
    v_pk_mul_f32 v[132:133], v[132:133], v[228:229]
    v_pk_mul_f32 v[134:135], v[134:135], v[230:231]
    v_pk_mul_f32 v[136:137], v[136:137], v[232:233]
    v_pk_mul_f32 v[138:139], v[138:139], v[234:235]
    v_pk_mul_f32 v[140:141], v[140:141], v[236:237]
    v_pk_mul_f32 v[142:143], v[142:143], v[238:239]
    v_pk_mul_f32 v[144:145], v[144:145], v[240:241]
    v_pk_mul_f32 v[146:147], v[146:147], v[242:243]
    v_pk_mul_f32 v[132:133], v[132:133], v[72:73]
    v_pk_mul_f32 v[134:135], v[134:135], v[74:75]
    v_pk_mul_f32 v[136:137], v[136:137], v[76:77]
    v_pk_mul_f32 v[138:139], v[138:139], v[78:79]
    v_pk_mul_f32 v[140:141], v[140:141], v[80:81]
    v_pk_mul_f32 v[142:143], v[142:143], v[82:83]
    v_pk_mul_f32 v[144:145], v[144:145], v[84:85]
    v_pk_mul_f32 v[146:147], v[146:147], v[86:87]
    v_cvt_pk_bf16_f32 v244, v132, v133
    v_cvt_pk_bf16_f32 v245, v134, v135
    v_cvt_pk_bf16_f32 v246, v136, v137
    v_cvt_pk_bf16_f32 v247, v138, v139
    v_cvt_pk_bf16_f32 v248, v140, v141
    v_cvt_pk_bf16_f32 v249, v142, v143
    v_cvt_pk_bf16_f32 v250, v144, v145
    v_cvt_pk_bf16_f32 v251, v146, v147
    s_nop 0
    v_permlane32_swap_b32 v244, v246
    v_permlane32_swap_b32 v245, v247
    buffer_store_dwordx4 v[244:247], v34, s[12:15], s25 offen offset:0
    v_permlane32_swap_b32 v248, v250
    v_permlane32_swap_b32 v249, v251
    buffer_store_dwordx4 v[248:251], v34, s[12:15], s25 offen offset:1024
    ds_read_b128 v[196:199], v5 offset:128
    ds_read_b128 v[212:215], v5 offset:640
    ds_read_b128 v[200:203], v5 offset:160
    ds_read_b128 v[216:219], v5 offset:672
    ds_read_b128 v[204:207], v5 offset:192
    ds_read_b128 v[220:223], v5 offset:704
    ds_read_b128 v[208:211], v5 offset:224
    ds_read_b128 v[224:227], v5 offset:736
    s_waitcnt lgkmcnt(0)
    v_pk_fma_f32 v[196:197], v[196:197], v[40:41], v[212:213]
    v_pk_fma_f32 v[198:199], v[198:199], v[40:41], v[214:215]
    v_pk_fma_f32 v[200:201], v[200:201], v[40:41], v[216:217]
    v_pk_fma_f32 v[202:203], v[202:203], v[40:41], v[218:219]
    v_pk_fma_f32 v[204:205], v[204:205], v[40:41], v[220:221]
    v_pk_fma_f32 v[206:207], v[206:207], v[40:41], v[222:223]
    v_pk_fma_f32 v[208:209], v[208:209], v[40:41], v[224:225]
    v_pk_fma_f32 v[210:211], v[210:211], v[40:41], v[226:227]
    v_pk_fma_f32 v[148:149], v[148:149], v[38:39], v[196:197]
    v_pk_fma_f32 v[150:151], v[150:151], v[38:39], v[198:199]
    v_pk_fma_f32 v[152:153], v[152:153], v[38:39], v[200:201]
    v_pk_fma_f32 v[154:155], v[154:155], v[38:39], v[202:203]
    v_pk_fma_f32 v[156:157], v[156:157], v[38:39], v[204:205]
    v_pk_fma_f32 v[158:159], v[158:159], v[38:39], v[206:207]
    v_pk_fma_f32 v[160:161], v[160:161], v[38:39], v[208:209]
    v_pk_fma_f32 v[162:163], v[162:163], v[38:39], v[210:211]
    v_pk_mul_f32 v[228:229], v[148:149], s[38:39]
    v_pk_mul_f32 v[230:231], v[150:151], s[38:39]
    v_pk_mul_f32 v[232:233], v[152:153], s[38:39]
    v_pk_mul_f32 v[234:235], v[154:155], s[38:39]
    v_pk_mul_f32 v[236:237], v[156:157], s[38:39]
    v_pk_mul_f32 v[238:239], v[158:159], s[38:39]
    v_pk_mul_f32 v[240:241], v[160:161], s[38:39]
    v_pk_mul_f32 v[242:243], v[162:163], s[38:39]
    v_min_f32 v228, 0x41e6d4ca, v228
    v_min_f32 v229, 0x41e6d4ca, v229
    v_min_f32 v230, 0x41e6d4ca, v230
    v_min_f32 v231, 0x41e6d4ca, v231
    v_min_f32 v232, 0x41e6d4ca, v232
    v_min_f32 v233, 0x41e6d4ca, v233
    v_min_f32 v234, 0x41e6d4ca, v234
    v_min_f32 v235, 0x41e6d4ca, v235
    v_min_f32 v236, 0x41e6d4ca, v236
    v_min_f32 v237, 0x41e6d4ca, v237
    v_min_f32 v238, 0x41e6d4ca, v238
    v_min_f32 v239, 0x41e6d4ca, v239
    v_min_f32 v240, 0x41e6d4ca, v240
    v_min_f32 v241, 0x41e6d4ca, v241
    v_min_f32 v242, 0x41e6d4ca, v242
    v_min_f32 v243, 0x41e6d4ca, v243
    v_exp_f32 v228, v228
    v_exp_f32 v229, v229
    v_exp_f32 v230, v230
    v_exp_f32 v231, v231
    v_exp_f32 v232, v232
    v_exp_f32 v233, v233
    v_exp_f32 v234, v234
    v_exp_f32 v235, v235
    v_exp_f32 v236, v236
    v_exp_f32 v237, v237
    v_exp_f32 v238, v238
    v_exp_f32 v239, v239
    v_exp_f32 v240, v240
    v_exp_f32 v241, v241
    v_exp_f32 v242, v242
    v_exp_f32 v243, v243
    v_pk_add_f32 v[72:73], v[228:229], s[36:37]
    v_pk_add_f32 v[74:75], v[230:231], s[36:37]
    v_pk_add_f32 v[76:77], v[232:233], s[36:37]
    v_pk_add_f32 v[78:79], v[234:235], s[36:37]
    v_pk_add_f32 v[80:81], v[236:237], s[36:37]
    v_pk_add_f32 v[82:83], v[238:239], s[36:37]
    v_pk_add_f32 v[84:85], v[240:241], s[36:37]
    v_pk_add_f32 v[86:87], v[242:243], s[36:37]
    v_pk_mul_f32 v[228:229], v[228:229], v[72:73]
    v_pk_mul_f32 v[230:231], v[230:231], v[74:75]
    v_pk_mul_f32 v[232:233], v[232:233], v[76:77]
    v_pk_mul_f32 v[234:235], v[234:235], v[78:79]
    v_pk_mul_f32 v[236:237], v[236:237], v[80:81]
    v_pk_mul_f32 v[238:239], v[238:239], v[82:83]
    v_pk_mul_f32 v[240:241], v[240:241], v[84:85]
    v_pk_mul_f32 v[242:243], v[242:243], v[86:87]
    v_pk_add_f32 v[72:73], v[228:229], s[36:37]
    v_pk_add_f32 v[74:75], v[230:231], s[36:37]
    v_pk_add_f32 v[76:77], v[232:233], s[36:37]
    v_pk_add_f32 v[78:79], v[234:235], s[36:37]
    v_pk_add_f32 v[80:81], v[236:237], s[36:37]
    v_pk_add_f32 v[82:83], v[238:239], s[36:37]
    v_pk_add_f32 v[84:85], v[240:241], s[36:37]
    v_pk_add_f32 v[86:87], v[242:243], s[36:37]
    v_rcp_f32 v72, v72
    v_rcp_f32 v73, v73
    v_rcp_f32 v74, v74
    v_rcp_f32 v75, v75
    v_rcp_f32 v76, v76
    v_rcp_f32 v77, v77
    v_rcp_f32 v78, v78
    v_rcp_f32 v79, v79
    v_rcp_f32 v80, v80
    v_rcp_f32 v81, v81
    v_rcp_f32 v82, v82
    v_rcp_f32 v83, v83
    v_rcp_f32 v84, v84
    v_rcp_f32 v85, v85
    v_rcp_f32 v86, v86
    v_rcp_f32 v87, v87
    v_pk_mul_f32 v[148:149], v[148:149], v[228:229]
    v_pk_mul_f32 v[150:151], v[150:151], v[230:231]
    v_pk_mul_f32 v[152:153], v[152:153], v[232:233]
    v_pk_mul_f32 v[154:155], v[154:155], v[234:235]
    v_pk_mul_f32 v[156:157], v[156:157], v[236:237]
    v_pk_mul_f32 v[158:159], v[158:159], v[238:239]
    v_pk_mul_f32 v[160:161], v[160:161], v[240:241]
    v_pk_mul_f32 v[162:163], v[162:163], v[242:243]
    v_pk_mul_f32 v[148:149], v[148:149], v[72:73]
    v_pk_mul_f32 v[150:151], v[150:151], v[74:75]
    v_pk_mul_f32 v[152:153], v[152:153], v[76:77]
    v_pk_mul_f32 v[154:155], v[154:155], v[78:79]
    v_pk_mul_f32 v[156:157], v[156:157], v[80:81]
    v_pk_mul_f32 v[158:159], v[158:159], v[82:83]
    v_pk_mul_f32 v[160:161], v[160:161], v[84:85]
    v_pk_mul_f32 v[162:163], v[162:163], v[86:87]
    v_cvt_pk_bf16_f32 v60, v148, v149
    v_cvt_pk_bf16_f32 v61, v150, v151
    v_cvt_pk_bf16_f32 v62, v152, v153
    v_cvt_pk_bf16_f32 v63, v154, v155
    v_cvt_pk_bf16_f32 v64, v156, v157
    v_cvt_pk_bf16_f32 v65, v158, v159
    v_cvt_pk_bf16_f32 v66, v160, v161
    v_cvt_pk_bf16_f32 v67, v162, v163
    s_nop 0
    v_permlane32_swap_b32 v60, v62
    v_permlane32_swap_b32 v61, v63
    buffer_store_dwordx4 v[60:63], v34, s[12:15], s25 offen offset:2048
    v_permlane32_swap_b32 v64, v66
    v_permlane32_swap_b32 v65, v67
    buffer_store_dwordx4 v[64:67], v34, s[12:15], s25 offen offset:3072
    ds_read_b128 v[196:199], v5 offset:256
    ds_read_b128 v[212:215], v5 offset:768
    ds_read_b128 v[200:203], v5 offset:288
    ds_read_b128 v[216:219], v5 offset:800
    ds_read_b128 v[204:207], v5 offset:320
    ds_read_b128 v[220:223], v5 offset:832
    ds_read_b128 v[208:211], v5 offset:352
    ds_read_b128 v[224:227], v5 offset:864
    s_waitcnt lgkmcnt(0)
    v_pk_fma_f32 v[196:197], v[196:197], v[40:41], v[212:213]
    v_pk_fma_f32 v[198:199], v[198:199], v[40:41], v[214:215]
    v_pk_fma_f32 v[200:201], v[200:201], v[40:41], v[216:217]
    v_pk_fma_f32 v[202:203], v[202:203], v[40:41], v[218:219]
    v_pk_fma_f32 v[204:205], v[204:205], v[40:41], v[220:221]
    v_pk_fma_f32 v[206:207], v[206:207], v[40:41], v[222:223]
    v_pk_fma_f32 v[208:209], v[208:209], v[40:41], v[224:225]
    v_pk_fma_f32 v[210:211], v[210:211], v[40:41], v[226:227]
    v_pk_fma_f32 v[164:165], v[164:165], v[38:39], v[196:197]
    v_pk_fma_f32 v[166:167], v[166:167], v[38:39], v[198:199]
    v_pk_fma_f32 v[168:169], v[168:169], v[38:39], v[200:201]
    v_pk_fma_f32 v[170:171], v[170:171], v[38:39], v[202:203]
    v_pk_fma_f32 v[172:173], v[172:173], v[38:39], v[204:205]
    v_pk_fma_f32 v[174:175], v[174:175], v[38:39], v[206:207]
    v_pk_fma_f32 v[176:177], v[176:177], v[38:39], v[208:209]
    v_pk_fma_f32 v[178:179], v[178:179], v[38:39], v[210:211]
    v_pk_mul_f32 v[228:229], v[164:165], s[38:39]
    v_pk_mul_f32 v[230:231], v[166:167], s[38:39]
    v_pk_mul_f32 v[232:233], v[168:169], s[38:39]
    v_pk_mul_f32 v[234:235], v[170:171], s[38:39]
    v_pk_mul_f32 v[236:237], v[172:173], s[38:39]
    v_pk_mul_f32 v[238:239], v[174:175], s[38:39]
    v_pk_mul_f32 v[240:241], v[176:177], s[38:39]
    v_pk_mul_f32 v[242:243], v[178:179], s[38:39]
    v_min_f32 v228, 0x41e6d4ca, v228
    v_min_f32 v229, 0x41e6d4ca, v229
    v_min_f32 v230, 0x41e6d4ca, v230
    v_min_f32 v231, 0x41e6d4ca, v231
    v_min_f32 v232, 0x41e6d4ca, v232
    v_min_f32 v233, 0x41e6d4ca, v233
    v_min_f32 v234, 0x41e6d4ca, v234
    v_min_f32 v235, 0x41e6d4ca, v235
    v_min_f32 v236, 0x41e6d4ca, v236
    v_min_f32 v237, 0x41e6d4ca, v237
    v_min_f32 v238, 0x41e6d4ca, v238
    v_min_f32 v239, 0x41e6d4ca, v239
    v_min_f32 v240, 0x41e6d4ca, v240
    v_min_f32 v241, 0x41e6d4ca, v241
    v_min_f32 v242, 0x41e6d4ca, v242
    v_min_f32 v243, 0x41e6d4ca, v243
    v_exp_f32 v228, v228
    v_exp_f32 v229, v229
    v_exp_f32 v230, v230
    v_exp_f32 v231, v231
    v_exp_f32 v232, v232
    v_exp_f32 v233, v233
    v_exp_f32 v234, v234
    v_exp_f32 v235, v235
    v_exp_f32 v236, v236
    v_exp_f32 v237, v237
    v_exp_f32 v238, v238
    v_exp_f32 v239, v239
    v_exp_f32 v240, v240
    v_exp_f32 v241, v241
    v_exp_f32 v242, v242
    v_exp_f32 v243, v243
    v_pk_add_f32 v[72:73], v[228:229], s[36:37]
    v_pk_add_f32 v[74:75], v[230:231], s[36:37]
    v_pk_add_f32 v[76:77], v[232:233], s[36:37]
    v_pk_add_f32 v[78:79], v[234:235], s[36:37]
    v_pk_add_f32 v[80:81], v[236:237], s[36:37]
    v_pk_add_f32 v[82:83], v[238:239], s[36:37]
    v_pk_add_f32 v[84:85], v[240:241], s[36:37]
    v_pk_add_f32 v[86:87], v[242:243], s[36:37]
    v_pk_mul_f32 v[228:229], v[228:229], v[72:73]
    v_pk_mul_f32 v[230:231], v[230:231], v[74:75]
    v_pk_mul_f32 v[232:233], v[232:233], v[76:77]
    v_pk_mul_f32 v[234:235], v[234:235], v[78:79]
    v_pk_mul_f32 v[236:237], v[236:237], v[80:81]
    v_pk_mul_f32 v[238:239], v[238:239], v[82:83]
    v_pk_mul_f32 v[240:241], v[240:241], v[84:85]
    v_pk_mul_f32 v[242:243], v[242:243], v[86:87]
    v_pk_add_f32 v[72:73], v[228:229], s[36:37]
    v_pk_add_f32 v[74:75], v[230:231], s[36:37]
    v_pk_add_f32 v[76:77], v[232:233], s[36:37]
    v_pk_add_f32 v[78:79], v[234:235], s[36:37]
    v_pk_add_f32 v[80:81], v[236:237], s[36:37]
    v_pk_add_f32 v[82:83], v[238:239], s[36:37]
    v_pk_add_f32 v[84:85], v[240:241], s[36:37]
    v_pk_add_f32 v[86:87], v[242:243], s[36:37]
    v_rcp_f32 v72, v72
    v_rcp_f32 v73, v73
    v_rcp_f32 v74, v74
    v_rcp_f32 v75, v75
    v_rcp_f32 v76, v76
    v_rcp_f32 v77, v77
    v_rcp_f32 v78, v78
    v_rcp_f32 v79, v79
    v_rcp_f32 v80, v80
    v_rcp_f32 v81, v81
    v_rcp_f32 v82, v82
    v_rcp_f32 v83, v83
    v_rcp_f32 v84, v84
    v_rcp_f32 v85, v85
    v_rcp_f32 v86, v86
    v_rcp_f32 v87, v87
    v_pk_mul_f32 v[164:165], v[164:165], v[228:229]
    v_pk_mul_f32 v[166:167], v[166:167], v[230:231]
    v_pk_mul_f32 v[168:169], v[168:169], v[232:233]
    v_pk_mul_f32 v[170:171], v[170:171], v[234:235]
    v_pk_mul_f32 v[172:173], v[172:173], v[236:237]
    v_pk_mul_f32 v[174:175], v[174:175], v[238:239]
    v_pk_mul_f32 v[176:177], v[176:177], v[240:241]
    v_pk_mul_f32 v[178:179], v[178:179], v[242:243]
    v_pk_mul_f32 v[164:165], v[164:165], v[72:73]
    v_pk_mul_f32 v[166:167], v[166:167], v[74:75]
    v_pk_mul_f32 v[168:169], v[168:169], v[76:77]
    v_pk_mul_f32 v[170:171], v[170:171], v[78:79]
    v_pk_mul_f32 v[172:173], v[172:173], v[80:81]
    v_pk_mul_f32 v[174:175], v[174:175], v[82:83]
    v_pk_mul_f32 v[176:177], v[176:177], v[84:85]
    v_pk_mul_f32 v[178:179], v[178:179], v[86:87]
    v_cvt_pk_bf16_f32 v244, v164, v165
    v_cvt_pk_bf16_f32 v245, v166, v167
    v_cvt_pk_bf16_f32 v246, v168, v169
    v_cvt_pk_bf16_f32 v247, v170, v171
    v_cvt_pk_bf16_f32 v248, v172, v173
    v_cvt_pk_bf16_f32 v249, v174, v175
    v_cvt_pk_bf16_f32 v250, v176, v177
    v_cvt_pk_bf16_f32 v251, v178, v179
    s_nop 0
    v_permlane32_swap_b32 v244, v246
    v_permlane32_swap_b32 v245, v247
    buffer_store_dwordx4 v[244:247], v34, s[12:15], s24 offen offset:0
    v_permlane32_swap_b32 v248, v250
    v_permlane32_swap_b32 v249, v251
    buffer_store_dwordx4 v[248:251], v34, s[12:15], s24 offen offset:1024
    ds_read_b128 v[196:199], v5 offset:384
    ds_read_b128 v[212:215], v5 offset:896
    ds_read_b128 v[200:203], v5 offset:416
    ds_read_b128 v[216:219], v5 offset:928
    ds_read_b128 v[204:207], v5 offset:448
    ds_read_b128 v[220:223], v5 offset:960
    ds_read_b128 v[208:211], v5 offset:480
    ds_read_b128 v[224:227], v5 offset:992
    s_waitcnt lgkmcnt(0)
    v_pk_fma_f32 v[196:197], v[196:197], v[40:41], v[212:213]
    v_pk_fma_f32 v[198:199], v[198:199], v[40:41], v[214:215]
    v_pk_fma_f32 v[200:201], v[200:201], v[40:41], v[216:217]
    v_pk_fma_f32 v[202:203], v[202:203], v[40:41], v[218:219]
    v_pk_fma_f32 v[204:205], v[204:205], v[40:41], v[220:221]
    v_pk_fma_f32 v[206:207], v[206:207], v[40:41], v[222:223]
    v_pk_fma_f32 v[208:209], v[208:209], v[40:41], v[224:225]
    v_pk_fma_f32 v[210:211], v[210:211], v[40:41], v[226:227]
    v_pk_fma_f32 v[180:181], v[180:181], v[38:39], v[196:197]
    v_pk_fma_f32 v[182:183], v[182:183], v[38:39], v[198:199]
    v_pk_fma_f32 v[184:185], v[184:185], v[38:39], v[200:201]
    v_pk_fma_f32 v[186:187], v[186:187], v[38:39], v[202:203]
    v_pk_fma_f32 v[188:189], v[188:189], v[38:39], v[204:205]
    v_pk_fma_f32 v[190:191], v[190:191], v[38:39], v[206:207]
    v_pk_fma_f32 v[192:193], v[192:193], v[38:39], v[208:209]
    v_pk_fma_f32 v[194:195], v[194:195], v[38:39], v[210:211]
    v_pk_mul_f32 v[228:229], v[180:181], s[38:39]
    v_pk_mul_f32 v[230:231], v[182:183], s[38:39]
    v_pk_mul_f32 v[232:233], v[184:185], s[38:39]
    v_pk_mul_f32 v[234:235], v[186:187], s[38:39]
    v_pk_mul_f32 v[236:237], v[188:189], s[38:39]
    v_pk_mul_f32 v[238:239], v[190:191], s[38:39]
    v_pk_mul_f32 v[240:241], v[192:193], s[38:39]
    v_pk_mul_f32 v[242:243], v[194:195], s[38:39]
    v_min_f32 v228, 0x41e6d4ca, v228
    v_min_f32 v229, 0x41e6d4ca, v229
    v_min_f32 v230, 0x41e6d4ca, v230
    v_min_f32 v231, 0x41e6d4ca, v231
    v_min_f32 v232, 0x41e6d4ca, v232
    v_min_f32 v233, 0x41e6d4ca, v233
    v_min_f32 v234, 0x41e6d4ca, v234
    v_min_f32 v235, 0x41e6d4ca, v235
    v_min_f32 v236, 0x41e6d4ca, v236
    v_min_f32 v237, 0x41e6d4ca, v237
    v_min_f32 v238, 0x41e6d4ca, v238
    v_min_f32 v239, 0x41e6d4ca, v239
    v_min_f32 v240, 0x41e6d4ca, v240
    v_min_f32 v241, 0x41e6d4ca, v241
    v_min_f32 v242, 0x41e6d4ca, v242
    v_min_f32 v243, 0x41e6d4ca, v243
    v_exp_f32 v228, v228
    v_exp_f32 v229, v229
    v_exp_f32 v230, v230
    v_exp_f32 v231, v231
    v_exp_f32 v232, v232
    v_exp_f32 v233, v233
    v_exp_f32 v234, v234
    v_exp_f32 v235, v235
    v_exp_f32 v236, v236
    v_exp_f32 v237, v237
    v_exp_f32 v238, v238
    v_exp_f32 v239, v239
    v_exp_f32 v240, v240
    v_exp_f32 v241, v241
    v_exp_f32 v242, v242
    v_exp_f32 v243, v243
    v_pk_add_f32 v[72:73], v[228:229], s[36:37]
    v_pk_add_f32 v[74:75], v[230:231], s[36:37]
    v_pk_add_f32 v[76:77], v[232:233], s[36:37]
    v_pk_add_f32 v[78:79], v[234:235], s[36:37]
    v_pk_add_f32 v[80:81], v[236:237], s[36:37]
    v_pk_add_f32 v[82:83], v[238:239], s[36:37]
    v_pk_add_f32 v[84:85], v[240:241], s[36:37]
    v_pk_add_f32 v[86:87], v[242:243], s[36:37]
    v_pk_mul_f32 v[228:229], v[228:229], v[72:73]
    v_pk_mul_f32 v[230:231], v[230:231], v[74:75]
    v_pk_mul_f32 v[232:233], v[232:233], v[76:77]
    v_pk_mul_f32 v[234:235], v[234:235], v[78:79]
    v_pk_mul_f32 v[236:237], v[236:237], v[80:81]
    v_pk_mul_f32 v[238:239], v[238:239], v[82:83]
    v_pk_mul_f32 v[240:241], v[240:241], v[84:85]
    v_pk_mul_f32 v[242:243], v[242:243], v[86:87]
    v_pk_add_f32 v[72:73], v[228:229], s[36:37]
    v_pk_add_f32 v[74:75], v[230:231], s[36:37]
    v_pk_add_f32 v[76:77], v[232:233], s[36:37]
    v_pk_add_f32 v[78:79], v[234:235], s[36:37]
    v_pk_add_f32 v[80:81], v[236:237], s[36:37]
    v_pk_add_f32 v[82:83], v[238:239], s[36:37]
    v_pk_add_f32 v[84:85], v[240:241], s[36:37]
    v_pk_add_f32 v[86:87], v[242:243], s[36:37]
    v_rcp_f32 v72, v72
    v_rcp_f32 v73, v73
    v_rcp_f32 v74, v74
    v_rcp_f32 v75, v75
    v_rcp_f32 v76, v76
    v_rcp_f32 v77, v77
    v_rcp_f32 v78, v78
    v_rcp_f32 v79, v79
    v_rcp_f32 v80, v80
    v_rcp_f32 v81, v81
    v_rcp_f32 v82, v82
    v_rcp_f32 v83, v83
    v_rcp_f32 v84, v84
    v_rcp_f32 v85, v85
    v_rcp_f32 v86, v86
    v_rcp_f32 v87, v87
    v_pk_mul_f32 v[180:181], v[180:181], v[228:229]
    v_pk_mul_f32 v[182:183], v[182:183], v[230:231]
    v_pk_mul_f32 v[184:185], v[184:185], v[232:233]
    v_pk_mul_f32 v[186:187], v[186:187], v[234:235]
    v_pk_mul_f32 v[188:189], v[188:189], v[236:237]
    v_pk_mul_f32 v[190:191], v[190:191], v[238:239]
    v_pk_mul_f32 v[192:193], v[192:193], v[240:241]
    v_pk_mul_f32 v[194:195], v[194:195], v[242:243]
    v_pk_mul_f32 v[180:181], v[180:181], v[72:73]
    v_pk_mul_f32 v[182:183], v[182:183], v[74:75]
    v_pk_mul_f32 v[184:185], v[184:185], v[76:77]
    v_pk_mul_f32 v[186:187], v[186:187], v[78:79]
    v_pk_mul_f32 v[188:189], v[188:189], v[80:81]
    v_pk_mul_f32 v[190:191], v[190:191], v[82:83]
    v_pk_mul_f32 v[192:193], v[192:193], v[84:85]
    v_pk_mul_f32 v[194:195], v[194:195], v[86:87]
    v_cvt_pk_bf16_f32 v60, v180, v181
    v_cvt_pk_bf16_f32 v61, v182, v183
    v_cvt_pk_bf16_f32 v62, v184, v185
    v_cvt_pk_bf16_f32 v63, v186, v187
    v_cvt_pk_bf16_f32 v64, v188, v189
    v_cvt_pk_bf16_f32 v65, v190, v191
    v_cvt_pk_bf16_f32 v66, v192, v193
    v_cvt_pk_bf16_f32 v67, v194, v195
    s_nop 0
    v_permlane32_swap_b32 v60, v62
    v_permlane32_swap_b32 v61, v63
    buffer_store_dwordx4 v[60:63], v34, s[12:15], s24 offen offset:2048
    v_permlane32_swap_b32 v64, v66
    v_permlane32_swap_b32 v65, v67
    buffer_store_dwordx4 v[64:67], v34, s[12:15], s24 offen offset:3072
ffa1_kernel_end:
    s_endpgm
.section .rodata,"a"
.p2align 6
.amdhsa_kernel ffa1_kernel
  .amdhsa_next_free_vgpr 256
  .amdhsa_next_free_sgpr 96
  .amdhsa_accum_offset 256
  .amdhsa_group_segment_fixed_size 0
  .amdhsa_kernarg_size 80
  .amdhsa_user_sgpr_count 2
  .amdhsa_user_sgpr_kernarg_segment_ptr 1
  .amdhsa_system_sgpr_workgroup_id_x 1
.end_amdhsa_kernel
.text
.globl ffb1_kernel
.p2align 8
.type ffb1_kernel,@function
ffb1_kernel:
    s_cmp_ge_u32 s2, 256
    s_cbranch_scc1 ffb1_kernel_end
    s_load_dwordx2 s[28:29], s[0:1], 72
    s_load_dwordx2 s[30:31], s[0:1], 48
    s_load_dwordx2 s[32:33], s[0:1], 0
    s_load_dwordx2 s[34:35], s[0:1], 56
    v_and_b32 v1, 63, v0
    v_lshrrev_b32 v2, 6, v0
    s_and_b32 s20, s2, 7
    v_readfirstlane_b32 s44, v2
    s_lshl_b32 s20, s20, 2
    s_bfe_u32 s22, s2, 0x20003
    s_add_u32 s20, s20, s22
    s_lshr_b32 s21, s2, 5
    s_and_b32 s3, s44, 3
    s_cmp_lt_u32 s44, 4
    s_cbranch_scc1 ffb1_kernel_comp
    s_lshl_b32 s22, s20, 1
    s_lshr_b32 s23, s3, 1
    s_add_u32 s22, s22, s23
    s_mul_i32 s22, s22, 114688
    s_and_b32 s23, s3, 1
    s_lshl_b32 s23, s23, 11
    s_add_u32 s22, s22, s23
    v_lshlrev_b32 v6, 4, v1
    v_add_u32 v6, s22, v6
    v_add_u32 v7, 1024, v6
    s_lshl_b32 s26, s3, 11
    s_waitcnt lgkmcnt(0)
    s_add_u32 s4, s28, 0x1000000
    s_addc_u32 s5, s29, 0
    s_and_b32 s5, s5, 0xffff
    s_mov_b32 s6, 0x700000
    s_mov_b32 s7, 0x00020000
    s_add_u32 s8, s28, 0x1b00000
    s_addc_u32 s9, s29, 0
    s_and_b32 s9, s9, 0xffff
    s_mov_b32 s10, 0x1c0000
    s_mov_b32 s11, 0x00020000
    s_mul_i32 s23, s21, 229376
    s_add_u32 s23, s23, s26
    v_lshlrev_b32 v8, 4, v1
    v_add_u32 v8, s23, v8
    v_add_u32 v9, 1024, v8
    s_mov_b32 s24, 0
    s_mov_b32 s25, 0
    s_add_u32 m0, s26, 0
    s_nop 0
    buffer_load_dwordx4 v6, s[4:7], s24 offen lds
    s_add_u32 m0, s26, 1024
    s_nop 0
    buffer_load_dwordx4 v7, s[4:7], s24 offen lds
    s_add_u32 m0, s26, 8192
    s_nop 0
    buffer_load_dwordx4 v8, s[8:11], s25 offen lds
    s_add_u32 m0, s26, 9216
    s_nop 0
    buffer_load_dwordx4 v9, s[8:11], s25 offen lds
    s_mov_b32 s24, 4096
    s_mov_b32 s25, 8192
    s_add_u32 m0, s26, 16384
    s_nop 0
    buffer_load_dwordx4 v6, s[4:7], s24 offen lds
    s_add_u32 m0, s26, 17408
    s_nop 0
    buffer_load_dwordx4 v7, s[4:7], s24 offen lds
    s_add_u32 m0, s26, 24576
    s_nop 0
    buffer_load_dwordx4 v8, s[8:11], s25 offen lds
    s_add_u32 m0, s26, 25600
    s_nop 0
    buffer_load_dwordx4 v9, s[8:11], s25 offen lds
    s_mov_b32 s24, 8192
    s_mov_b32 s25, 16384
    s_add_u32 m0, s26, 32768
    s_nop 0
    buffer_load_dwordx4 v6, s[4:7], s24 offen lds
    s_add_u32 m0, s26, 33792
    s_nop 0
    buffer_load_dwordx4 v7, s[4:7], s24 offen lds
    s_add_u32 m0, s26, 40960
    s_nop 0
    buffer_load_dwordx4 v8, s[8:11], s25 offen lds
    s_add_u32 m0, s26, 41984
    s_nop 0
    buffer_load_dwordx4 v9, s[8:11], s25 offen lds
    s_mov_b32 s24, 12288
    s_mov_b32 s25, 24576
    s_add_u32 m0, s26, 49152
    s_nop 0
    buffer_load_dwordx4 v6, s[4:7], s24 offen lds
    s_add_u32 m0, s26, 50176
    s_nop 0
    buffer_load_dwordx4 v7, s[4:7], s24 offen lds
    s_add_u32 m0, s26, 57344
    s_nop 0
    buffer_load_dwordx4 v8, s[8:11], s25 offen lds
    s_add_u32 m0, s26, 58368
    s_nop 0
    buffer_load_dwordx4 v9, s[8:11], s25 offen lds
    s_mov_b32 s24, 16384
    s_mov_b32 s25, 32768
    s_add_u32 m0, s26, 65536
    s_nop 0
    buffer_load_dwordx4 v6, s[4:7], s24 offen lds
    s_add_u32 m0, s26, 66560
    s_nop 0
    buffer_load_dwordx4 v7, s[4:7], s24 offen lds
    s_add_u32 m0, s26, 73728
    s_nop 0
    buffer_load_dwordx4 v8, s[8:11], s25 offen lds
    s_add_u32 m0, s26, 74752
    s_nop 0
    buffer_load_dwordx4 v9, s[8:11], s25 offen lds
    s_mov_b32 s24, 20480
    s_mov_b32 s25, 40960
    s_add_u32 m0, s26, 81920
    s_nop 0
    buffer_load_dwordx4 v6, s[4:7], s24 offen lds
    s_add_u32 m0, s26, 82944
    s_nop 0
    buffer_load_dwordx4 v7, s[4:7], s24 offen lds
    s_add_u32 m0, s26, 90112
    s_nop 0
    buffer_load_dwordx4 v8, s[8:11], s25 offen lds
    s_add_u32 m0, s26, 91136
    s_nop 0
    buffer_load_dwordx4 v9, s[8:11], s25 offen lds
    s_waitcnt vmcnt(20)
    s_barrier
    s_mov_b32 s24, 24576
    s_mov_b32 s25, 49152
    s_add_u32 m0, s26, 98304
    s_nop 0
    buffer_load_dwordx4 v6, s[4:7], s24 offen lds
    s_add_u32 m0, s26, 99328
    s_nop 0
    buffer_load_dwordx4 v7, s[4:7], s24 offen lds
    s_add_u32 m0, s26, 106496
    s_nop 0
    buffer_load_dwordx4 v8, s[8:11], s25 offen lds
    s_add_u32 m0, s26, 107520
    s_nop 0
    buffer_load_dwordx4 v9, s[8:11], s25 offen lds
    s_waitcnt vmcnt(20)
    s_barrier
    s_mov_b32 s24, 28672
    s_mov_b32 s25, 57344
    s_add_u32 m0, s26, 0
    s_nop 0
    buffer_load_dwordx4 v6, s[4:7], s24 offen lds
    s_add_u32 m0, s26, 1024
    s_nop 0
    buffer_load_dwordx4 v7, s[4:7], s24 offen lds
    s_add_u32 m0, s26, 8192
    s_nop 0
    buffer_load_dwordx4 v8, s[8:11], s25 offen lds
    s_add_u32 m0, s26, 9216
    s_nop 0
    buffer_load_dwordx4 v9, s[8:11], s25 offen lds
    s_waitcnt vmcnt(20)
    s_barrier
    s_mov_b32 s24, 32768
    s_mov_b32 s25, 65536
    s_add_u32 m0, s26, 16384
    s_nop 0
    buffer_load_dwordx4 v6, s[4:7], s24 offen lds
    s_add_u32 m0, s26, 17408
    s_nop 0
    buffer_load_dwordx4 v7, s[4:7], s24 offen lds
    s_add_u32 m0, s26, 24576
    s_nop 0
    buffer_load_dwordx4 v8, s[8:11], s25 offen lds
    s_add_u32 m0, s26, 25600
    s_nop 0
    buffer_load_dwordx4 v9, s[8:11], s25 offen lds
    s_waitcnt vmcnt(20)
    s_barrier
    s_mov_b32 s24, 36864
    s_mov_b32 s25, 73728
    s_add_u32 m0, s26, 32768
    s_nop 0
    buffer_load_dwordx4 v6, s[4:7], s24 offen lds
    s_add_u32 m0, s26, 33792
    s_nop 0
    buffer_load_dwordx4 v7, s[4:7], s24 offen lds
    s_add_u32 m0, s26, 40960
    s_nop 0
    buffer_load_dwordx4 v8, s[8:11], s25 offen lds
    s_add_u32 m0, s26, 41984
    s_nop 0
    buffer_load_dwordx4 v9, s[8:11], s25 offen lds
    s_waitcnt vmcnt(20)
    s_barrier
    s_mov_b32 s24, 40960
    s_mov_b32 s25, 81920
    s_add_u32 m0, s26, 49152
    s_nop 0
    buffer_load_dwordx4 v6, s[4:7], s24 offen lds
    s_add_u32 m0, s26, 50176
    s_nop 0
    buffer_load_dwordx4 v7, s[4:7], s24 offen lds
    s_add_u32 m0, s26, 57344
    s_nop 0
    buffer_load_dwordx4 v8, s[8:11], s25 offen lds
    s_add_u32 m0, s26, 58368
    s_nop 0
    buffer_load_dwordx4 v9, s[8:11], s25 offen lds
    s_waitcnt vmcnt(20)
    s_barrier
    s_mov_b32 s24, 45056
    s_mov_b32 s25, 90112
    s_add_u32 m0, s26, 65536
    s_nop 0
    buffer_load_dwordx4 v6, s[4:7], s24 offen lds
    s_add_u32 m0, s26, 66560
    s_nop 0
    buffer_load_dwordx4 v7, s[4:7], s24 offen lds
    s_add_u32 m0, s26, 73728
    s_nop 0
    buffer_load_dwordx4 v8, s[8:11], s25 offen lds
    s_add_u32 m0, s26, 74752
    s_nop 0
    buffer_load_dwordx4 v9, s[8:11], s25 offen lds
    s_waitcnt vmcnt(20)
    s_barrier
    s_mov_b32 s24, 49152
    s_mov_b32 s25, 98304
    s_add_u32 m0, s26, 81920
    s_nop 0
    buffer_load_dwordx4 v6, s[4:7], s24 offen lds
    s_add_u32 m0, s26, 82944
    s_nop 0
    buffer_load_dwordx4 v7, s[4:7], s24 offen lds
    s_add_u32 m0, s26, 90112
    s_nop 0
    buffer_load_dwordx4 v8, s[8:11], s25 offen lds
    s_add_u32 m0, s26, 91136
    s_nop 0
    buffer_load_dwordx4 v9, s[8:11], s25 offen lds
    s_waitcnt vmcnt(20)
    s_barrier
    s_mov_b32 s36, 13
ffb1_kernel_pl1:
    s_lshl_b32 s24, s36, 12
    s_lshl_b32 s25, s36, 13
    s_cmp_lt_u32 s36, 28
    s_cselect_b32 s24, s24, 0x7ff00000
    s_cselect_b32 s25, s25, 0x7ff00000
    s_add_u32 s36, s36, 1
    s_add_u32 m0, s26, 98304
    s_nop 0
    buffer_load_dwordx4 v6, s[4:7], s24 offen lds
    s_add_u32 m0, s26, 99328
    s_nop 0
    buffer_load_dwordx4 v7, s[4:7], s24 offen lds
    s_add_u32 m0, s26, 106496
    s_nop 0
    buffer_load_dwordx4 v8, s[8:11], s25 offen lds
    s_add_u32 m0, s26, 107520
    s_nop 0
    buffer_load_dwordx4 v9, s[8:11], s25 offen lds
    s_waitcnt vmcnt(20)
    s_barrier
    s_lshl_b32 s24, s36, 12
    s_lshl_b32 s25, s36, 13
    s_cmp_lt_u32 s36, 28
    s_cselect_b32 s24, s24, 0x7ff00000
    s_cselect_b32 s25, s25, 0x7ff00000
    s_add_u32 s36, s36, 1
    s_add_u32 m0, s26, 0
    s_nop 0
    buffer_load_dwordx4 v6, s[4:7], s24 offen lds
    s_add_u32 m0, s26, 1024
    s_nop 0
    buffer_load_dwordx4 v7, s[4:7], s24 offen lds
    s_add_u32 m0, s26, 8192
    s_nop 0
    buffer_load_dwordx4 v8, s[8:11], s25 offen lds
    s_add_u32 m0, s26, 9216
    s_nop 0
    buffer_load_dwordx4 v9, s[8:11], s25 offen lds
    s_waitcnt vmcnt(20)
    s_barrier
    s_lshl_b32 s24, s36, 12
    s_lshl_b32 s25, s36, 13
    s_cmp_lt_u32 s36, 28
    s_cselect_b32 s24, s24, 0x7ff00000
    s_cselect_b32 s25, s25, 0x7ff00000
    s_add_u32 s36, s36, 1
    s_add_u32 m0, s26, 16384
    s_nop 0
    buffer_load_dwordx4 v6, s[4:7], s24 offen lds
    s_add_u32 m0, s26, 17408
    s_nop 0
    buffer_load_dwordx4 v7, s[4:7], s24 offen lds
    s_add_u32 m0, s26, 24576
    s_nop 0
    buffer_load_dwordx4 v8, s[8:11], s25 offen lds
    s_add_u32 m0, s26, 25600
    s_nop 0
    buffer_load_dwordx4 v9, s[8:11], s25 offen lds
    s_waitcnt vmcnt(20)
    s_barrier
    s_lshl_b32 s24, s36, 12
    s_lshl_b32 s25, s36, 13
    s_cmp_lt_u32 s36, 28
    s_cselect_b32 s24, s24, 0x7ff00000
    s_cselect_b32 s25, s25, 0x7ff00000
    s_add_u32 s36, s36, 1
    s_add_u32 m0, s26, 32768
    s_nop 0
    buffer_load_dwordx4 v6, s[4:7], s24 offen lds
    s_add_u32 m0, s26, 33792
    s_nop 0
    buffer_load_dwordx4 v7, s[4:7], s24 offen lds
    s_add_u32 m0, s26, 40960
    s_nop 0
    buffer_load_dwordx4 v8, s[8:11], s25 offen lds
    s_add_u32 m0, s26, 41984
    s_nop 0
    buffer_load_dwordx4 v9, s[8:11], s25 offen lds
    s_waitcnt vmcnt(20)
    s_barrier
    s_lshl_b32 s24, s36, 12
    s_lshl_b32 s25, s36, 13
    s_cmp_lt_u32 s36, 28
    s_cselect_b32 s24, s24, 0x7ff00000
    s_cselect_b32 s25, s25, 0x7ff00000
    s_add_u32 s36, s36, 1
    s_add_u32 m0, s26, 49152
    s_nop 0
    buffer_load_dwordx4 v6, s[4:7], s24 offen lds
    s_add_u32 m0, s26, 50176
    s_nop 0
    buffer_load_dwordx4 v7, s[4:7], s24 offen lds
    s_add_u32 m0, s26, 57344
    s_nop 0
    buffer_load_dwordx4 v8, s[8:11], s25 offen lds
    s_add_u32 m0, s26, 58368
    s_nop 0
    buffer_load_dwordx4 v9, s[8:11], s25 offen lds
    s_waitcnt vmcnt(20)
    s_barrier
    s_lshl_b32 s24, s36, 12
    s_lshl_b32 s25, s36, 13
    s_cmp_lt_u32 s36, 28
    s_cselect_b32 s24, s24, 0x7ff00000
    s_cselect_b32 s25, s25, 0x7ff00000
    s_add_u32 s36, s36, 1
    s_add_u32 m0, s26, 65536
    s_nop 0
    buffer_load_dwordx4 v6, s[4:7], s24 offen lds
    s_add_u32 m0, s26, 66560
    s_nop 0
    buffer_load_dwordx4 v7, s[4:7], s24 offen lds
    s_add_u32 m0, s26, 73728
    s_nop 0
    buffer_load_dwordx4 v8, s[8:11], s25 offen lds
    s_add_u32 m0, s26, 74752
    s_nop 0
    buffer_load_dwordx4 v9, s[8:11], s25 offen lds
    s_waitcnt vmcnt(20)
    s_barrier
    s_lshl_b32 s24, s36, 12
    s_lshl_b32 s25, s36, 13
    s_cmp_lt_u32 s36, 28
    s_cselect_b32 s24, s24, 0x7ff00000
    s_cselect_b32 s25, s25, 0x7ff00000
    s_add_u32 s36, s36, 1
    s_add_u32 m0, s26, 81920
    s_nop 0
    buffer_load_dwordx4 v6, s[4:7], s24 offen lds
    s_add_u32 m0, s26, 82944
    s_nop 0
    buffer_load_dwordx4 v7, s[4:7], s24 offen lds
    s_add_u32 m0, s26, 90112
    s_nop 0
    buffer_load_dwordx4 v8, s[8:11], s25 offen lds
    s_add_u32 m0, s26, 91136
    s_nop 0
    buffer_load_dwordx4 v9, s[8:11], s25 offen lds
    s_waitcnt vmcnt(20)
    s_barrier
    s_cmp_lt_u32 s36, 34
    s_cbranch_scc1 ffb1_kernel_pl1
    s_endpgm
ffb1_kernel_comp:
    s_lshl_b32 s22, s20, 1
    s_and_b32 s23, s3, 1
    s_add_u32 s22, s22, s23
    s_lshl_b32 s23, s21, 1
    s_lshr_b32 s25, s3, 1
    s_add_u32 s23, s23, s25
    s_lshl_b32 s24, s22, 15
    s_lshl_b32 s25, s23, 6
    s_add_u32 s25, s24, s25
    v_and_b32 v4, 31, v1
    v_lshlrev_b32 v4, 10, v4
    v_lshrrev_b32 v2, 5, v1
    v_lshl_add_u32 v4, v2, 4, v4
    v_add_u32 v4, s25, v4
    s_lshl_b32 s25, s23, 11
    s_add_u32 s25, s24, s25
    v_lshlrev_b32 v5, 4, v1
    v_add_u32 v5, s25, v5
    v_mov_b32 v88, v5
    v_mov_b32 v89, v5
    s_lshl_b32 s27, s22, 12
    s_lshl_b32 s23, s23, 3
    s_add_u32 s27, s27, s23
    s_add_u32 s27, s27, 14680064
    s_and_b32 s22, s3, 1
    s_lshl_b32 s22, s22, 12
    v_lshlrev_b32 v10, 4, v1
    v_add_u32 v10, s22, v10
    v_add_u32 v11, 1024, v10
    v_add_u32 v12, 2048, v10
    v_add_u32 v13, 3072, v10
    v_add_u32 v14, 65536, v10
    v_add_u32 v15, 65536, v11
    v_add_u32 v16, 65536, v12
    v_add_u32 v17, 65536, v13
    s_lshr_b32 s22, s3, 1
    v_bfe_u32 v2, v1, 2, 2
    v_lshrrev_b32 v3, 5, v1
    v_lshl_add_u32 v3, v3, 3, v2
    v_lshlrev_b32 v3, 7, v3
    v_lshrrev_b32 v4, 1, v2
    v_xor_b32 v4, s22, v4
    v_lshl_add_u32 v3, v4, 6, v3
    v_bfe_u32 v4, v1, 4, 1
    v_lshl_add_u32 v3, v4, 5, v3
    v_and_b32 v4, 3, v1
    v_lshl_add_u32 v3, v4, 3, v3
    v_add_u32 v18, 8192, v3
    v_add_u32 v19, 65536, v18
    v_mov_b32 v20, 0x3f803f80
    v_mov_b32 v56, 0
    v_mov_b32 v57, 0
    v_mov_b32 v58, 0
    v_mov_b32 v59, 0
    v_mov_b32 v60, 0
    v_mov_b32 v61, 0
    v_mov_b32 v62, 0
    v_mov_b32 v63, 0
    v_mov_b32 v64, 0
    v_mov_b32 v65, 0
    v_mov_b32 v66, 0
    v_mov_b32 v67, 0
    v_mov_b32 v68, 0
    v_mov_b32 v69, 0
    v_mov_b32 v70, 0
    v_mov_b32 v71, 0
    s_waitcnt lgkmcnt(0)
    s_add_u32 s16, s28, 0x800000
    s_addc_u32 s17, s29, 0
    s_and_b32 s17, s17, 0xffff
    s_mov_b32 s18, 0x200000
    s_mov_b32 s19, 0x00020000
    buffer_load_dwordx4 v[72:75], v89, s[16:19], 0 offen offset:0
    buffer_load_dwordx4 v[76:79], v89, s[16:19], 0 offen offset:1024
    s_add_u32 s12, s28, 0xa00000
    s_addc_u32 s13, s29, 0
    s_and_b32 s13, s13, 0xffff
    s_mov_b32 s14, 0x200000
    s_mov_b32 s15, 0x00020000
    s_mov_b32 s40, s28
    s_mov_b32 s41, s29
    s_and_b32 s41, s41, 0xffff
    s_mov_b32 s42, 0x10000000
    s_mov_b32 s43, 0x00020000
    s_barrier
    ds_read_b128 v[24:27], v10 offset:0
    ds_read_b64_tr_b16 v[40:41], v18 offset:0
    ds_read_b64_tr_b16 v[42:43], v18 offset:512
    ds_read_b128 v[28:31], v11 offset:0
    ds_read_b64_tr_b16 v[44:45], v18 offset:2048
    ds_read_b64_tr_b16 v[46:47], v18 offset:2560
    s_mov_b32 s36, 0
ffb1_kernel_lp2:
    s_waitcnt lgkmcnt(3)
    v_mfma_f32_32x32x16_bf16 v[56:71], v[40:43], v[24:27], v[56:71]
    ds_read_b128 v[32:35], v12 offset:0
    ds_read_b64_tr_b16 v[48:49], v18 offset:4096
    ds_read_b64_tr_b16 v[50:51], v18 offset:4608
    s_waitcnt lgkmcnt(3)
    v_mfma_f32_32x32x16_bf16 v[56:71], v[44:47], v[28:31], v[56:71]
    ds_read_b128 v[36:39], v13 offset:0
    ds_read_b64_tr_b16 v[52:53], v18 offset:6144
    ds_read_b64_tr_b16 v[54:55], v18 offset:6656
    s_waitcnt lgkmcnt(0)
    s_barrier
    v_mfma_f32_32x32x16_bf16 v[56:71], v[48:51], v[32:35], v[56:71]
    ds_read_b128 v[24:27], v10 offset:16384
    ds_read_b64_tr_b16 v[40:41], v18 offset:16384
    ds_read_b64_tr_b16 v[42:43], v18 offset:16896
    s_waitcnt lgkmcnt(3)
    v_mfma_f32_32x32x16_bf16 v[56:71], v[52:55], v[36:39], v[56:71]
    ds_read_b128 v[28:31], v11 offset:16384
    ds_read_b64_tr_b16 v[44:45], v18 offset:18432
    ds_read_b64_tr_b16 v[46:47], v18 offset:18944
    s_waitcnt lgkmcnt(3)
    v_mfma_f32_32x32x16_bf16 v[56:71], v[40:43], v[24:27], v[56:71]
    ds_read_b128 v[32:35], v12 offset:16384
    ds_read_b64_tr_b16 v[48:49], v18 offset:20480
    ds_read_b64_tr_b16 v[50:51], v18 offset:20992
    s_waitcnt lgkmcnt(3)
    v_mfma_f32_32x32x16_bf16 v[56:71], v[44:47], v[28:31], v[56:71]
    ds_read_b128 v[36:39], v13 offset:16384
    ds_read_b64_tr_b16 v[52:53], v18 offset:22528
    ds_read_b64_tr_b16 v[54:55], v18 offset:23040
    s_waitcnt lgkmcnt(0)
    s_barrier
    v_mfma_f32_32x32x16_bf16 v[56:71], v[48:51], v[32:35], v[56:71]
    ds_read_b128 v[24:27], v10 offset:32768
    ds_read_b64_tr_b16 v[40:41], v18 offset:32768
    ds_read_b64_tr_b16 v[42:43], v18 offset:33280
    s_waitcnt lgkmcnt(3)
    v_mfma_f32_32x32x16_bf16 v[56:71], v[52:55], v[36:39], v[56:71]
    ds_read_b128 v[28:31], v11 offset:32768
    ds_read_b64_tr_b16 v[44:45], v18 offset:34816
    ds_read_b64_tr_b16 v[46:47], v18 offset:35328
    s_waitcnt lgkmcnt(3)
    v_mfma_f32_32x32x16_bf16 v[56:71], v[40:43], v[24:27], v[56:71]
    ds_read_b128 v[32:35], v12 offset:32768
    ds_read_b64_tr_b16 v[48:49], v18 offset:36864
    ds_read_b64_tr_b16 v[50:51], v18 offset:37376
    s_waitcnt lgkmcnt(3)
    v_mfma_f32_32x32x16_bf16 v[56:71], v[44:47], v[28:31], v[56:71]
    ds_read_b128 v[36:39], v13 offset:32768
    ds_read_b64_tr_b16 v[52:53], v18 offset:38912
    ds_read_b64_tr_b16 v[54:55], v18 offset:39424
    s_waitcnt lgkmcnt(0)
    s_barrier
    v_mfma_f32_32x32x16_bf16 v[56:71], v[48:51], v[32:35], v[56:71]
    ds_read_b128 v[24:27], v10 offset:49152
    ds_read_b64_tr_b16 v[40:41], v18 offset:49152
    ds_read_b64_tr_b16 v[42:43], v18 offset:49664
    s_waitcnt lgkmcnt(3)
    v_mfma_f32_32x32x16_bf16 v[56:71], v[52:55], v[36:39], v[56:71]
    ds_read_b128 v[28:31], v11 offset:49152
    ds_read_b64_tr_b16 v[44:45], v18 offset:51200
    ds_read_b64_tr_b16 v[46:47], v18 offset:51712
    s_waitcnt lgkmcnt(3)
    v_mfma_f32_32x32x16_bf16 v[56:71], v[40:43], v[24:27], v[56:71]
    ds_read_b128 v[32:35], v12 offset:49152
    ds_read_b64_tr_b16 v[48:49], v18 offset:53248
    ds_read_b64_tr_b16 v[50:51], v18 offset:53760
    s_waitcnt lgkmcnt(3)
    v_mfma_f32_32x32x16_bf16 v[56:71], v[44:47], v[28:31], v[56:71]
    ds_read_b128 v[36:39], v13 offset:49152
    ds_read_b64_tr_b16 v[52:53], v18 offset:55296
    ds_read_b64_tr_b16 v[54:55], v18 offset:55808
    s_waitcnt lgkmcnt(0)
    s_barrier
    v_mfma_f32_32x32x16_bf16 v[56:71], v[48:51], v[32:35], v[56:71]
    ds_read_b128 v[24:27], v14 offset:0
    ds_read_b64_tr_b16 v[40:41], v19 offset:0
    ds_read_b64_tr_b16 v[42:43], v19 offset:512
    s_waitcnt lgkmcnt(3)
    v_mfma_f32_32x32x16_bf16 v[56:71], v[52:55], v[36:39], v[56:71]
    ds_read_b128 v[28:31], v15 offset:0
    ds_read_b64_tr_b16 v[44:45], v19 offset:2048
    ds_read_b64_tr_b16 v[46:47], v19 offset:2560
    s_waitcnt lgkmcnt(3)
    v_mfma_f32_32x32x16_bf16 v[56:71], v[40:43], v[24:27], v[56:71]
    ds_read_b128 v[32:35], v16 offset:0
    ds_read_b64_tr_b16 v[48:49], v19 offset:4096
    ds_read_b64_tr_b16 v[50:51], v19 offset:4608
    s_waitcnt lgkmcnt(3)
    v_mfma_f32_32x32x16_bf16 v[56:71], v[44:47], v[28:31], v[56:71]
    ds_read_b128 v[36:39], v17 offset:0
    ds_read_b64_tr_b16 v[52:53], v19 offset:6144
    ds_read_b64_tr_b16 v[54:55], v19 offset:6656
    s_waitcnt lgkmcnt(0)
    s_barrier
    v_mfma_f32_32x32x16_bf16 v[56:71], v[48:51], v[32:35], v[56:71]
    ds_read_b128 v[24:27], v14 offset:16384
    ds_read_b64_tr_b16 v[40:41], v19 offset:16384
    ds_read_b64_tr_b16 v[42:43], v19 offset:16896
    s_waitcnt lgkmcnt(3)
    v_mfma_f32_32x32x16_bf16 v[56:71], v[52:55], v[36:39], v[56:71]
    ds_read_b128 v[28:31], v15 offset:16384
    ds_read_b64_tr_b16 v[44:45], v19 offset:18432
    ds_read_b64_tr_b16 v[46:47], v19 offset:18944
    s_waitcnt lgkmcnt(3)
    v_mfma_f32_32x32x16_bf16 v[56:71], v[40:43], v[24:27], v[56:71]
    ds_read_b128 v[32:35], v16 offset:16384
    ds_read_b64_tr_b16 v[48:49], v19 offset:20480
    ds_read_b64_tr_b16 v[50:51], v19 offset:20992
    s_waitcnt lgkmcnt(3)
    v_mfma_f32_32x32x16_bf16 v[56:71], v[44:47], v[28:31], v[56:71]
    ds_read_b128 v[36:39], v17 offset:16384
    ds_read_b64_tr_b16 v[52:53], v19 offset:22528
    ds_read_b64_tr_b16 v[54:55], v19 offset:23040
    s_waitcnt lgkmcnt(0)
    s_barrier
    v_mfma_f32_32x32x16_bf16 v[56:71], v[48:51], v[32:35], v[56:71]
    ds_read_b128 v[24:27], v14 offset:32768
    ds_read_b64_tr_b16 v[40:41], v19 offset:32768
    ds_read_b64_tr_b16 v[42:43], v19 offset:33280
    s_waitcnt lgkmcnt(3)
    v_mfma_f32_32x32x16_bf16 v[56:71], v[52:55], v[36:39], v[56:71]
    ds_read_b128 v[28:31], v15 offset:32768
    ds_read_b64_tr_b16 v[44:45], v19 offset:34816
    ds_read_b64_tr_b16 v[46:47], v19 offset:35328
    s_waitcnt lgkmcnt(3)
    v_mfma_f32_32x32x16_bf16 v[56:71], v[40:43], v[24:27], v[56:71]
    ds_read_b128 v[32:35], v16 offset:32768
    ds_read_b64_tr_b16 v[48:49], v19 offset:36864
    ds_read_b64_tr_b16 v[50:51], v19 offset:37376
    s_waitcnt lgkmcnt(3)
    v_mfma_f32_32x32x16_bf16 v[56:71], v[44:47], v[28:31], v[56:71]
    ds_read_b128 v[36:39], v17 offset:32768
    ds_read_b64_tr_b16 v[52:53], v19 offset:38912
    ds_read_b64_tr_b16 v[54:55], v19 offset:39424
    s_waitcnt lgkmcnt(0)
    s_barrier
    v_mfma_f32_32x32x16_bf16 v[56:71], v[48:51], v[32:35], v[56:71]
    ds_read_b128 v[24:27], v10 offset:0
    ds_read_b64_tr_b16 v[40:41], v18 offset:0
    ds_read_b64_tr_b16 v[42:43], v18 offset:512
    s_waitcnt lgkmcnt(3)
    v_mfma_f32_32x32x16_bf16 v[56:71], v[52:55], v[36:39], v[56:71]
    ds_read_b128 v[28:31], v11 offset:0
    ds_read_b64_tr_b16 v[44:45], v18 offset:2048
    ds_read_b64_tr_b16 v[46:47], v18 offset:2560
    s_add_u32 s36, s36, 1
    s_cmp_lt_u32 s36, 4
    s_cbranch_scc1 ffb1_kernel_lp2
    s_waitcnt lgkmcnt(0)
    s_waitcnt vmcnt(0)
    s_nop 15
    v_cvt_pk_bf16_f32 v80, v56, v57
    v_cvt_pk_bf16_f32 v81, v58, v59
    v_cvt_pk_bf16_f32 v82, v60, v61
    v_cvt_pk_bf16_f32 v83, v62, v63
    v_cvt_pk_bf16_f32 v84, v64, v65
    v_cvt_pk_bf16_f32 v85, v66, v67
    v_cvt_pk_bf16_f32 v86, v68, v69
    v_cvt_pk_bf16_f32 v87, v70, v71
    s_nop 0
    v_permlane32_swap_b32 v80, v82
    v_permlane32_swap_b32 v81, v83
    v_permlane32_swap_b32 v84, v86
    v_permlane32_swap_b32 v85, v87
    v_lshlrev_b32 v2, 16, v80
    v_lshlrev_b32 v3, 16, v72
    v_add_f32 v2, v2, v3
    v_and_b32 v4, 0xffff0000, v80
    v_and_b32 v5, 0xffff0000, v72
    v_add_f32 v4, v4, v5
    v_cvt_pk_bf16_f32 v80, v2, v4
    v_lshlrev_b32 v2, 16, v81
    v_lshlrev_b32 v3, 16, v73
    v_add_f32 v2, v2, v3
    v_and_b32 v4, 0xffff0000, v81
    v_and_b32 v5, 0xffff0000, v73
    v_add_f32 v4, v4, v5
    v_cvt_pk_bf16_f32 v81, v2, v4
    v_lshlrev_b32 v2, 16, v82
    v_lshlrev_b32 v3, 16, v74
    v_add_f32 v2, v2, v3
    v_and_b32 v4, 0xffff0000, v82
    v_and_b32 v5, 0xffff0000, v74
    v_add_f32 v4, v4, v5
    v_cvt_pk_bf16_f32 v82, v2, v4
    v_lshlrev_b32 v2, 16, v83
    v_lshlrev_b32 v3, 16, v75
    v_add_f32 v2, v2, v3
    v_and_b32 v4, 0xffff0000, v83
    v_and_b32 v5, 0xffff0000, v75
    v_add_f32 v4, v4, v5
    v_cvt_pk_bf16_f32 v83, v2, v4
    buffer_store_dwordx4 v[80:83], v88, s[12:15], 0 offen offset:0
    v_lshlrev_b32 v2, 16, v84
    v_lshlrev_b32 v3, 16, v76
    v_add_f32 v2, v2, v3
    v_and_b32 v4, 0xffff0000, v84
    v_and_b32 v5, 0xffff0000, v76
    v_add_f32 v4, v4, v5
    v_cvt_pk_bf16_f32 v84, v2, v4
    v_lshlrev_b32 v2, 16, v85
    v_lshlrev_b32 v3, 16, v77
    v_add_f32 v2, v2, v3
    v_and_b32 v4, 0xffff0000, v85
    v_and_b32 v5, 0xffff0000, v77
    v_add_f32 v4, v4, v5
    v_cvt_pk_bf16_f32 v85, v2, v4
    v_lshlrev_b32 v2, 16, v86
    v_lshlrev_b32 v3, 16, v78
    v_add_f32 v2, v2, v3
    v_and_b32 v4, 0xffff0000, v86
    v_and_b32 v5, 0xffff0000, v78
    v_add_f32 v4, v4, v5
    v_cvt_pk_bf16_f32 v86, v2, v4
    v_lshlrev_b32 v2, 16, v87
    v_lshlrev_b32 v3, 16, v79
    v_add_f32 v2, v2, v3
    v_and_b32 v4, 0xffff0000, v87
    v_and_b32 v5, 0xffff0000, v79
    v_add_f32 v4, v4, v5
    v_cvt_pk_bf16_f32 v87, v2, v4
    buffer_store_dwordx4 v[84:87], v88, s[12:15], 0 offen offset:1024
    v_mov_b32 v90, 0
    v_mov_b32 v91, 0
    v_dot2c_f32_bf16 v90, v80, v20
    v_dot2c_f32_bf16 v91, v80, v80
    v_dot2c_f32_bf16 v90, v81, v20
    v_dot2c_f32_bf16 v91, v81, v81
    v_dot2c_f32_bf16 v90, v82, v20
    v_dot2c_f32_bf16 v91, v82, v82
    v_dot2c_f32_bf16 v90, v83, v20
    v_dot2c_f32_bf16 v91, v83, v83
    v_dot2c_f32_bf16 v90, v84, v20
    v_dot2c_f32_bf16 v91, v84, v84
    v_dot2c_f32_bf16 v90, v85, v20
    v_dot2c_f32_bf16 v91, v85, v85
    v_dot2c_f32_bf16 v90, v86, v20
    v_dot2c_f32_bf16 v91, v86, v86
    v_dot2c_f32_bf16 v90, v87, v20
    v_dot2c_f32_bf16 v91, v87, v87
    v_and_b32 v4, 31, v1
    v_lshlrev_b32 v4, 7, v4
    s_nop 1
    v_mov_b32 v2, v90
    s_nop 1
    v_permlane32_swap_b32 v90, v2
    v_add_f32 v90, v90, v2
    v_mov_b32 v2, v91
    s_nop 1
    v_permlane32_swap_b32 v91, v2
    v_add_f32 v91, v91, v2
    s_mov_b32 exec_hi, 0
    buffer_store_dwordx2 v[90:91], v4, s[40:43], s27 offen
    s_mov_b64 exec, -1
ffb1_kernel_end:
    s_endpgm
.section .rodata,"a"
.p2align 6
.amdhsa_kernel ffb1_kernel
  .amdhsa_next_free_vgpr 96
  .amdhsa_next_free_sgpr 96
  .amdhsa_accum_offset 96
  .amdhsa_group_segment_fixed_size 0
  .amdhsa_kernarg_size 80
  .amdhsa_user_sgpr_count 2
  .amdhsa_user_sgpr_kernarg_segment_ptr 1
  .amdhsa_system_sgpr_workgroup_id_x 1
.end_amdhsa_kernel
.text
.globl qkv2_kernel
.p2align 8
.type qkv2_kernel,@function
qkv2_kernel:
    s_cmp_ge_u32 s2, 256
    s_cbranch_scc1 qkv2_kernel_end
    s_load_dwordx2 s[28:29], s[0:1], 72
    s_load_dwordx2 s[30:31], s[0:1], 8
    s_load_dwordx2 s[32:33], s[0:1], 0
    s_load_dwordx2 s[34:35], s[0:1], 40
    v_and_b32 v1, 63, v0
    v_lshrrev_b32 v2, 6, v0
    s_bfe_u32 s20, s2, 0x20001
    v_readfirstlane_b32 s44, v2
    s_lshl_b32 s20, s20, 2
    s_bfe_u32 s22, s2, 0x20003
    s_add_u32 s20, s20, s22
    s_and_b32 s21, s2, 1
    s_mul_i32 s21, s21, 8
    s_lshr_b32 s22, s2, 5
    s_add_u32 s21, s21, s22
    s_and_b32 s3, s44, 3
    s_lshl_b32 s26, s3, 12
    s_lshl_b32 s22, s20, 7
    s_lshl_b32 s23, s3, 5
    s_add_u32 s22, s22, s23
    s_cmp_lt_u32 s44, 4
    s_cbranch_scc1 qkv2_kernel_comp
    s_lshl_b32 s24, s22, 10
    v_lshlrev_b32 v6, 4, v1
    v_add_u32 v6, s24, v6
    v_add_u32 v7, 1024, v6
    v_add_u32 v8, 2048, v6
    v_add_u32 v9, 3072, v6
    s_lshl_b32 s24, s3, 4
    s_lshl_b32 s23, s21, 6
    v_add_u32 v2, 0, v1
    v_mul_u32_u24 v3, 171, v2
    v_lshrrev_b32 v3, 11, v3
    v_mul_u32_u24 v4, 12, v3
    v_sub_u32 v4, v2, v4
    v_add_u32 v3, s24, v3
    v_mul_u32_u24 v10, 3072, v3
    v_lshrrev_b32 v5, 2, v4
    v_lshl_add_u32 v10, v5, 10, v10
    v_and_b32 v5, 3, v4
    v_lshl_add_u32 v10, v5, 4, v10
    v_add_u32 v10, s23, v10
    v_add_u32 v2, 64, v1
    v_mul_u32_u24 v3, 171, v2
    v_lshrrev_b32 v3, 11, v3
    v_mul_u32_u24 v4, 12, v3
    v_sub_u32 v4, v2, v4
    v_add_u32 v3, s24, v3
    v_mul_u32_u24 v11, 3072, v3
    v_lshrrev_b32 v5, 2, v4
    v_lshl_add_u32 v11, v5, 10, v11
    v_and_b32 v5, 3, v4
    v_lshl_add_u32 v11, v5, 4, v11
    v_add_u32 v11, s23, v11
    v_add_u32 v2, 128, v1
    v_mul_u32_u24 v3, 171, v2
    v_lshrrev_b32 v3, 11, v3
    v_mul_u32_u24 v4, 12, v3
    v_sub_u32 v4, v2, v4
    v_add_u32 v3, s24, v3
    v_mul_u32_u24 v12, 3072, v3
    v_lshrrev_b32 v5, 2, v4
    v_lshl_add_u32 v12, v5, 10, v12
    v_and_b32 v5, 3, v4
    v_lshl_add_u32 v12, v5, 4, v12
    v_add_u32 v12, s23, v12
    s_mul_i32 s27, s3, 3072
    s_waitcnt lgkmcnt(0)
    s_add_u32 s4, s28, 0xa00000
    s_addc_u32 s5, s29, 0
    s_and_b32 s5, s5, 0xffff
    s_mov_b32 s6, 0x200000
    s_mov_b32 s7, 0x00020000
    s_add_u32 s8, s28, 0x1d00000
    s_addc_u32 s9, s29, 0
    s_and_b32 s9, s9, 0xffff
    s_mov_b32 s10, 0x180000
    s_mov_b32 s11, 0x00020000
    s_mul_i32 s23, s21, 98304
    s_add_u32 s23, s23, s27
    v_lshlrev_b32 v10, 4, v1
    v_add_u32 v10, s23, v10
    v_add_u32 v11, 1024, v10
    v_add_u32 v12, 2048, v10
    s_mov_b32 s24, 0
    s_add_u32 m0, s26, 0
    s_nop 0
    buffer_load_dwordx4 v6, s[4:7], s24 offen lds
    s_add_u32 m0, s26, 1024
    s_nop 0
    buffer_load_dwordx4 v7, s[4:7], s24 offen lds
    s_add_u32 m0, s26, 2048
    s_nop 0
    buffer_load_dwordx4 v8, s[4:7], s24 offen lds
    s_add_u32 m0, s26, 3072
    s_nop 0
    buffer_load_dwordx4 v9, s[4:7], s24 offen lds
    s_mov_b32 s25, 0
    s_add_u32 m0, s27, 16384
    s_nop 0
    buffer_load_dwordx4 v10, s[8:11], s25 offen lds
    s_add_u32 m0, s27, 17408
    s_nop 0
    buffer_load_dwordx4 v11, s[8:11], s25 offen lds
    s_add_u32 m0, s27, 18432
    s_nop 0
    buffer_load_dwordx4 v12, s[8:11], s25 offen lds
    s_mov_b32 s24, 4096
    s_add_u32 m0, s26, 28672
    s_nop 0
    buffer_load_dwordx4 v6, s[4:7], s24 offen lds
    s_add_u32 m0, s26, 29696
    s_nop 0
    buffer_load_dwordx4 v7, s[4:7], s24 offen lds
    s_add_u32 m0, s26, 30720
    s_nop 0
    buffer_load_dwordx4 v8, s[4:7], s24 offen lds
    s_add_u32 m0, s26, 31744
    s_nop 0
    buffer_load_dwordx4 v9, s[4:7], s24 offen lds
    s_mov_b32 s25, 12288
    s_add_u32 m0, s27, 45056
    s_nop 0
    buffer_load_dwordx4 v10, s[8:11], s25 offen lds
    s_add_u32 m0, s27, 46080
    s_nop 0
    buffer_load_dwordx4 v11, s[8:11], s25 offen lds
    s_add_u32 m0, s27, 47104
    s_nop 0
    buffer_load_dwordx4 v12, s[8:11], s25 offen lds
    s_mov_b32 s24, 8192
    s_add_u32 m0, s26, 57344
    s_nop 0
    buffer_load_dwordx4 v6, s[4:7], s24 offen lds
    s_add_u32 m0, s26, 58368
    s_nop 0
    buffer_load_dwordx4 v7, s[4:7], s24 offen lds
    s_add_u32 m0, s26, 59392
    s_nop 0
    buffer_load_dwordx4 v8, s[4:7], s24 offen lds
    s_add_u32 m0, s26, 60416
    s_nop 0
    buffer_load_dwordx4 v9, s[4:7], s24 offen lds
    s_mov_b32 s25, 24576
    s_add_u32 m0, s27, 73728
    s_nop 0
    buffer_load_dwordx4 v10, s[8:11], s25 offen lds
    s_add_u32 m0, s27, 74752
    s_nop 0
    buffer_load_dwordx4 v11, s[8:11], s25 offen lds
    s_add_u32 m0, s27, 75776
    s_nop 0
    buffer_load_dwordx4 v12, s[8:11], s25 offen lds
    s_waitcnt vmcnt(14)
    s_barrier
    s_mov_b32 s24, 12288
    s_add_u32 m0, s26, 86016
    s_nop 0
    buffer_load_dwordx4 v6, s[4:7], s24 offen lds
    s_add_u32 m0, s26, 87040
    s_nop 0
    buffer_load_dwordx4 v7, s[4:7], s24 offen lds
    s_add_u32 m0, s26, 88064
    s_nop 0
    buffer_load_dwordx4 v8, s[4:7], s24 offen lds
    s_add_u32 m0, s26, 89088
    s_nop 0
    buffer_load_dwordx4 v9, s[4:7], s24 offen lds
    s_mov_b32 s25, 36864
    s_add_u32 m0, s27, 102400
    s_nop 0
    buffer_load_dwordx4 v10, s[8:11], s25 offen lds
    s_add_u32 m0, s27, 103424
    s_nop 0
    buffer_load_dwordx4 v11, s[8:11], s25 offen lds
    s_add_u32 m0, s27, 104448
    s_nop 0
    buffer_load_dwordx4 v12, s[8:11], s25 offen lds
    s_waitcnt vmcnt(14)
    s_barrier
    s_mov_b32 s24, 16384
    s_add_u32 m0, s26, 0
    s_nop 0
    buffer_load_dwordx4 v6, s[4:7], s24 offen lds
    s_add_u32 m0, s26, 1024
    s_nop 0
    buffer_load_dwordx4 v7, s[4:7], s24 offen lds
    s_add_u32 m0, s26, 2048
    s_nop 0
    buffer_load_dwordx4 v8, s[4:7], s24 offen lds
    s_add_u32 m0, s26, 3072
    s_nop 0
    buffer_load_dwordx4 v9, s[4:7], s24 offen lds
    s_mov_b32 s25, 49152
    s_add_u32 m0, s27, 16384
    s_nop 0
    buffer_load_dwordx4 v10, s[8:11], s25 offen lds
    s_add_u32 m0, s27, 17408
    s_nop 0
    buffer_load_dwordx4 v11, s[8:11], s25 offen lds
    s_add_u32 m0, s27, 18432
    s_nop 0
    buffer_load_dwordx4 v12, s[8:11], s25 offen lds
    s_waitcnt vmcnt(14)
    s_barrier
    s_mov_b32 s24, 20480
    s_add_u32 m0, s26, 28672
    s_nop 0
    buffer_load_dwordx4 v6, s[4:7], s24 offen lds
    s_add_u32 m0, s26, 29696
    s_nop 0
    buffer_load_dwordx4 v7, s[4:7], s24 offen lds
    s_add_u32 m0, s26, 30720
    s_nop 0
    buffer_load_dwordx4 v8, s[4:7], s24 offen lds
    s_add_u32 m0, s26, 31744
    s_nop 0
    buffer_load_dwordx4 v9, s[4:7], s24 offen lds
    s_mov_b32 s25, 61440
    s_add_u32 m0, s27, 45056
    s_nop 0
    buffer_load_dwordx4 v10, s[8:11], s25 offen lds
    s_add_u32 m0, s27, 46080
    s_nop 0
    buffer_load_dwordx4 v11, s[8:11], s25 offen lds
    s_add_u32 m0, s27, 47104
    s_nop 0
    buffer_load_dwordx4 v12, s[8:11], s25 offen lds
    s_waitcnt vmcnt(14)
    s_barrier
    s_mov_b32 s24, 24576
    s_add_u32 m0, s26, 57344
    s_nop 0
    buffer_load_dwordx4 v6, s[4:7], s24 offen lds
    s_add_u32 m0, s26, 58368
    s_nop 0
    buffer_load_dwordx4 v7, s[4:7], s24 offen lds
    s_add_u32 m0, s26, 59392
    s_nop 0
    buffer_load_dwordx4 v8, s[4:7], s24 offen lds
    s_add_u32 m0, s26, 60416
    s_nop 0
    buffer_load_dwordx4 v9, s[4:7], s24 offen lds
    s_mov_b32 s25, 73728
    s_add_u32 m0, s27, 73728
    s_nop 0
    buffer_load_dwordx4 v10, s[8:11], s25 offen lds
    s_add_u32 m0, s27, 74752
    s_nop 0
    buffer_load_dwordx4 v11, s[8:11], s25 offen lds
    s_add_u32 m0, s27, 75776
    s_nop 0
    buffer_load_dwordx4 v12, s[8:11], s25 offen lds
    s_waitcnt vmcnt(14)
    s_barrier
    s_mov_b32 s24, 28672
    s_add_u32 m0, s26, 86016
    s_nop 0
    buffer_load_dwordx4 v6, s[4:7], s24 offen lds
    s_add_u32 m0, s26, 87040
    s_nop 0
    buffer_load_dwordx4 v7, s[4:7], s24 offen lds
    s_add_u32 m0, s26, 88064
    s_nop 0
    buffer_load_dwordx4 v8, s[4:7], s24 offen lds
    s_add_u32 m0, s26, 89088
    s_nop 0
    buffer_load_dwordx4 v9, s[4:7], s24 offen lds
    s_mov_b32 s25, 86016
    s_add_u32 m0, s27, 102400
    s_nop 0
    buffer_load_dwordx4 v10, s[8:11], s25 offen lds
    s_add_u32 m0, s27, 103424
    s_nop 0
    buffer_load_dwordx4 v11, s[8:11], s25 offen lds
    s_add_u32 m0, s27, 104448
    s_nop 0
    buffer_load_dwordx4 v12, s[8:11], s25 offen lds
    s_waitcnt vmcnt(14)
    s_barrier
    s_waitcnt vmcnt(7)
    s_barrier
    s_mov_b32 s12, s28
    s_mov_b32 s13, s29
    s_and_b32 s13, s13, 0xffff
    s_mov_b32 s14, 0x10000000
    s_mov_b32 s15, 0x00020000
    v_and_b32 v2, 31, v1
    v_lshlrev_b32 v2, 2, v2
    s_min_u32 s23, s3, 2
    s_lshl_b32 s23, s23, 11
    s_lshl_b32 s22, s21, 7
    s_add_u32 s23, s23, s22
    s_add_u32 s23, s23, 15728640
    buffer_load_dword v3, v2, s[12:15], s23 offen
    s_lshl_b32 s22, s3, 7
    v_add_u32 v4, s22, v2
    v_add_u32 v4, 114688, v4
    s_waitcnt vmcnt(0)
    ds_write_b32 v4, v3
    s_waitcnt lgkmcnt(0)
    s_barrier
    s_endpgm
qkv2_kernel_comp:
    v_and_b32 v2, 31, v1
    v_add_u32 v2, s22, v2
    v_lshlrev_b32 v2, 7, v2
    v_lshrrev_b32 v3, 5, v1
    v_lshl_add_u32 v168, v3, 6, v2
    v_lshlrev_b32 v14, 4, v1
    v_add_u32 v14, s26, v14
    v_add_u32 v15, 1024, v14
    v_add_u32 v16, 2048, v14
    v_add_u32 v17, 3072, v14
    v_bfe_u32 v2, v1, 2, 2
    v_lshrrev_b32 v3, 5, v1
    v_lshl_add_u32 v3, v3, 3, v2
    v_mul_u32_u24 v3, 192, v3
    v_bfe_u32 v4, v1, 4, 1
    v_lshl_add_u32 v3, v4, 5, v3
    v_and_b32 v4, 3, v1
    v_lshl_add_u32 v3, v4, 3, v3
    v_add_u32 v3, 16384, v3
    v_add_u32 v22, 0, v3
    v_add_u32 v23, 64, v3
    v_add_u32 v24, 128, v3
    s_min_u32 s23, s3, 2
    s_lshl_b32 s23, s23, 6
    v_add_u32 v30, s23, v3
    v_add_u32 v18, 57344, v14
    v_add_u32 v19, 57344, v15
    v_add_u32 v20, 57344, v16
    v_add_u32 v21, 57344, v17
    v_add_u32 v26, 57344, v22
    v_add_u32 v27, 57344, v23
    v_add_u32 v28, 57344, v24
    v_add_u32 v31, 57344, v30
    v_mov_b32 v32, 0x3f803f80
    v_mov_b32 v33, 0
    v_mov_b32 v34, 0
    v_mov_b32 v35, 0
    v_mov_b32 v216, 0
    v_mov_b32 v217, 0
    v_mov_b32 v218, 0
    v_mov_b32 v219, 0
    v_mov_b32 v220, 0
    v_mov_b32 v221, 0
    s_mov_b32 s36, 2.0
    s_mov_b32 s37, 2.0
    s_mov_b32 s38, 0x3fb8aa3b
    s_mov_b32 s39, 0x3fb8aa3b
    s_waitcnt lgkmcnt(0)
    s_mov_b32 s12, s28
    s_mov_b32 s13, s29
    s_and_b32 s13, s13, 0xffff
    s_mov_b32 s14, 0x10000000
    s_mov_b32 s15, 0x00020000
    s_mov_b32 s24, 14680064
    buffer_load_dwordx4 v[44:47], v168, s[12:15], s24 offen offset:0
    buffer_load_dwordx4 v[48:51], v168, s[12:15], s24 offen offset:16
    buffer_load_dwordx4 v[52:55], v168, s[12:15], s24 offen offset:32
    buffer_load_dwordx4 v[56:59], v168, s[12:15], s24 offen offset:48
    s_barrier
    ds_read_b128 v[60:63], v14 offset:0
    ds_read_b64_tr_b16 v[72:73], v22 offset:0
    ds_read_b64_tr_b16 v[74:75], v22 offset:768
    ds_read_b64_tr_b16 v[76:77], v23 offset:0
    ds_read_b64_tr_b16 v[78:79], v23 offset:768
    ds_read_b64_tr_b16 v[80:81], v24 offset:0
    ds_read_b64_tr_b16 v[82:83], v24 offset:768
    ds_read_b128 v[64:67], v15 offset:0
    ds_read_b64_tr_b16 v[84:85], v22 offset:3072
    ds_read_b64_tr_b16 v[86:87], v22 offset:3840
    ds_read_b64_tr_b16 v[88:89], v23 offset:3072
    ds_read_b64_tr_b16 v[90:91], v23 offset:3840
    ds_read_b64_tr_b16 v[92:93], v24 offset:3072
    ds_read_b64_tr_b16 v[94:95], v24 offset:3840
    s_waitcnt lgkmcnt(7)
    v_mfma_f32_32x32x16_bf16 v[120:135], v[72:75], v[60:63], 0
    ds_read_b128 v[68:71], v16 offset:0
    ds_read_b64_tr_b16 v[96:97], v22 offset:6144
    ds_read_b64_tr_b16 v[98:99], v22 offset:6912
    v_mfma_f32_32x32x16_bf16 v[136:151], v[76:79], v[60:63], 0
    ds_read_b64_tr_b16 v[100:101], v23 offset:6144
    ds_read_b64_tr_b16 v[102:103], v23 offset:6912
    v_mfma_f32_32x32x16_bf16 v[152:167], v[60:63], v[80:83], 0
    ds_read_b64_tr_b16 v[104:105], v24 offset:6144
    ds_read_b64_tr_b16 v[106:107], v24 offset:6912
    s_waitcnt lgkmcnt(7)
    v_mfma_f32_32x32x16_bf16 v[120:135], v[84:87], v[64:67], v[120:135]
    ds_read_b128 v[60:63], v17 offset:0
    ds_read_b64_tr_b16 v[72:73], v22 offset:9216
    ds_read_b64_tr_b16 v[74:75], v22 offset:9984
    v_mfma_f32_32x32x16_bf16 v[136:151], v[88:91], v[64:67], v[136:151]
    ds_read_b64_tr_b16 v[76:77], v23 offset:9216
    ds_read_b64_tr_b16 v[78:79], v23 offset:9984
    v_mfma_f32_32x32x16_bf16 v[152:167], v[64:67], v[92:95], v[152:167]
    ds_read_b64_tr_b16 v[80:81], v24 offset:9216
    ds_read_b64_tr_b16 v[82:83], v24 offset:9984
    s_waitcnt lgkmcnt(0)
    s_barrier
    v_mfma_f32_32x32x16_bf16 v[120:135], v[96:99], v[68:71], v[120:135]
    ds_read_b128 v[64:67], v14 offset:28672
    ds_read_b64_tr_b16 v[84:85], v22 offset:28672
    ds_read_b64_tr_b16 v[86:87], v22 offset:29440
    v_mfma_f32_32x32x16_bf16 v[136:151], v[100:103], v[68:71], v[136:151]
    ds_read_b64_tr_b16 v[88:89], v23 offset:28672
    ds_read_b64_tr_b16 v[90:91], v23 offset:29440
    v_mfma_f32_32x32x16_bf16 v[152:167], v[68:71], v[104:107], v[152:167]
    ds_read_b64_tr_b16 v[92:93], v24 offset:28672
    ds_read_b64_tr_b16 v[94:95], v24 offset:29440
    s_waitcnt lgkmcnt(7)
    v_mfma_f32_32x32x16_bf16 v[120:135], v[72:75], v[60:63], v[120:135]
    ds_read_b128 v[68:71], v15 offset:28672
    ds_read_b64_tr_b16 v[96:97], v22 offset:31744
    ds_read_b64_tr_b16 v[98:99], v22 offset:32512
    v_mfma_f32_32x32x16_bf16 v[136:151], v[76:79], v[60:63], v[136:151]
    ds_read_b64_tr_b16 v[100:101], v23 offset:31744
    ds_read_b64_tr_b16 v[102:103], v23 offset:32512
    v_mfma_f32_32x32x16_bf16 v[152:167], v[60:63], v[80:83], v[152:167]
    ds_read_b64_tr_b16 v[104:105], v24 offset:31744
    ds_read_b64_tr_b16 v[106:107], v24 offset:32512
    s_waitcnt lgkmcnt(7)
    v_mfma_f32_32x32x16_bf16 v[120:135], v[84:87], v[64:67], v[120:135]
    ds_read_b128 v[60:63], v16 offset:28672
    ds_read_b64_tr_b16 v[72:73], v22 offset:34816
    ds_read_b64_tr_b16 v[74:75], v22 offset:35584
    v_mfma_f32_32x32x16_bf16 v[136:151], v[88:91], v[64:67], v[136:151]
    ds_read_b64_tr_b16 v[76:77], v23 offset:34816
    ds_read_b64_tr_b16 v[78:79], v23 offset:35584
    v_mfma_f32_32x32x16_bf16 v[152:167], v[64:67], v[92:95], v[152:167]
    ds_read_b64_tr_b16 v[80:81], v24 offset:34816
    ds_read_b64_tr_b16 v[82:83], v24 offset:35584
    s_waitcnt lgkmcnt(7)
    v_mfma_f32_32x32x16_bf16 v[120:135], v[96:99], v[68:71], v[120:135]
    ds_read_b128 v[64:67], v17 offset:28672
    ds_read_b64_tr_b16 v[84:85], v22 offset:37888
    ds_read_b64_tr_b16 v[86:87], v22 offset:38656
    v_mfma_f32_32x32x16_bf16 v[136:151], v[100:103], v[68:71], v[136:151]
    ds_read_b64_tr_b16 v[88:89], v23 offset:37888
    ds_read_b64_tr_b16 v[90:91], v23 offset:38656
    v_mfma_f32_32x32x16_bf16 v[152:167], v[68:71], v[104:107], v[152:167]
    ds_read_b64_tr_b16 v[92:93], v24 offset:37888
    ds_read_b64_tr_b16 v[94:95], v24 offset:38656
    s_waitcnt lgkmcnt(0)
    s_barrier
    v_mfma_f32_32x32x16_bf16 v[120:135], v[72:75], v[60:63], v[120:135]
    ds_read_b128 v[68:71], v18 offset:0
    ds_read_b64_tr_b16 v[96:97], v26 offset:0
    ds_read_b64_tr_b16 v[98:99], v26 offset:768
    v_mfma_f32_32x32x16_bf16 v[136:151], v[76:79], v[60:63], v[136:151]
    ds_read_b64_tr_b16 v[100:101], v27 offset:0
    ds_read_b64_tr_b16 v[102:103], v27 offset:768
    v_mfma_f32_32x32x16_bf16 v[152:167], v[60:63], v[80:83], v[152:167]
    ds_read_b64_tr_b16 v[104:105], v28 offset:0
    ds_read_b64_tr_b16 v[106:107], v28 offset:768
    s_waitcnt lgkmcnt(7)
    v_mfma_f32_32x32x16_bf16 v[120:135], v[84:87], v[64:67], v[120:135]
    ds_read_b128 v[60:63], v19 offset:0
    ds_read_b64_tr_b16 v[72:73], v26 offset:3072
    ds_read_b64_tr_b16 v[74:75], v26 offset:3840
    v_mfma_f32_32x32x16_bf16 v[136:151], v[88:91], v[64:67], v[136:151]
    ds_read_b64_tr_b16 v[76:77], v27 offset:3072
    ds_read_b64_tr_b16 v[78:79], v27 offset:3840
    v_mfma_f32_32x32x16_bf16 v[152:167], v[64:67], v[92:95], v[152:167]
    ds_read_b64_tr_b16 v[80:81], v28 offset:3072
    ds_read_b64_tr_b16 v[82:83], v28 offset:3840
    s_waitcnt lgkmcnt(7)
    v_mfma_f32_32x32x16_bf16 v[120:135], v[96:99], v[68:71], v[120:135]
    ds_read_b128 v[64:67], v20 offset:0
    ds_read_b64_tr_b16 v[84:85], v26 offset:6144
    ds_read_b64_tr_b16 v[86:87], v26 offset:6912
    v_mfma_f32_32x32x16_bf16 v[136:151], v[100:103], v[68:71], v[136:151]
    ds_read_b64_tr_b16 v[88:89], v27 offset:6144
    ds_read_b64_tr_b16 v[90:91], v27 offset:6912
    v_mfma_f32_32x32x16_bf16 v[152:167], v[68:71], v[104:107], v[152:167]
    ds_read_b64_tr_b16 v[92:93], v28 offset:6144
    ds_read_b64_tr_b16 v[94:95], v28 offset:6912
    s_waitcnt lgkmcnt(7)
    v_mfma_f32_32x32x16_bf16 v[120:135], v[72:75], v[60:63], v[120:135]
    ds_read_b128 v[68:71], v21 offset:0
    ds_read_b64_tr_b16 v[96:97], v26 offset:9216
    ds_read_b64_tr_b16 v[98:99], v26 offset:9984
    v_mfma_f32_32x32x16_bf16 v[136:151], v[76:79], v[60:63], v[136:151]
    ds_read_b64_tr_b16 v[100:101], v27 offset:9216
    ds_read_b64_tr_b16 v[102:103], v27 offset:9984
    v_mfma_f32_32x32x16_bf16 v[152:167], v[60:63], v[80:83], v[152:167]
    ds_read_b64_tr_b16 v[104:105], v28 offset:9216
    ds_read_b64_tr_b16 v[106:107], v28 offset:9984
    s_waitcnt lgkmcnt(0)
    s_barrier
    v_mfma_f32_32x32x16_bf16 v[120:135], v[84:87], v[64:67], v[120:135]
    ds_read_b128 v[60:63], v18 offset:28672
    ds_read_b64_tr_b16 v[72:73], v26 offset:28672
    ds_read_b64_tr_b16 v[74:75], v26 offset:29440
    v_mfma_f32_32x32x16_bf16 v[136:151], v[88:91], v[64:67], v[136:151]
    ds_read_b64_tr_b16 v[76:77], v27 offset:28672
    ds_read_b64_tr_b16 v[78:79], v27 offset:29440
    v_mfma_f32_32x32x16_bf16 v[152:167], v[64:67], v[92:95], v[152:167]
    ds_read_b64_tr_b16 v[80:81], v28 offset:28672
    ds_read_b64_tr_b16 v[82:83], v28 offset:29440
    s_waitcnt lgkmcnt(7)
    v_mfma_f32_32x32x16_bf16 v[120:135], v[96:99], v[68:71], v[120:135]
    ds_read_b128 v[64:67], v19 offset:28672
    ds_read_b64_tr_b16 v[84:85], v26 offset:31744
    ds_read_b64_tr_b16 v[86:87], v26 offset:32512
    v_mfma_f32_32x32x16_bf16 v[136:151], v[100:103], v[68:71], v[136:151]
    ds_read_b64_tr_b16 v[88:89], v27 offset:31744
    ds_read_b64_tr_b16 v[90:91], v27 offset:32512
    v_mfma_f32_32x32x16_bf16 v[152:167], v[68:71], v[104:107], v[152:167]
    ds_read_b64_tr_b16 v[92:93], v28 offset:31744
    ds_read_b64_tr_b16 v[94:95], v28 offset:32512
    s_waitcnt lgkmcnt(7)
    v_mfma_f32_32x32x16_bf16 v[120:135], v[72:75], v[60:63], v[120:135]
    ds_read_b128 v[68:71], v20 offset:28672
    ds_read_b64_tr_b16 v[96:97], v26 offset:34816
    ds_read_b64_tr_b16 v[98:99], v26 offset:35584
    v_mfma_f32_32x32x16_bf16 v[136:151], v[76:79], v[60:63], v[136:151]
    ds_read_b64_tr_b16 v[100:101], v27 offset:34816
    ds_read_b64_tr_b16 v[102:103], v27 offset:35584
    v_mfma_f32_32x32x16_bf16 v[152:167], v[60:63], v[80:83], v[152:167]
    ds_read_b64_tr_b16 v[104:105], v28 offset:34816
    ds_read_b64_tr_b16 v[106:107], v28 offset:35584
    s_waitcnt lgkmcnt(7)
    v_mfma_f32_32x32x16_bf16 v[120:135], v[84:87], v[64:67], v[120:135]
    ds_read_b128 v[60:63], v21 offset:28672
    ds_read_b64_tr_b16 v[72:73], v26 offset:37888
    ds_read_b64_tr_b16 v[74:75], v26 offset:38656
    v_mfma_f32_32x32x16_bf16 v[136:151], v[88:91], v[64:67], v[136:151]
    ds_read_b64_tr_b16 v[76:77], v27 offset:37888
    ds_read_b64_tr_b16 v[78:79], v27 offset:38656
    v_mfma_f32_32x32x16_bf16 v[152:167], v[64:67], v[92:95], v[152:167]
    ds_read_b64_tr_b16 v[80:81], v28 offset:37888
    ds_read_b64_tr_b16 v[82:83], v28 offset:38656
    s_waitcnt lgkmcnt(0)
    s_barrier
    v_mfma_f32_32x32x16_bf16 v[120:135], v[96:99], v[68:71], v[120:135]
    ds_read_b128 v[64:67], v14 offset:0
    ds_read_b64_tr_b16 v[84:85], v22 offset:0
    ds_read_b64_tr_b16 v[86:87], v22 offset:768
    v_mfma_f32_32x32x16_bf16 v[136:151], v[100:103], v[68:71], v[136:151]
    ds_read_b64_tr_b16 v[88:89], v23 offset:0
    ds_read_b64_tr_b16 v[90:91], v23 offset:768
    v_mfma_f32_32x32x16_bf16 v[152:167], v[68:71], v[104:107], v[152:167]
    ds_read_b64_tr_b16 v[92:93], v24 offset:0
    ds_read_b64_tr_b16 v[94:95], v24 offset:768
    s_waitcnt lgkmcnt(7)
    v_mfma_f32_32x32x16_bf16 v[120:135], v[72:75], v[60:63], v[120:135]
    ds_read_b128 v[68:71], v15 offset:0
    ds_read_b64_tr_b16 v[96:97], v22 offset:3072
    ds_read_b64_tr_b16 v[98:99], v22 offset:3840
    v_mfma_f32_32x32x16_bf16 v[136:151], v[76:79], v[60:63], v[136:151]
    ds_read_b64_tr_b16 v[100:101], v23 offset:3072
    ds_read_b64_tr_b16 v[102:103], v23 offset:3840
    v_mfma_f32_32x32x16_bf16 v[152:167], v[60:63], v[80:83], v[152:167]
    ds_read_b64_tr_b16 v[104:105], v24 offset:3072
    ds_read_b64_tr_b16 v[106:107], v24 offset:3840
    s_waitcnt lgkmcnt(7)
    v_mfma_f32_32x32x16_bf16 v[120:135], v[84:87], v[64:67], v[120:135]
    ds_read_b128 v[60:63], v16 offset:0
    ds_read_b64_tr_b16 v[72:73], v22 offset:6144
    ds_read_b64_tr_b16 v[74:75], v22 offset:6912
    v_mfma_f32_32x32x16_bf16 v[136:151], v[88:91], v[64:67], v[136:151]
    ds_read_b64_tr_b16 v[76:77], v23 offset:6144
    ds_read_b64_tr_b16 v[78:79], v23 offset:6912
    v_mfma_f32_32x32x16_bf16 v[152:167], v[64:67], v[92:95], v[152:167]
    ds_read_b64_tr_b16 v[80:81], v24 offset:6144
    ds_read_b64_tr_b16 v[82:83], v24 offset:6912
    s_waitcnt lgkmcnt(7)
    v_mfma_f32_32x32x16_bf16 v[120:135], v[96:99], v[68:71], v[120:135]
    ds_read_b128 v[64:67], v17 offset:0
    ds_read_b64_tr_b16 v[84:85], v22 offset:9216
    ds_read_b64_tr_b16 v[86:87], v22 offset:9984
    v_mfma_f32_32x32x16_bf16 v[136:151], v[100:103], v[68:71], v[136:151]
    ds_read_b64_tr_b16 v[88:89], v23 offset:9216
    ds_read_b64_tr_b16 v[90:91], v23 offset:9984
    v_mfma_f32_32x32x16_bf16 v[152:167], v[68:71], v[104:107], v[152:167]
    ds_read_b64_tr_b16 v[92:93], v24 offset:9216
    ds_read_b64_tr_b16 v[94:95], v24 offset:9984
    s_waitcnt lgkmcnt(0)
    s_barrier
    v_mfma_f32_32x32x16_bf16 v[120:135], v[72:75], v[60:63], v[120:135]
    ds_read_b128 v[68:71], v14 offset:28672
    ds_read_b64_tr_b16 v[96:97], v22 offset:28672
    ds_read_b64_tr_b16 v[98:99], v22 offset:29440
    v_mfma_f32_32x32x16_bf16 v[136:151], v[76:79], v[60:63], v[136:151]
    ds_read_b64_tr_b16 v[100:101], v23 offset:28672
    ds_read_b64_tr_b16 v[102:103], v23 offset:29440
    v_mfma_f32_32x32x16_bf16 v[152:167], v[60:63], v[80:83], v[152:167]
    ds_read_b64_tr_b16 v[104:105], v24 offset:28672
    ds_read_b64_tr_b16 v[106:107], v24 offset:29440
    s_waitcnt lgkmcnt(7)
    v_mfma_f32_32x32x16_bf16 v[120:135], v[84:87], v[64:67], v[120:135]
    ds_read_b128 v[60:63], v15 offset:28672
    ds_read_b64_tr_b16 v[72:73], v22 offset:31744
    ds_read_b64_tr_b16 v[74:75], v22 offset:32512
    v_mfma_f32_32x32x16_bf16 v[136:151], v[88:91], v[64:67], v[136:151]
    ds_read_b64_tr_b16 v[76:77], v23 offset:31744
    ds_read_b64_tr_b16 v[78:79], v23 offset:32512
    v_mfma_f32_32x32x16_bf16 v[152:167], v[64:67], v[92:95], v[152:167]
    ds_read_b64_tr_b16 v[80:81], v24 offset:31744
    ds_read_b64_tr_b16 v[82:83], v24 offset:32512
    s_waitcnt lgkmcnt(7)
    v_mfma_f32_32x32x16_bf16 v[120:135], v[96:99], v[68:71], v[120:135]
    ds_read_b128 v[64:67], v16 offset:28672
    ds_read_b64_tr_b16 v[84:85], v22 offset:34816
    ds_read_b64_tr_b16 v[86:87], v22 offset:35584
    v_mfma_f32_32x32x16_bf16 v[136:151], v[100:103], v[68:71], v[136:151]
    ds_read_b64_tr_b16 v[88:89], v23 offset:34816
    ds_read_b64_tr_b16 v[90:91], v23 offset:35584
    v_mfma_f32_32x32x16_bf16 v[152:167], v[68:71], v[104:107], v[152:167]
    ds_read_b64_tr_b16 v[92:93], v24 offset:34816
    ds_read_b64_tr_b16 v[94:95], v24 offset:35584
    s_waitcnt lgkmcnt(7)
    v_mfma_f32_32x32x16_bf16 v[120:135], v[72:75], v[60:63], v[120:135]
    ds_read_b128 v[68:71], v17 offset:28672
    ds_read_b64_tr_b16 v[96:97], v22 offset:37888
    ds_read_b64_tr_b16 v[98:99], v22 offset:38656
    v_mfma_f32_32x32x16_bf16 v[136:151], v[76:79], v[60:63], v[136:151]
    ds_read_b64_tr_b16 v[100:101], v23 offset:37888
    ds_read_b64_tr_b16 v[102:103], v23 offset:38656
    v_mfma_f32_32x32x16_bf16 v[152:167], v[60:63], v[80:83], v[152:167]
    ds_read_b64_tr_b16 v[104:105], v24 offset:37888
    ds_read_b64_tr_b16 v[106:107], v24 offset:38656
    s_waitcnt lgkmcnt(0)
    s_barrier
    v_mfma_f32_32x32x16_bf16 v[120:135], v[84:87], v[64:67], v[120:135]
    ds_read_b128 v[60:63], v18 offset:0
    ds_read_b64_tr_b16 v[72:73], v26 offset:0
    ds_read_b64_tr_b16 v[74:75], v26 offset:768
    v_mfma_f32_32x32x16_bf16 v[136:151], v[88:91], v[64:67], v[136:151]
    ds_read_b64_tr_b16 v[76:77], v27 offset:0
    ds_read_b64_tr_b16 v[78:79], v27 offset:768
    v_mfma_f32_32x32x16_bf16 v[152:167], v[64:67], v[92:95], v[152:167]
    ds_read_b64_tr_b16 v[80:81], v28 offset:0
    ds_read_b64_tr_b16 v[82:83], v28 offset:768
    s_waitcnt lgkmcnt(7)
    v_mfma_f32_32x32x16_bf16 v[120:135], v[96:99], v[68:71], v[120:135]
    ds_read_b128 v[64:67], v19 offset:0
    ds_read_b64_tr_b16 v[84:85], v26 offset:3072
    ds_read_b64_tr_b16 v[86:87], v26 offset:3840
    v_mfma_f32_32x32x16_bf16 v[136:151], v[100:103], v[68:71], v[136:151]
    ds_read_b64_tr_b16 v[88:89], v27 offset:3072
    ds_read_b64_tr_b16 v[90:91], v27 offset:3840
    v_mfma_f32_32x32x16_bf16 v[152:167], v[68:71], v[104:107], v[152:167]
    ds_read_b64_tr_b16 v[92:93], v28 offset:3072
    ds_read_b64_tr_b16 v[94:95], v28 offset:3840
    s_waitcnt lgkmcnt(7)
    v_mfma_f32_32x32x16_bf16 v[120:135], v[72:75], v[60:63], v[120:135]
    ds_read_b128 v[68:71], v20 offset:0
    ds_read_b64_tr_b16 v[96:97], v26 offset:6144
    ds_read_b64_tr_b16 v[98:99], v26 offset:6912
    v_mfma_f32_32x32x16_bf16 v[136:151], v[76:79], v[60:63], v[136:151]
    ds_read_b64_tr_b16 v[100:101], v27 offset:6144
    ds_read_b64_tr_b16 v[102:103], v27 offset:6912
    v_mfma_f32_32x32x16_bf16 v[152:167], v[60:63], v[80:83], v[152:167]
    ds_read_b64_tr_b16 v[104:105], v28 offset:6144
    ds_read_b64_tr_b16 v[106:107], v28 offset:6912
    s_waitcnt lgkmcnt(7)
    v_mfma_f32_32x32x16_bf16 v[120:135], v[84:87], v[64:67], v[120:135]
    ds_read_b128 v[60:63], v21 offset:0
    ds_read_b64_tr_b16 v[72:73], v26 offset:9216
    ds_read_b64_tr_b16 v[74:75], v26 offset:9984
    v_mfma_f32_32x32x16_bf16 v[136:151], v[88:91], v[64:67], v[136:151]
    ds_read_b64_tr_b16 v[76:77], v27 offset:9216
    ds_read_b64_tr_b16 v[78:79], v27 offset:9984
    v_mfma_f32_32x32x16_bf16 v[152:167], v[64:67], v[92:95], v[152:167]
    ds_read_b64_tr_b16 v[80:81], v28 offset:9216
    ds_read_b64_tr_b16 v[82:83], v28 offset:9984
    s_waitcnt lgkmcnt(0)
    s_barrier
    v_mfma_f32_32x32x16_bf16 v[120:135], v[96:99], v[68:71], v[120:135]
    ds_read_b128 v[64:67], v18 offset:28672
    ds_read_b64_tr_b16 v[84:85], v26 offset:28672
    ds_read_b64_tr_b16 v[86:87], v26 offset:29440
    v_mfma_f32_32x32x16_bf16 v[136:151], v[100:103], v[68:71], v[136:151]
    ds_read_b64_tr_b16 v[88:89], v27 offset:28672
    ds_read_b64_tr_b16 v[90:91], v27 offset:29440
    v_mfma_f32_32x32x16_bf16 v[152:167], v[68:71], v[104:107], v[152:167]
    ds_read_b64_tr_b16 v[92:93], v28 offset:28672
    ds_read_b64_tr_b16 v[94:95], v28 offset:29440
    s_waitcnt lgkmcnt(7)
    v_mfma_f32_32x32x16_bf16 v[120:135], v[72:75], v[60:63], v[120:135]
    ds_read_b128 v[68:71], v19 offset:28672
    ds_read_b64_tr_b16 v[96:97], v26 offset:31744
    ds_read_b64_tr_b16 v[98:99], v26 offset:32512
    v_mfma_f32_32x32x16_bf16 v[136:151], v[76:79], v[60:63], v[136:151]
    ds_read_b64_tr_b16 v[100:101], v27 offset:31744
    ds_read_b64_tr_b16 v[102:103], v27 offset:32512
    v_mfma_f32_32x32x16_bf16 v[152:167], v[60:63], v[80:83], v[152:167]
    ds_read_b64_tr_b16 v[104:105], v28 offset:31744
    ds_read_b64_tr_b16 v[106:107], v28 offset:32512
    s_waitcnt lgkmcnt(7)
    v_mfma_f32_32x32x16_bf16 v[120:135], v[84:87], v[64:67], v[120:135]
    ds_read_b128 v[60:63], v20 offset:28672
    ds_read_b64_tr_b16 v[72:73], v26 offset:34816
    ds_read_b64_tr_b16 v[74:75], v26 offset:35584
    v_mfma_f32_32x32x16_bf16 v[136:151], v[88:91], v[64:67], v[136:151]
    ds_read_b64_tr_b16 v[76:77], v27 offset:34816
    ds_read_b64_tr_b16 v[78:79], v27 offset:35584
    v_mfma_f32_32x32x16_bf16 v[152:167], v[64:67], v[92:95], v[152:167]
    ds_read_b64_tr_b16 v[80:81], v28 offset:34816
    ds_read_b64_tr_b16 v[82:83], v28 offset:35584
    s_waitcnt lgkmcnt(7)
    v_mfma_f32_32x32x16_bf16 v[120:135], v[96:99], v[68:71], v[120:135]
    ds_read_b128 v[64:67], v21 offset:28672
    ds_read_b64_tr_b16 v[84:85], v26 offset:37888
    ds_read_b64_tr_b16 v[86:87], v26 offset:38656
    v_mfma_f32_32x32x16_bf16 v[136:151], v[100:103], v[68:71], v[136:151]
    ds_read_b64_tr_b16 v[88:89], v27 offset:37888
    ds_read_b64_tr_b16 v[90:91], v27 offset:38656
    v_mfma_f32_32x32x16_bf16 v[152:167], v[68:71], v[104:107], v[152:167]
    ds_read_b64_tr_b16 v[92:93], v28 offset:37888
    ds_read_b64_tr_b16 v[94:95], v28 offset:38656
    s_waitcnt lgkmcnt(7)
    v_mfma_f32_32x32x16_bf16 v[120:135], v[72:75], v[60:63], v[120:135]
    v_mfma_f32_32x32x16_bf16 v[136:151], v[76:79], v[60:63], v[136:151]
    v_mfma_f32_32x32x16_bf16 v[152:167], v[60:63], v[80:83], v[152:167]
    s_waitcnt lgkmcnt(0)
    v_mfma_f32_32x32x16_bf16 v[120:135], v[84:87], v[64:67], v[120:135]
    v_mfma_f32_32x32x16_bf16 v[136:151], v[88:91], v[64:67], v[136:151]
    v_mfma_f32_32x32x16_bf16 v[152:167], v[64:67], v[92:95], v[152:167]
    s_waitcnt vmcnt(0)
    v_pk_add_f32 v[44:45], v[44:45], v[46:47]
    v_pk_add_f32 v[48:49], v[48:49], v[50:51]
    v_pk_add_f32 v[52:53], v[52:53], v[54:55]
    v_pk_add_f32 v[56:57], v[56:57], v[58:59]
    v_pk_add_f32 v[44:45], v[44:45], v[48:49]
    v_pk_add_f32 v[52:53], v[52:53], v[56:57]
    v_pk_add_f32 v[44:45], v[44:45], v[52:53]
    v_mov_b32 v33, v44
    v_mov_b32 v34, v45
    v_mov_b32 v2, v33
    s_nop 1
    v_permlane32_swap_b32 v33, v2
    v_add_f32 v33, v33, v2
    v_mov_b32 v2, v34
    s_nop 1
    v_permlane32_swap_b32 v34, v2
    v_add_f32 v34, v34, v2
    v_mul_f32 v37, 0x3b000000, v33
    v_mul_f32 v2, 0x3b000000, v34
    v_fma_f32 v2, -v37, v37, v2
    v_max_f32 v2, 0, v2
    v_cvt_pk_bf16_f32 v3, v2, v2
    v_and_b32 v2, 0xffff0000, v3
    v_add_f32 v2, 0x3727c5ac, v2
    v_cvt_pk_bf16_f32 v3, v2, v2
    v_and_b32 v2, 0xffff0000, v3
    v_sqrt_f32 v2, v2
    s_nop 0
    v_cvt_pk_bf16_f32 v3, v2, v2
    v_and_b32 v2, 0xffff0000, v3
    v_rcp_f32 v38, v2
    v_cvt_pk_bf16_f32 v3, v37, v37
    v_and_b32 v37, 0xffff0000, v3
    v_mov_b32 v39, v38
    v_mul_f32 v40, v37, v38
    v_sub_f32 v40, 0, v40
    v_mov_b32 v41, v40
    v_and_b32 v2, 31, v1
    v_lshlrev_b32 v2, 2, v2
    s_lshl_b32 s22, s3, 7
    v_add_u32 v3, s22, v2
    v_add_u32 v3, 114688, v3
    s_lshl_b32 s22, s3, 8
    v_add_u32 v4, s22, v2
    v_add_u32 v4, 115712, v4
    ds_write_b32 v4, v37
    ds_write_b32 v4, v38 offset:128
    s_waitcnt lgkmcnt(0)
    s_barrier
    v_lshrrev_b32 v5, 5, v1
    v_lshlrev_b32 v5, 4, v5
    v_add_u32 v5, 114688, v5
    ds_read_b128 v[168:171], v5 offset:0
    ds_read_b128 v[172:175], v5 offset:32
    ds_read_b128 v[176:179], v5 offset:64
    ds_read_b128 v[180:183], v5 offset:96
    ds_read_b128 v[184:187], v5 offset:128
    ds_read_b128 v[188:191], v5 offset:160
    ds_read_b128 v[192:195], v5 offset:192
    ds_read_b128 v[196:199], v5 offset:224
    s_lshl_b32 s22, s20, 2
    s_add_u32 s22, s22, s3
    s_lshl_b32 s23, s22, 10
    s_lshl_b32 s24, s21, 17
    s_add_u32 s23, s23, s24
    v_lshlrev_b32 v228, 4, v1
    v_add_u32 v228, s23, v228
    v_mul_f32 v224, 0x3eb8aa3b, v38
    v_mul_f32 v226, 0x3eb8aa3b, v40
    v_mov_b32 v225, v224
    v_mov_b32 v227, v226
    s_waitcnt lgkmcnt(4)
    v_pk_mul_f32 v[168:169], v[168:169], v[226:227]
    v_pk_mul_f32 v[170:171], v[170:171], v[226:227]
    v_pk_mul_f32 v[172:173], v[172:173], v[226:227]
    v_pk_mul_f32 v[174:175], v[174:175], v[226:227]
    v_pk_mul_f32 v[176:177], v[176:177], v[226:227]
    v_pk_mul_f32 v[178:179], v[178:179], v[226:227]
    v_pk_mul_f32 v[180:181], v[180:181], v[226:227]
    v_pk_mul_f32 v[182:183], v[182:183], v[226:227]
    v_pk_fma_f32 v[120:121], v[120:121], v[224:225], v[168:169]
    v_pk_fma_f32 v[122:123], v[122:123], v[224:225], v[170:171]
    v_pk_fma_f32 v[124:125], v[124:125], v[224:225], v[172:173]
    v_pk_fma_f32 v[126:127], v[126:127], v[224:225], v[174:175]
    v_pk_fma_f32 v[128:129], v[128:129], v[224:225], v[176:177]
    v_pk_fma_f32 v[130:131], v[130:131], v[224:225], v[178:179]
    v_pk_fma_f32 v[132:133], v[132:133], v[224:225], v[180:181]
    v_pk_fma_f32 v[134:135], v[134:135], v[224:225], v[182:183]
    v_cvt_pk_bf16_f32 v200, v120, v121
    v_cvt_pk_bf16_f32 v201, v122, v123
    v_cvt_pk_bf16_f32 v202, v124, v125
    v_cvt_pk_bf16_f32 v203, v126, v127
    v_cvt_pk_bf16_f32 v204, v128, v129
    v_cvt_pk_bf16_f32 v205, v130, v131
    v_cvt_pk_bf16_f32 v206, v132, v133
    v_cvt_pk_bf16_f32 v207, v134, v135
    s_nop 0
    v_permlane32_swap_b32 v200, v202
    v_permlane32_swap_b32 v201, v203
    s_mov_b32 s25, 0
    buffer_store_dwordx4 v[200:203], v228, s[12:15], s25 offen
    v_permlane32_swap_b32 v204, v206
    v_permlane32_swap_b32 v205, v207
    s_mov_b32 s25, 65536
    buffer_store_dwordx4 v[204:207], v228, s[12:15], s25 offen
    s_waitcnt lgkmcnt(0)
    v_pk_mul_f32 v[184:185], v[184:185], v[40:41]
    v_pk_mul_f32 v[186:187], v[186:187], v[40:41]
    v_pk_mul_f32 v[188:189], v[188:189], v[40:41]
    v_pk_mul_f32 v[190:191], v[190:191], v[40:41]
    v_pk_mul_f32 v[192:193], v[192:193], v[40:41]
    v_pk_mul_f32 v[194:195], v[194:195], v[40:41]
    v_pk_mul_f32 v[196:197], v[196:197], v[40:41]
    v_pk_mul_f32 v[198:199], v[198:199], v[40:41]
    v_pk_fma_f32 v[136:137], v[136:137], v[38:39], v[184:185]
    v_pk_fma_f32 v[138:139], v[138:139], v[38:39], v[186:187]
    v_pk_fma_f32 v[140:141], v[140:141], v[38:39], v[188:189]
    v_pk_fma_f32 v[142:143], v[142:143], v[38:39], v[190:191]
    v_pk_fma_f32 v[144:145], v[144:145], v[38:39], v[192:193]
    v_pk_fma_f32 v[146:147], v[146:147], v[38:39], v[194:195]
    v_pk_fma_f32 v[148:149], v[148:149], v[38:39], v[196:197]
    v_pk_fma_f32 v[150:151], v[150:151], v[38:39], v[198:199]
    v_cvt_pk_bf16_f32 v208, v136, v137
    v_cvt_pk_bf16_f32 v209, v138, v139
    v_cvt_pk_bf16_f32 v210, v140, v141
    v_cvt_pk_bf16_f32 v211, v142, v143
    v_cvt_pk_bf16_f32 v212, v144, v145
    v_cvt_pk_bf16_f32 v213, v146, v147
    v_cvt_pk_bf16_f32 v214, v148, v149
    v_cvt_pk_bf16_f32 v215, v150, v151
    s_nop 0
    v_permlane32_swap_b32 v208, v210
    v_permlane32_swap_b32 v209, v211
    s_mov_b32 s25, 2097152
    buffer_store_dwordx4 v[208:211], v228, s[12:15], s25 offen
    v_permlane32_swap_b32 v212, v214
    v_permlane32_swap_b32 v213, v215
    s_mov_b32 s25, 2162688
    buffer_store_dwordx4 v[212:215], v228, s[12:15], s25 offen
    v_and_b32 v2, 31, v1
    v_lshlrev_b32 v2, 2, v2
    v_add_u32 v2, 114688, v2
    ds_read_b32 v35, v2 offset:256
    s_lshl_b32 s25, s3, 8
    v_add_u32 v4, s25, v5
    ds_read_b128 v[168:171], v4 offset:1024
    ds_read_b128 v[184:187], v4 offset:1152
    ds_read_b128 v[172:175], v4 offset:1056
    ds_read_b128 v[188:191], v4 offset:1184
    ds_read_b128 v[176:179], v4 offset:1088
    ds_read_b128 v[192:195], v4 offset:1216
    ds_read_b128 v[180:183], v4 offset:1120
    ds_read_b128 v[196:199], v4 offset:1248
    v_bfe_u32 v229, v1, 4, 1
    v_lshlrev_b32 v229, 16, v229
    v_lshrrev_b32 v2, 5, v1
    v_lshl_add_u32 v229, v2, 8, v229
    v_and_b32 v2, 15, v1
    v_lshl_add_u32 v229, v2, 4, v229
    v_add_u32 v229, s23, v229
    s_waitcnt lgkmcnt(0)
    v_sub_f32 v224, 0, v35
    v_sub_f32 v225, 0, v35
    v_pk_fma_f32 v[152:153], v[168:169], v[224:225], v[152:153]
    v_pk_fma_f32 v[154:155], v[170:171], v[224:225], v[154:155]
    v_pk_fma_f32 v[156:157], v[172:173], v[224:225], v[156:157]
    v_pk_fma_f32 v[158:159], v[174:175], v[224:225], v[158:159]
    v_pk_fma_f32 v[160:161], v[176:177], v[224:225], v[160:161]
    v_pk_fma_f32 v[162:163], v[178:179], v[224:225], v[162:163]
    v_pk_fma_f32 v[164:165], v[180:181], v[224:225], v[164:165]
    v_pk_fma_f32 v[166:167], v[182:183], v[224:225], v[166:167]
    v_pk_mul_f32 v[152:153], v[152:153], v[184:185]
    v_pk_mul_f32 v[154:155], v[154:155], v[186:187]
    v_pk_mul_f32 v[156:157], v[156:157], v[188:189]
    v_pk_mul_f32 v[158:159], v[158:159], v[190:191]
    v_pk_mul_f32 v[160:161], v[160:161], v[192:193]
    v_pk_mul_f32 v[162:163], v[162:163], v[194:195]
    v_pk_mul_f32 v[164:165], v[164:165], v[196:197]
    v_pk_mul_f32 v[166:167], v[166:167], v[198:199]
    v_cvt_pk_bf16_f32 v216, v152, v153
    v_cvt_pk_bf16_f32 v217, v154, v155
    v_cvt_pk_bf16_f32 v218, v156, v157
    v_cvt_pk_bf16_f32 v219, v158, v159
    s_mov_b32 s25, 4194304
    buffer_store_dwordx4 v[216:219], v229, s[12:15], s25 offen
    v_cvt_pk_bf16_f32 v220, v160, v161
    v_cvt_pk_bf16_f32 v221, v162, v163
    v_cvt_pk_bf16_f32 v222, v164, v165
    v_cvt_pk_bf16_f32 v223, v166, v167
    s_mov_b32 s25, 4194816
    buffer_store_dwordx4 v[220:223], v229, s[12:15], s25 offen
qkv2_kernel_end:
    s_endpgm
.section .rodata,"a"
.p2align 6
.amdhsa_kernel qkv2_kernel
  .amdhsa_next_free_vgpr 232
  .amdhsa_next_free_sgpr 96
  .amdhsa_accum_offset 232
  .amdhsa_group_segment_fixed_size 0
  .amdhsa_kernarg_size 80
  .amdhsa_user_sgpr_count 2
  .amdhsa_user_sgpr_kernarg_segment_ptr 1
  .amdhsa_system_sgpr_workgroup_id_x 1
.end_amdhsa_kernel
.text
.globl wo2_kernel
.p2align 8
.type wo2_kernel,@function
wo2_kernel:
    s_cmp_ge_u32 s2, 256
    s_cbranch_scc1 wo2_kernel_end
    s_load_dwordx2 s[28:29], s[0:1], 72
    s_load_dwordx2 s[30:31], s[0:1], 16
    s_load_dwordx2 s[32:33], s[0:1], 0
    s_load_dwordx2 s[34:35], s[0:1], 56
    v_and_b32 v1, 63, v0
    v_lshrrev_b32 v2, 6, v0
    s_and_b32 s20, s2, 7
    v_readfirstlane_b32 s44, v2
    s_lshl_b32 s20, s20, 2
    s_bfe_u32 s22, s2, 0x20003
    s_add_u32 s20, s20, s22
    s_lshr_b32 s21, s2, 5
    s_and_b32 s3, s44, 3
    s_cmp_lt_u32 s44, 4
    s_cbranch_scc1 wo2_kernel_comp
    s_lshl_b32 s22, s20, 1
    s_lshr_b32 s23, s3, 1
    s_add_u32 s22, s22, s23
    s_mul_i32 s22, s22, 32768
    s_and_b32 s23, s3, 1
    s_lshl_b32 s23, s23, 11
    s_add_u32 s22, s22, s23
    v_lshlrev_b32 v6, 4, v1
    v_add_u32 v6, s22, v6
    v_add_u32 v7, 1024, v6
    s_lshl_b32 s26, s3, 11
    s_waitcnt lgkmcnt(0)
    s_add_u32 s4, s28, 0x600000
    s_addc_u32 s5, s29, 0
    s_and_b32 s5, s5, 0xffff
    s_mov_b32 s6, 0x200000
    s_mov_b32 s7, 0x00020000
    s_add_u32 s8, s28, 0x1800000
    s_addc_u32 s9, s29, 0
    s_and_b32 s9, s9, 0xffff
    s_mov_b32 s10, 0x80000
    s_mov_b32 s11, 0x00020000
    s_mul_i32 s23, s21, 65536
    s_add_u32 s23, s23, s26
    v_lshlrev_b32 v8, 4, v1
    v_add_u32 v8, s23, v8
    v_add_u32 v9, 1024, v8
    s_mov_b32 s24, 0
    s_mov_b32 s25, 0
    s_add_u32 m0, s26, 0
    s_nop 0
    buffer_load_dwordx4 v6, s[4:7], s24 offen lds
    s_add_u32 m0, s26, 1024
    s_nop 0
    buffer_load_dwordx4 v7, s[4:7], s24 offen lds
    s_add_u32 m0, s26, 8192
    s_nop 0
    buffer_load_dwordx4 v8, s[8:11], s25 offen lds
    s_add_u32 m0, s26, 9216
    s_nop 0
    buffer_load_dwordx4 v9, s[8:11], s25 offen lds
    s_mov_b32 s24, 4096
    s_mov_b32 s25, 8192
    s_add_u32 m0, s26, 16384
    s_nop 0
    buffer_load_dwordx4 v6, s[4:7], s24 offen lds
    s_add_u32 m0, s26, 17408
    s_nop 0
    buffer_load_dwordx4 v7, s[4:7], s24 offen lds
    s_add_u32 m0, s26, 24576
    s_nop 0
    buffer_load_dwordx4 v8, s[8:11], s25 offen lds
    s_add_u32 m0, s26, 25600
    s_nop 0
    buffer_load_dwordx4 v9, s[8:11], s25 offen lds
    s_mov_b32 s24, 8192
    s_mov_b32 s25, 16384
    s_add_u32 m0, s26, 32768
    s_nop 0
    buffer_load_dwordx4 v6, s[4:7], s24 offen lds
    s_add_u32 m0, s26, 33792
    s_nop 0
    buffer_load_dwordx4 v7, s[4:7], s24 offen lds
    s_add_u32 m0, s26, 40960
    s_nop 0
    buffer_load_dwordx4 v8, s[8:11], s25 offen lds
    s_add_u32 m0, s26, 41984
    s_nop 0
    buffer_load_dwordx4 v9, s[8:11], s25 offen lds
    s_mov_b32 s24, 12288
    s_mov_b32 s25, 24576
    s_add_u32 m0, s26, 49152
    s_nop 0
    buffer_load_dwordx4 v6, s[4:7], s24 offen lds
    s_add_u32 m0, s26, 50176
    s_nop 0
    buffer_load_dwordx4 v7, s[4:7], s24 offen lds
    s_add_u32 m0, s26, 57344
    s_nop 0
    buffer_load_dwordx4 v8, s[8:11], s25 offen lds
    s_add_u32 m0, s26, 58368
    s_nop 0
    buffer_load_dwordx4 v9, s[8:11], s25 offen lds
    s_mov_b32 s24, 16384
    s_mov_b32 s25, 32768
    s_add_u32 m0, s26, 65536
    s_nop 0
    buffer_load_dwordx4 v6, s[4:7], s24 offen lds
    s_add_u32 m0, s26, 66560
    s_nop 0
    buffer_load_dwordx4 v7, s[4:7], s24 offen lds
    s_add_u32 m0, s26, 73728
    s_nop 0
    buffer_load_dwordx4 v8, s[8:11], s25 offen lds
    s_add_u32 m0, s26, 74752
    s_nop 0
    buffer_load_dwordx4 v9, s[8:11], s25 offen lds
    s_mov_b32 s24, 20480
    s_mov_b32 s25, 40960
    s_add_u32 m0, s26, 81920
    s_nop 0
    buffer_load_dwordx4 v6, s[4:7], s24 offen lds
    s_add_u32 m0, s26, 82944
    s_nop 0
    buffer_load_dwordx4 v7, s[4:7], s24 offen lds
    s_add_u32 m0, s26, 90112
    s_nop 0
    buffer_load_dwordx4 v8, s[8:11], s25 offen lds
    s_add_u32 m0, s26, 91136
    s_nop 0
    buffer_load_dwordx4 v9, s[8:11], s25 offen lds
    s_waitcnt vmcnt(20)
    s_barrier
    s_mov_b32 s24, 24576
    s_mov_b32 s25, 49152
    s_add_u32 m0, s26, 98304
    s_nop 0
    buffer_load_dwordx4 v6, s[4:7], s24 offen lds
    s_add_u32 m0, s26, 99328
    s_nop 0
    buffer_load_dwordx4 v7, s[4:7], s24 offen lds
    s_add_u32 m0, s26, 106496
    s_nop 0
    buffer_load_dwordx4 v8, s[8:11], s25 offen lds
    s_add_u32 m0, s26, 107520
    s_nop 0
    buffer_load_dwordx4 v9, s[8:11], s25 offen lds
    s_waitcnt vmcnt(20)
    s_barrier
    s_mov_b32 s24, 28672
    s_mov_b32 s25, 57344
    s_add_u32 m0, s26, 114688
    s_nop 0
    buffer_load_dwordx4 v6, s[4:7], s24 offen lds
    s_add_u32 m0, s26, 115712
    s_nop 0
    buffer_load_dwordx4 v7, s[4:7], s24 offen lds
    s_add_u32 m0, s26, 122880
    s_nop 0
    buffer_load_dwordx4 v8, s[8:11], s25 offen lds
    s_add_u32 m0, s26, 123904
    s_nop 0
    buffer_load_dwordx4 v9, s[8:11], s25 offen lds
    s_waitcnt vmcnt(20)
    s_barrier
    s_waitcnt vmcnt(16)
    s_barrier
    s_waitcnt vmcnt(12)
    s_barrier
    s_waitcnt vmcnt(8)
    s_barrier
    s_waitcnt vmcnt(4)
    s_barrier
    s_waitcnt vmcnt(0)
    s_barrier
    s_endpgm
wo2_kernel_comp:
    s_lshl_b32 s22, s20, 1
    s_and_b32 s23, s3, 1
    s_add_u32 s22, s22, s23
    s_lshl_b32 s23, s21, 1
    s_lshr_b32 s25, s3, 1
    s_add_u32 s23, s23, s25
    s_lshl_b32 s24, s22, 15
    s_lshl_b32 s25, s23, 6
    s_add_u32 s25, s24, s25
    v_and_b32 v4, 31, v1
    v_lshlrev_b32 v4, 10, v4
    v_lshrrev_b32 v2, 5, v1
    v_lshl_add_u32 v4, v2, 4, v4
    v_add_u32 v4, s25, v4
    s_lshl_b32 s25, s23, 11
    s_add_u32 s25, s24, s25
    v_lshlrev_b32 v5, 4, v1
    v_add_u32 v5, s25, v5
    v_mov_b32 v88, v5
    v_mov_b32 v89, v5
    s_lshl_b32 s27, s22, 12
    s_lshl_b32 s23, s23, 3
    s_add_u32 s27, s27, s23
    s_add_u32 s27, s27, 14680064
    s_and_b32 s22, s3, 1
    s_lshl_b32 s22, s22, 12
    v_lshlrev_b32 v10, 4, v1
    v_add_u32 v10, s22, v10
    v_add_u32 v11, 1024, v10
    v_add_u32 v12, 2048, v10
    v_add_u32 v13, 3072, v10
    v_add_u32 v14, 65536, v10
    v_add_u32 v15, 65536, v11
    v_add_u32 v16, 65536, v12
    v_add_u32 v17, 65536, v13
    s_lshr_b32 s22, s3, 1
    v_bfe_u32 v2, v1, 2, 2
    v_lshrrev_b32 v3, 5, v1
    v_lshl_add_u32 v3, v3, 3, v2
    v_lshlrev_b32 v3, 7, v3
    v_lshrrev_b32 v4, 1, v2
    v_xor_b32 v4, s22, v4
    v_lshl_add_u32 v3, v4, 6, v3
    v_bfe_u32 v4, v1, 4, 1
    v_lshl_add_u32 v3, v4, 5, v3
    v_and_b32 v4, 3, v1
    v_lshl_add_u32 v3, v4, 3, v3
    v_add_u32 v18, 8192, v3
    v_add_u32 v19, 65536, v18
    v_mov_b32 v20, 0x3f803f80
    v_mov_b32 v56, 0
    v_mov_b32 v57, 0
    v_mov_b32 v58, 0
    v_mov_b32 v59, 0
    v_mov_b32 v60, 0
    v_mov_b32 v61, 0
    v_mov_b32 v62, 0
    v_mov_b32 v63, 0
    v_mov_b32 v64, 0
    v_mov_b32 v65, 0
    v_mov_b32 v66, 0
    v_mov_b32 v67, 0
    v_mov_b32 v68, 0
    v_mov_b32 v69, 0
    v_mov_b32 v70, 0
    v_mov_b32 v71, 0
    s_waitcnt lgkmcnt(0)
    s_add_u32 s16, s28, 0xa00000
    s_addc_u32 s17, s29, 0
    s_and_b32 s17, s17, 0xffff
    s_mov_b32 s18, 0x200000
    s_mov_b32 s19, 0x00020000
    buffer_load_dwordx4 v[72:75], v89, s[16:19], 0 offen offset:0
    buffer_load_dwordx4 v[76:79], v89, s[16:19], 0 offen offset:1024
    s_add_u32 s12, s28, 0xc00000
    s_addc_u32 s13, s29, 0
    s_and_b32 s13, s13, 0xffff
    s_mov_b32 s14, 0x200000
    s_mov_b32 s15, 0x00020000
    s_mov_b32 s40, s28
    s_mov_b32 s41, s29
    s_and_b32 s41, s41, 0xffff
    s_mov_b32 s42, 0x10000000
    s_mov_b32 s43, 0x00020000
    s_barrier
    ds_read_b128 v[24:27], v10 offset:0
    ds_read_b64_tr_b16 v[40:41], v18 offset:0
    ds_read_b64_tr_b16 v[42:43], v18 offset:512
    ds_read_b128 v[28:31], v11 offset:0
    ds_read_b64_tr_b16 v[44:45], v18 offset:2048
    ds_read_b64_tr_b16 v[46:47], v18 offset:2560
    s_waitcnt lgkmcnt(3)
    v_mfma_f32_32x32x16_bf16 v[56:71], v[40:43], v[24:27], v[56:71]
    ds_read_b128 v[32:35], v12 offset:0
    ds_read_b64_tr_b16 v[48:49], v18 offset:4096
    ds_read_b64_tr_b16 v[50:51], v18 offset:4608
    s_waitcnt lgkmcnt(3)
    v_mfma_f32_32x32x16_bf16 v[56:71], v[44:47], v[28:31], v[56:71]
    ds_read_b128 v[36:39], v13 offset:0
    ds_read_b64_tr_b16 v[52:53], v18 offset:6144
    ds_read_b64_tr_b16 v[54:55], v18 offset:6656
    s_waitcnt lgkmcnt(3)
    s_barrier
    v_mfma_f32_32x32x16_bf16 v[56:71], v[48:51], v[32:35], v[56:71]
    ds_read_b128 v[24:27], v10 offset:16384
    ds_read_b64_tr_b16 v[40:41], v18 offset:16384
    ds_read_b64_tr_b16 v[42:43], v18 offset:16896
    s_waitcnt lgkmcnt(3)
    v_mfma_f32_32x32x16_bf16 v[56:71], v[52:55], v[36:39], v[56:71]
    ds_read_b128 v[28:31], v11 offset:16384
    ds_read_b64_tr_b16 v[44:45], v18 offset:18432
    ds_read_b64_tr_b16 v[46:47], v18 offset:18944
    s_waitcnt lgkmcnt(3)
    v_mfma_f32_32x32x16_bf16 v[56:71], v[40:43], v[24:27], v[56:71]
    ds_read_b128 v[32:35], v12 offset:16384
    ds_read_b64_tr_b16 v[48:49], v18 offset:20480
    ds_read_b64_tr_b16 v[50:51], v18 offset:20992
    s_waitcnt lgkmcnt(3)
    v_mfma_f32_32x32x16_bf16 v[56:71], v[44:47], v[28:31], v[56:71]
    ds_read_b128 v[36:39], v13 offset:16384
    ds_read_b64_tr_b16 v[52:53], v18 offset:22528
    ds_read_b64_tr_b16 v[54:55], v18 offset:23040
    s_waitcnt lgkmcnt(3)
    s_barrier
    v_mfma_f32_32x32x16_bf16 v[56:71], v[48:51], v[32:35], v[56:71]
    ds_read_b128 v[24:27], v10 offset:32768
    ds_read_b64_tr_b16 v[40:41], v18 offset:32768
    ds_read_b64_tr_b16 v[42:43], v18 offset:33280
    s_waitcnt lgkmcnt(3)
    v_mfma_f32_32x32x16_bf16 v[56:71], v[52:55], v[36:39], v[56:71]
    ds_read_b128 v[28:31], v11 offset:32768
    ds_read_b64_tr_b16 v[44:45], v18 offset:34816
    ds_read_b64_tr_b16 v[46:47], v18 offset:35328
    s_waitcnt lgkmcnt(3)
    v_mfma_f32_32x32x16_bf16 v[56:71], v[40:43], v[24:27], v[56:71]
    ds_read_b128 v[32:35], v12 offset:32768
    ds_read_b64_tr_b16 v[48:49], v18 offset:36864
    ds_read_b64_tr_b16 v[50:51], v18 offset:37376
    s_waitcnt lgkmcnt(3)
    v_mfma_f32_32x32x16_bf16 v[56:71], v[44:47], v[28:31], v[56:71]
    ds_read_b128 v[36:39], v13 offset:32768
    ds_read_b64_tr_b16 v[52:53], v18 offset:38912
    ds_read_b64_tr_b16 v[54:55], v18 offset:39424
    s_waitcnt lgkmcnt(3)
    s_barrier
    v_mfma_f32_32x32x16_bf16 v[56:71], v[48:51], v[32:35], v[56:71]
    ds_read_b128 v[24:27], v10 offset:49152
    ds_read_b64_tr_b16 v[40:41], v18 offset:49152
    ds_read_b64_tr_b16 v[42:43], v18 offset:49664
    s_waitcnt lgkmcnt(3)
    v_mfma_f32_32x32x16_bf16 v[56:71], v[52:55], v[36:39], v[56:71]
    ds_read_b128 v[28:31], v11 offset:49152
    ds_read_b64_tr_b16 v[44:45], v18 offset:51200
    ds_read_b64_tr_b16 v[46:47], v18 offset:51712
    s_waitcnt lgkmcnt(3)
    v_mfma_f32_32x32x16_bf16 v[56:71], v[40:43], v[24:27], v[56:71]
    ds_read_b128 v[32:35], v12 offset:49152
    ds_read_b64_tr_b16 v[48:49], v18 offset:53248
    ds_read_b64_tr_b16 v[50:51], v18 offset:53760
    s_waitcnt lgkmcnt(3)
    v_mfma_f32_32x32x16_bf16 v[56:71], v[44:47], v[28:31], v[56:71]
    ds_read_b128 v[36:39], v13 offset:49152
    ds_read_b64_tr_b16 v[52:53], v18 offset:55296
    ds_read_b64_tr_b16 v[54:55], v18 offset:55808
    s_waitcnt lgkmcnt(3)
    s_barrier
    v_mfma_f32_32x32x16_bf16 v[56:71], v[48:51], v[32:35], v[56:71]
    ds_read_b128 v[24:27], v14 offset:0
    ds_read_b64_tr_b16 v[40:41], v19 offset:0
    ds_read_b64_tr_b16 v[42:43], v19 offset:512
    s_waitcnt lgkmcnt(3)
    v_mfma_f32_32x32x16_bf16 v[56:71], v[52:55], v[36:39], v[56:71]
    ds_read_b128 v[28:31], v15 offset:0
    ds_read_b64_tr_b16 v[44:45], v19 offset:2048
    ds_read_b64_tr_b16 v[46:47], v19 offset:2560
    s_waitcnt lgkmcnt(3)
    v_mfma_f32_32x32x16_bf16 v[56:71], v[40:43], v[24:27], v[56:71]
    ds_read_b128 v[32:35], v16 offset:0
    ds_read_b64_tr_b16 v[48:49], v19 offset:4096
    ds_read_b64_tr_b16 v[50:51], v19 offset:4608
    s_waitcnt lgkmcnt(3)
    v_mfma_f32_32x32x16_bf16 v[56:71], v[44:47], v[28:31], v[56:71]
    ds_read_b128 v[36:39], v17 offset:0
    ds_read_b64_tr_b16 v[52:53], v19 offset:6144
    ds_read_b64_tr_b16 v[54:55], v19 offset:6656
    s_waitcnt lgkmcnt(3)
    s_barrier
    v_mfma_f32_32x32x16_bf16 v[56:71], v[48:51], v[32:35], v[56:71]
    ds_read_b128 v[24:27], v14 offset:16384
    ds_read_b64_tr_b16 v[40:41], v19 offset:16384
    ds_read_b64_tr_b16 v[42:43], v19 offset:16896
    s_waitcnt lgkmcnt(3)
    v_mfma_f32_32x32x16_bf16 v[56:71], v[52:55], v[36:39], v[56:71]
    ds_read_b128 v[28:31], v15 offset:16384
    ds_read_b64_tr_b16 v[44:45], v19 offset:18432
    ds_read_b64_tr_b16 v[46:47], v19 offset:18944
    s_waitcnt lgkmcnt(3)
    v_mfma_f32_32x32x16_bf16 v[56:71], v[40:43], v[24:27], v[56:71]
    ds_read_b128 v[32:35], v16 offset:16384
    ds_read_b64_tr_b16 v[48:49], v19 offset:20480
    ds_read_b64_tr_b16 v[50:51], v19 offset:20992
    s_waitcnt lgkmcnt(3)
    v_mfma_f32_32x32x16_bf16 v[56:71], v[44:47], v[28:31], v[56:71]
    ds_read_b128 v[36:39], v17 offset:16384
    ds_read_b64_tr_b16 v[52:53], v19 offset:22528
    ds_read_b64_tr_b16 v[54:55], v19 offset:23040
    s_waitcnt lgkmcnt(3)
    s_barrier
    v_mfma_f32_32x32x16_bf16 v[56:71], v[48:51], v[32:35], v[56:71]
    ds_read_b128 v[24:27], v14 offset:32768
    ds_read_b64_tr_b16 v[40:41], v19 offset:32768
    ds_read_b64_tr_b16 v[42:43], v19 offset:33280
    s_waitcnt lgkmcnt(3)
    v_mfma_f32_32x32x16_bf16 v[56:71], v[52:55], v[36:39], v[56:71]
    ds_read_b128 v[28:31], v15 offset:32768
    ds_read_b64_tr_b16 v[44:45], v19 offset:34816
    ds_read_b64_tr_b16 v[46:47], v19 offset:35328
    s_waitcnt lgkmcnt(3)
    v_mfma_f32_32x32x16_bf16 v[56:71], v[40:43], v[24:27], v[56:71]
    ds_read_b128 v[32:35], v16 offset:32768
    ds_read_b64_tr_b16 v[48:49], v19 offset:36864
    ds_read_b64_tr_b16 v[50:51], v19 offset:37376
    s_waitcnt lgkmcnt(3)
    v_mfma_f32_32x32x16_bf16 v[56:71], v[44:47], v[28:31], v[56:71]
    ds_read_b128 v[36:39], v17 offset:32768
    ds_read_b64_tr_b16 v[52:53], v19 offset:38912
    ds_read_b64_tr_b16 v[54:55], v19 offset:39424
    s_waitcnt lgkmcnt(3)
    s_barrier
    v_mfma_f32_32x32x16_bf16 v[56:71], v[48:51], v[32:35], v[56:71]
    ds_read_b128 v[24:27], v14 offset:49152
    ds_read_b64_tr_b16 v[40:41], v19 offset:49152
    ds_read_b64_tr_b16 v[42:43], v19 offset:49664
    s_waitcnt lgkmcnt(3)
    v_mfma_f32_32x32x16_bf16 v[56:71], v[52:55], v[36:39], v[56:71]
    ds_read_b128 v[28:31], v15 offset:49152
    ds_read_b64_tr_b16 v[44:45], v19 offset:51200
    ds_read_b64_tr_b16 v[46:47], v19 offset:51712
    s_waitcnt lgkmcnt(3)
    v_mfma_f32_32x32x16_bf16 v[56:71], v[40:43], v[24:27], v[56:71]
    ds_read_b128 v[32:35], v16 offset:49152
    ds_read_b64_tr_b16 v[48:49], v19 offset:53248
    ds_read_b64_tr_b16 v[50:51], v19 offset:53760
    s_waitcnt lgkmcnt(3)
    v_mfma_f32_32x32x16_bf16 v[56:71], v[44:47], v[28:31], v[56:71]
    ds_read_b128 v[36:39], v17 offset:49152
    ds_read_b64_tr_b16 v[52:53], v19 offset:55296
    ds_read_b64_tr_b16 v[54:55], v19 offset:55808
    s_waitcnt lgkmcnt(3)
    v_mfma_f32_32x32x16_bf16 v[56:71], v[48:51], v[32:35], v[56:71]
    s_waitcnt lgkmcnt(0)
    v_mfma_f32_32x32x16_bf16 v[56:71], v[52:55], v[36:39], v[56:71]
    s_waitcnt vmcnt(0)
    s_nop 15
    v_cvt_pk_bf16_f32 v80, v56, v57
    v_cvt_pk_bf16_f32 v81, v58, v59
    v_cvt_pk_bf16_f32 v82, v60, v61
    v_cvt_pk_bf16_f32 v83, v62, v63
    v_cvt_pk_bf16_f32 v84, v64, v65
    v_cvt_pk_bf16_f32 v85, v66, v67
    v_cvt_pk_bf16_f32 v86, v68, v69
    v_cvt_pk_bf16_f32 v87, v70, v71
    s_nop 0
    v_permlane32_swap_b32 v80, v82
    v_permlane32_swap_b32 v81, v83
    v_permlane32_swap_b32 v84, v86
    v_permlane32_swap_b32 v85, v87
    v_lshlrev_b32 v2, 16, v80
    v_lshlrev_b32 v3, 16, v72
    v_add_f32 v2, v2, v3
    v_and_b32 v4, 0xffff0000, v80
    v_and_b32 v5, 0xffff0000, v72
    v_add_f32 v4, v4, v5
    v_cvt_pk_bf16_f32 v80, v2, v4
    v_lshlrev_b32 v2, 16, v81
    v_lshlrev_b32 v3, 16, v73
    v_add_f32 v2, v2, v3
    v_and_b32 v4, 0xffff0000, v81
    v_and_b32 v5, 0xffff0000, v73
    v_add_f32 v4, v4, v5
    v_cvt_pk_bf16_f32 v81, v2, v4
    v_lshlrev_b32 v2, 16, v82
    v_lshlrev_b32 v3, 16, v74
    v_add_f32 v2, v2, v3
    v_and_b32 v4, 0xffff0000, v82
    v_and_b32 v5, 0xffff0000, v74
    v_add_f32 v4, v4, v5
    v_cvt_pk_bf16_f32 v82, v2, v4
    v_lshlrev_b32 v2, 16, v83
    v_lshlrev_b32 v3, 16, v75
    v_add_f32 v2, v2, v3
    v_and_b32 v4, 0xffff0000, v83
    v_and_b32 v5, 0xffff0000, v75
    v_add_f32 v4, v4, v5
    v_cvt_pk_bf16_f32 v83, v2, v4
    buffer_store_dwordx4 v[80:83], v88, s[12:15], 0 offen offset:0
    v_lshlrev_b32 v2, 16, v84
    v_lshlrev_b32 v3, 16, v76
    v_add_f32 v2, v2, v3
    v_and_b32 v4, 0xffff0000, v84
    v_and_b32 v5, 0xffff0000, v76
    v_add_f32 v4, v4, v5
    v_cvt_pk_bf16_f32 v84, v2, v4
    v_lshlrev_b32 v2, 16, v85
    v_lshlrev_b32 v3, 16, v77
    v_add_f32 v2, v2, v3
    v_and_b32 v4, 0xffff0000, v85
    v_and_b32 v5, 0xffff0000, v77
    v_add_f32 v4, v4, v5
    v_cvt_pk_bf16_f32 v85, v2, v4
    v_lshlrev_b32 v2, 16, v86
    v_lshlrev_b32 v3, 16, v78
    v_add_f32 v2, v2, v3
    v_and_b32 v4, 0xffff0000, v86
    v_and_b32 v5, 0xffff0000, v78
    v_add_f32 v4, v4, v5
    v_cvt_pk_bf16_f32 v86, v2, v4
    v_lshlrev_b32 v2, 16, v87
    v_lshlrev_b32 v3, 16, v79
    v_add_f32 v2, v2, v3
    v_and_b32 v4, 0xffff0000, v87
    v_and_b32 v5, 0xffff0000, v79
    v_add_f32 v4, v4, v5
    v_cvt_pk_bf16_f32 v87, v2, v4
    buffer_store_dwordx4 v[84:87], v88, s[12:15], 0 offen offset:1024
    v_mov_b32 v90, 0
    v_mov_b32 v91, 0
    v_dot2c_f32_bf16 v90, v80, v20
    v_dot2c_f32_bf16 v91, v80, v80
    v_dot2c_f32_bf16 v90, v81, v20
    v_dot2c_f32_bf16 v91, v81, v81
    v_dot2c_f32_bf16 v90, v82, v20
    v_dot2c_f32_bf16 v91, v82, v82
    v_dot2c_f32_bf16 v90, v83, v20
    v_dot2c_f32_bf16 v91, v83, v83
    v_dot2c_f32_bf16 v90, v84, v20
    v_dot2c_f32_bf16 v91, v84, v84
    v_dot2c_f32_bf16 v90, v85, v20
    v_dot2c_f32_bf16 v91, v85, v85
    v_dot2c_f32_bf16 v90, v86, v20
    v_dot2c_f32_bf16 v91, v86, v86
    v_dot2c_f32_bf16 v90, v87, v20
    v_dot2c_f32_bf16 v91, v87, v87
    v_and_b32 v4, 31, v1
    v_lshlrev_b32 v4, 7, v4
    s_nop 1
    v_mov_b32 v2, v90
    s_nop 1
    v_permlane32_swap_b32 v90, v2
    v_add_f32 v90, v90, v2
    v_mov_b32 v2, v91
    s_nop 1
    v_permlane32_swap_b32 v91, v2
    v_add_f32 v91, v91, v2
    s_mov_b32 exec_hi, 0
    buffer_store_dwordx2 v[90:91], v4, s[40:43], s27 offen
    s_mov_b64 exec, -1
wo2_kernel_end:
    s_endpgm
.section .rodata,"a"
.p2align 6
.amdhsa_kernel wo2_kernel
  .amdhsa_next_free_vgpr 96
  .amdhsa_next_free_sgpr 96
  .amdhsa_accum_offset 96
  .amdhsa_group_segment_fixed_size 0
  .amdhsa_kernarg_size 80
  .amdhsa_user_sgpr_count 2
  .amdhsa_user_sgpr_kernarg_segment_ptr 1
  .amdhsa_system_sgpr_workgroup_id_x 1
.end_amdhsa_kernel
.text
.globl ffa2_kernel
.p2align 8
.type ffa2_kernel,@function
ffa2_kernel:
    s_cmp_ge_u32 s2, 224
    s_cbranch_scc1 ffa2_kernel_end
    s_load_dwordx2 s[28:29], s[0:1], 72
    s_load_dwordx2 s[30:31], s[0:1], 32
    s_load_dwordx2 s[32:33], s[0:1], 0
    s_load_dwordx2 s[34:35], s[0:1], 40
    v_and_b32 v1, 63, v0
    v_lshrrev_b32 v2, 6, v0
    s_bfe_u32 s20, s2, 0x20001
    v_readfirstlane_b32 s44, v2
    s_lshl_b32 s20, s20, 2
    s_bfe_u32 s22, s2, 0x20003
    s_add_u32 s20, s20, s22
    s_and_b32 s21, s2, 1
    s_mul_i32 s21, s21, 7
    s_lshr_b32 s22, s2, 5
    s_add_u32 s21, s21, s22
    s_and_b32 s3, s44, 3
    s_lshl_b32 s26, s3, 12
    s_lshl_b32 s22, s20, 7
    s_lshl_b32 s23, s3, 5
    s_add_u32 s22, s22, s23
    s_cmp_lt_u32 s44, 4
    s_cbranch_scc1 ffa2_kernel_comp
    s_lshl_b32 s24, s22, 10
    v_lshlrev_b32 v6, 4, v1
    v_add_u32 v6, s24, v6
    v_add_u32 v7, 1024, v6
    v_add_u32 v8, 2048, v6
    v_add_u32 v9, 3072, v6
    s_lshl_b32 s24, s3, 4
    s_lshl_b32 s23, s21, 8
    v_lshrrev_b32 v2, 4, v1
    v_bfe_u32 v3, v1, 2, 2
    v_xor_b32 v3, v3, v2
    v_lshlrev_b32 v3, 6, v3
    v_and_b32 v4, 3, v1
    v_lshlrev_b32 v4, 4, v4
    v_add3_u32 v3, v3, v4, s23
    v_add_u32 v4, s24, v2
    v_mul_u32_u24 v10, 3584, v4
    v_add_u32 v10, v10, v3
    v_add_u32 v11, 14336, v10
    v_add_u32 v12, 28672, v10
    v_add_u32 v13, 43008, v10
    s_mul_i32 s27, s3, 4096
    s_waitcnt lgkmcnt(0)
    s_add_u32 s4, s28, 0xc00000
    s_addc_u32 s5, s29, 0
    s_and_b32 s5, s5, 0xffff
    s_mov_b32 s6, 0x200000
    s_mov_b32 s7, 0x00020000
    s_add_u32 s8, s28, 0x1900000
    s_addc_u32 s9, s29, 0
    s_and_b32 s9, s9, 0xffff
    s_mov_b32 s10, 0x1c0000
    s_mov_b32 s11, 0x00020000
    s_mul_i32 s23, s21, 131072
    s_add_u32 s23, s23, s27
    v_lshlrev_b32 v10, 4, v1
    v_add_u32 v10, s23, v10
    v_add_u32 v11, 1024, v10
    v_add_u32 v12, 2048, v10
    v_add_u32 v13, 3072, v10
    s_mov_b32 s24, 0
    s_add_u32 m0, s26, 0
    s_nop 0
    buffer_load_dwordx4 v6, s[4:7], s24 offen lds
    s_add_u32 m0, s26, 1024
    s_nop 0
    buffer_load_dwordx4 v7, s[4:7], s24 offen lds
    s_add_u32 m0, s26, 2048
    s_nop 0
    buffer_load_dwordx4 v8, s[4:7], s24 offen lds
    s_add_u32 m0, s26, 3072
    s_nop 0
    buffer_load_dwordx4 v9, s[4:7], s24 offen lds
    s_mov_b32 s25, 0
    s_add_u32 m0, s27, 16384
    s_nop 0
    buffer_load_dwordx4 v10, s[8:11], s25 offen lds
    s_add_u32 m0, s27, 17408
    s_nop 0
    buffer_load_dwordx4 v11, s[8:11], s25 offen lds
    s_add_u32 m0, s27, 18432
    s_nop 0
    buffer_load_dwordx4 v12, s[8:11], s25 offen lds
    s_add_u32 m0, s27, 19456
    s_nop 0
    buffer_load_dwordx4 v13, s[8:11], s25 offen lds
    s_mov_b32 s24, 4096
    s_add_u32 m0, s26, 32768
    s_nop 0
    buffer_load_dwordx4 v6, s[4:7], s24 offen lds
    s_add_u32 m0, s26, 33792
    s_nop 0
    buffer_load_dwordx4 v7, s[4:7], s24 offen lds
    s_add_u32 m0, s26, 34816
    s_nop 0
    buffer_load_dwordx4 v8, s[4:7], s24 offen lds
    s_add_u32 m0, s26, 35840
    s_nop 0
    buffer_load_dwordx4 v9, s[4:7], s24 offen lds
    s_mov_b32 s25, 16384
    s_add_u32 m0, s27, 49152
    s_nop 0
    buffer_load_dwordx4 v10, s[8:11], s25 offen lds
    s_add_u32 m0, s27, 50176
    s_nop 0
    buffer_load_dwordx4 v11, s[8:11], s25 offen lds
    s_add_u32 m0, s27, 51200
    s_nop 0
    buffer_load_dwordx4 v12, s[8:11], s25 offen lds
    s_add_u32 m0, s27, 52224
    s_nop 0
    buffer_load_dwordx4 v13, s[8:11], s25 offen lds
    s_mov_b32 s24, 8192
    s_add_u32 m0, s26, 65536
    s_nop 0
    buffer_load_dwordx4 v6, s[4:7], s24 offen lds
    s_add_u32 m0, s26, 66560
    s_nop 0
    buffer_load_dwordx4 v7, s[4:7], s24 offen lds
    s_add_u32 m0, s26, 67584
    s_nop 0
    buffer_load_dwordx4 v8, s[4:7], s24 offen lds
    s_add_u32 m0, s26, 68608
    s_nop 0
    buffer_load_dwordx4 v9, s[4:7], s24 offen lds
    s_mov_b32 s25, 32768
    s_add_u32 m0, s27, 81920
    s_nop 0
    buffer_load_dwordx4 v10, s[8:11], s25 offen lds
    s_add_u32 m0, s27, 82944
    s_nop 0
    buffer_load_dwordx4 v11, s[8:11], s25 offen lds
    s_add_u32 m0, s27, 83968
    s_nop 0
    buffer_load_dwordx4 v12, s[8:11], s25 offen lds
    s_add_u32 m0, s27, 84992
    s_nop 0
    buffer_load_dwordx4 v13, s[8:11], s25 offen lds
    s_waitcnt vmcnt(16)
    s_barrier
    s_mov_b32 s24, 12288
    s_add_u32 m0, s26, 98304
    s_nop 0
    buffer_load_dwordx4 v6, s[4:7], s24 offen lds
    s_add_u32 m0, s26, 99328
    s_nop 0
    buffer_load_dwordx4 v7, s[4:7], s24 offen lds
    s_add_u32 m0, s26, 100352
    s_nop 0
    buffer_load_dwordx4 v8, s[4:7], s24 offen lds
    s_add_u32 m0, s26, 101376
    s_nop 0
    buffer_load_dwordx4 v9, s[4:7], s24 offen lds
    s_mov_b32 s25, 49152
    s_add_u32 m0, s27, 114688
    s_nop 0
    buffer_load_dwordx4 v10, s[8:11], s25 offen lds
    s_add_u32 m0, s27, 115712
    s_nop 0
    buffer_load_dwordx4 v11, s[8:11], s25 offen lds
    s_add_u32 m0, s27, 116736
    s_nop 0
    buffer_load_dwordx4 v12, s[8:11], s25 offen lds
    s_add_u32 m0, s27, 117760
    s_nop 0
    buffer_load_dwordx4 v13, s[8:11], s25 offen lds
    s_waitcnt vmcnt(16)
    s_barrier
    s_mov_b32 s24, 16384
    s_add_u32 m0, s26, 0
    s_nop 0
    buffer_load_dwordx4 v6, s[4:7], s24 offen lds
    s_add_u32 m0, s26, 1024
    s_nop 0
    buffer_load_dwordx4 v7, s[4:7], s24 offen lds
    s_add_u32 m0, s26, 2048
    s_nop 0
    buffer_load_dwordx4 v8, s[4:7], s24 offen lds
    s_add_u32 m0, s26, 3072
    s_nop 0
    buffer_load_dwordx4 v9, s[4:7], s24 offen lds
    s_mov_b32 s25, 65536
    s_add_u32 m0, s27, 16384
    s_nop 0
    buffer_load_dwordx4 v10, s[8:11], s25 offen lds
    s_add_u32 m0, s27, 17408
    s_nop 0
    buffer_load_dwordx4 v11, s[8:11], s25 offen lds
    s_add_u32 m0, s27, 18432
    s_nop 0
    buffer_load_dwordx4 v12, s[8:11], s25 offen lds
    s_add_u32 m0, s27, 19456
    s_nop 0
    buffer_load_dwordx4 v13, s[8:11], s25 offen lds
    s_waitcnt vmcnt(16)
    s_barrier
    s_mov_b32 s24, 20480
    s_add_u32 m0, s26, 32768
    s_nop 0
    buffer_load_dwordx4 v6, s[4:7], s24 offen lds
    s_add_u32 m0, s26, 33792
    s_nop 0
    buffer_load_dwordx4 v7, s[4:7], s24 offen lds
    s_add_u32 m0, s26, 34816
    s_nop 0
    buffer_load_dwordx4 v8, s[4:7], s24 offen lds
    s_add_u32 m0, s26, 35840
    s_nop 0
    buffer_load_dwordx4 v9, s[4:7], s24 offen lds
    s_mov_b32 s25, 81920
    s_add_u32 m0, s27, 49152
    s_nop 0
    buffer_load_dwordx4 v10, s[8:11], s25 offen lds
    s_add_u32 m0, s27, 50176
    s_nop 0
    buffer_load_dwordx4 v11, s[8:11], s25 offen lds
    s_add_u32 m0, s27, 51200
    s_nop 0
    buffer_load_dwordx4 v12, s[8:11], s25 offen lds
    s_add_u32 m0, s27, 52224
    s_nop 0
    buffer_load_dwordx4 v13, s[8:11], s25 offen lds
    s_waitcnt vmcnt(16)
    s_barrier
    s_mov_b32 s24, 24576
    s_add_u32 m0, s26, 65536
    s_nop 0
    buffer_load_dwordx4 v6, s[4:7], s24 offen lds
    s_add_u32 m0, s26, 66560
    s_nop 0
    buffer_load_dwordx4 v7, s[4:7], s24 offen lds
    s_add_u32 m0, s26, 67584
    s_nop 0
    buffer_load_dwordx4 v8, s[4:7], s24 offen lds
    s_add_u32 m0, s26, 68608
    s_nop 0
    buffer_load_dwordx4 v9, s[4:7], s24 offen lds
    s_mov_b32 s25, 98304
    s_add_u32 m0, s27, 81920
    s_nop 0
    buffer_load_dwordx4 v10, s[8:11], s25 offen lds
    s_add_u32 m0, s27, 82944
    s_nop 0
    buffer_load_dwordx4 v11, s[8:11], s25 offen lds
    s_add_u32 m0, s27, 83968
    s_nop 0
    buffer_load_dwordx4 v12, s[8:11], s25 offen lds
    s_add_u32 m0, s27, 84992
    s_nop 0
    buffer_load_dwordx4 v13, s[8:11], s25 offen lds
    s_waitcnt vmcnt(16)
    s_barrier
    s_mov_b32 s24, 28672
    s_add_u32 m0, s26, 98304
    s_nop 0
    buffer_load_dwordx4 v6, s[4:7], s24 offen lds
    s_add_u32 m0, s26, 99328
    s_nop 0
    buffer_load_dwordx4 v7, s[4:7], s24 offen lds
    s_add_u32 m0, s26, 100352
    s_nop 0
    buffer_load_dwordx4 v8, s[4:7], s24 offen lds
    s_add_u32 m0, s26, 101376
    s_nop 0
    buffer_load_dwordx4 v9, s[4:7], s24 offen lds
    s_mov_b32 s25, 114688
    s_add_u32 m0, s27, 114688
    s_nop 0
    buffer_load_dwordx4 v10, s[8:11], s25 offen lds
    s_add_u32 m0, s27, 115712
    s_nop 0
    buffer_load_dwordx4 v11, s[8:11], s25 offen lds
    s_add_u32 m0, s27, 116736
    s_nop 0
    buffer_load_dwordx4 v12, s[8:11], s25 offen lds
    s_add_u32 m0, s27, 117760
    s_nop 0
    buffer_load_dwordx4 v13, s[8:11], s25 offen lds
    s_waitcnt vmcnt(16)
    s_barrier
    s_waitcnt vmcnt(8)
    s_barrier
    s_mov_b32 s12, s28
    s_mov_b32 s13, s29
    s_and_b32 s13, s13, 0xffff
    s_mov_b32 s14, 0x10000000
    s_mov_b32 s15, 0x00020000
    v_and_b32 v2, 31, v1
    v_lshlrev_b32 v2, 2, v2
    s_min_u32 s23, s3, 3
    s_lshl_b32 s23, s23, 7
    s_lshl_b32 s22, s21, 9
    s_add_u32 s23, s23, s22
    s_add_u32 s23, s23, 15736832
    buffer_load_dword v3, v2, s[12:15], s23 offen
    s_lshl_b32 s22, s3, 7
    v_add_u32 v4, s22, v2
    v_add_u32 v4, 131072, v4
    s_waitcnt vmcnt(0)
    ds_write_b32 v4, v3
    s_waitcnt lgkmcnt(0)
    s_barrier
    s_endpgm
ffa2_kernel_comp:
    v_and_b32 v2, 31, v1
    v_add_u32 v2, s22, v2
    v_lshlrev_b32 v2, 7, v2
    v_lshrrev_b32 v3, 5, v1
    v_lshl_add_u32 v196, v3, 6, v2
    v_and_b32 v3, 31, v1
    v_lshlrev_b32 v3, 1, v3
    s_lshl_b32 s24, s3, 6
    s_lshl_b32 s23, s21, 8
    s_add_u32 s24, s24, s23
    v_add_u32 v197, s24, v3
    v_lshlrev_b32 v14, 4, v1
    v_add_u32 v14, s26, v14
    v_add_u32 v15, 1024, v14
    v_add_u32 v16, 2048, v14
    v_add_u32 v17, 3072, v14
    v_bfe_u32 v2, v1, 2, 2
    v_lshrrev_b32 v3, 5, v1
    v_lshl_add_u32 v3, v3, 3, v2
    v_mul_u32_u24 v3, 256, v3
    v_bfe_u32 v4, v1, 4, 1
    v_lshl_add_u32 v3, v4, 5, v3
    v_and_b32 v4, 3, v1
    v_lshl_add_u32 v3, v4, 3, v3
    v_add_u32 v3, 16384, v3
    v_xor_b32 v4, 0, v2
    v_lshl_add_u32 v22, v4, 6, v3
    v_xor_b32 v4, 1, v2
    v_lshl_add_u32 v23, v4, 6, v3
    v_xor_b32 v4, 2, v2
    v_lshl_add_u32 v24, v4, 6, v3
    v_xor_b32 v4, 3, v2
    v_lshl_add_u32 v25, v4, 6, v3
    s_min_u32 s23, s3, 3
    v_xor_b32 v4, s23, v2
    v_lshl_add_u32 v30, v4, 6, v3
    v_add_u32 v18, 65536, v14
    v_add_u32 v19, 65536, v15
    v_add_u32 v20, 65536, v16
    v_add_u32 v21, 65536, v17
    v_add_u32 v26, 65536, v22
    v_add_u32 v27, 65536, v23
    v_add_u32 v28, 65536, v24
    v_add_u32 v29, 65536, v25
    v_add_u32 v31, 65536, v30
    v_mov_b32 v32, 0x3f803f80
    v_mov_b32 v33, 0
    v_mov_b32 v34, 0
    v_mov_b32 v35, 0
    v_mov_b32 v244, 0
    v_mov_b32 v245, 0
    v_mov_b32 v246, 0
    v_mov_b32 v247, 0
    v_mov_b32 v248, 0
    v_mov_b32 v249, 0
    s_mov_b32 s36, 2.0
    s_mov_b32 s37, 2.0
    s_mov_b32 s38, 0x3fb8aa3b
    s_mov_b32 s39, 0x3fb8aa3b
    s_waitcnt lgkmcnt(0)
    s_mov_b32 s12, s28
    s_mov_b32 s13, s29
    s_and_b32 s13, s13, 0xffff
    s_mov_b32 s14, 0x10000000
    s_mov_b32 s15, 0x00020000
    s_mov_b32 s16, s34
    s_mov_b32 s17, s35
    s_and_b32 s17, s17, 0xffff
    s_mov_b32 s18, 0xe00
    s_mov_b32 s19, 0x00020000
    s_mov_b32 s24, 14680064
    buffer_load_dwordx4 v[44:47], v196, s[12:15], s24 offen offset:0
    buffer_load_dwordx4 v[48:51], v196, s[12:15], s24 offen offset:16
    buffer_load_dwordx4 v[52:55], v196, s[12:15], s24 offen offset:32
    buffer_load_dwordx4 v[56:59], v196, s[12:15], s24 offen offset:48
    buffer_load_ushort v36, v197, s[16:19], 0 offen
    s_barrier
    ds_read_b128 v[60:63], v14 offset:0
    ds_read_b64_tr_b16 v[72:73], v22 offset:0
    ds_read_b64_tr_b16 v[74:75], v22 offset:1024
    ds_read_b64_tr_b16 v[76:77], v23 offset:0
    ds_read_b64_tr_b16 v[78:79], v23 offset:1024
    ds_read_b64_tr_b16 v[80:81], v24 offset:0
    ds_read_b64_tr_b16 v[82:83], v24 offset:1024
    ds_read_b64_tr_b16 v[84:85], v25 offset:0
    ds_read_b64_tr_b16 v[86:87], v25 offset:1024
    ds_read_b128 v[64:67], v15 offset:0
    ds_read_b64_tr_b16 v[88:89], v22 offset:4096
    ds_read_b64_tr_b16 v[90:91], v22 offset:5120
    ds_read_b64_tr_b16 v[92:93], v23 offset:4096
    ds_read_b64_tr_b16 v[94:95], v23 offset:5120
    ds_read_b64_tr_b16 v[96:97], v24 offset:4096
    ds_read_b64_tr_b16 v[98:99], v24 offset:5120
    ds_read_b64_tr_b16 v[100:101], v25 offset:4096
    ds_read_b64_tr_b16 v[102:103], v25 offset:5120
    s_waitcnt lgkmcnt(9)
    v_mfma_f32_32x32x16_bf16 v[132:147], v[72:75], v[60:63], 0
    ds_read_b128 v[68:71], v16 offset:0
    ds_read_b64_tr_b16 v[104:105], v22 offset:8192
    ds_read_b64_tr_b16 v[106:107], v22 offset:9216
    v_mfma_f32_32x32x16_bf16 v[148:163], v[76:79], v[60:63], 0
    ds_read_b64_tr_b16 v[108:109], v23 offset:8192
    ds_read_b64_tr_b16 v[110:111], v23 offset:9216
    v_mfma_f32_32x32x16_bf16 v[164:179], v[80:83], v[60:63], 0
    ds_read_b64_tr_b16 v[112:113], v24 offset:8192
    ds_read_b64_tr_b16 v[114:115], v24 offset:9216
    v_mfma_f32_32x32x16_bf16 v[180:195], v[84:87], v[60:63], 0
    ds_read_b64_tr_b16 v[116:117], v25 offset:8192
    ds_read_b64_tr_b16 v[118:119], v25 offset:9216
    s_waitcnt lgkmcnt(9)
    v_mfma_f32_32x32x16_bf16 v[132:147], v[88:91], v[64:67], v[132:147]
    ds_read_b128 v[60:63], v17 offset:0
    ds_read_b64_tr_b16 v[72:73], v22 offset:12288
    ds_read_b64_tr_b16 v[74:75], v22 offset:13312
    v_mfma_f32_32x32x16_bf16 v[148:163], v[92:95], v[64:67], v[148:163]
    ds_read_b64_tr_b16 v[76:77], v23 offset:12288
    ds_read_b64_tr_b16 v[78:79], v23 offset:13312
    v_mfma_f32_32x32x16_bf16 v[164:179], v[96:99], v[64:67], v[164:179]
    ds_read_b64_tr_b16 v[80:81], v24 offset:12288
    ds_read_b64_tr_b16 v[82:83], v24 offset:13312
    v_mfma_f32_32x32x16_bf16 v[180:195], v[100:103], v[64:67], v[180:195]
    ds_read_b64_tr_b16 v[84:85], v25 offset:12288
    ds_read_b64_tr_b16 v[86:87], v25 offset:13312
    s_waitcnt lgkmcnt(0)
    s_barrier
    v_mfma_f32_32x32x16_bf16 v[132:147], v[104:107], v[68:71], v[132:147]
    ds_read_b128 v[64:67], v14 offset:32768
    ds_read_b64_tr_b16 v[88:89], v22 offset:32768
    ds_read_b64_tr_b16 v[90:91], v22 offset:33792
    v_mfma_f32_32x32x16_bf16 v[148:163], v[108:111], v[68:71], v[148:163]
    ds_read_b64_tr_b16 v[92:93], v23 offset:32768
    ds_read_b64_tr_b16 v[94:95], v23 offset:33792
    v_mfma_f32_32x32x16_bf16 v[164:179], v[112:115], v[68:71], v[164:179]
    ds_read_b64_tr_b16 v[96:97], v24 offset:32768
    ds_read_b64_tr_b16 v[98:99], v24 offset:33792
    v_mfma_f32_32x32x16_bf16 v[180:195], v[116:119], v[68:71], v[180:195]
    ds_read_b64_tr_b16 v[100:101], v25 offset:32768
    ds_read_b64_tr_b16 v[102:103], v25 offset:33792
    s_waitcnt lgkmcnt(9)
    v_mfma_f32_32x32x16_bf16 v[132:147], v[72:75], v[60:63], v[132:147]
    ds_read_b128 v[68:71], v15 offset:32768
    ds_read_b64_tr_b16 v[104:105], v22 offset:36864
    ds_read_b64_tr_b16 v[106:107], v22 offset:37888
    v_mfma_f32_32x32x16_bf16 v[148:163], v[76:79], v[60:63], v[148:163]
    ds_read_b64_tr_b16 v[108:109], v23 offset:36864
    ds_read_b64_tr_b16 v[110:111], v23 offset:37888
    v_mfma_f32_32x32x16_bf16 v[164:179], v[80:83], v[60:63], v[164:179]
    ds_read_b64_tr_b16 v[112:113], v24 offset:36864
    ds_read_b64_tr_b16 v[114:115], v24 offset:37888
    v_mfma_f32_32x32x16_bf16 v[180:195], v[84:87], v[60:63], v[180:195]
    ds_read_b64_tr_b16 v[116:117], v25 offset:36864
    ds_read_b64_tr_b16 v[118:119], v25 offset:37888
    s_waitcnt lgkmcnt(9)
    v_mfma_f32_32x32x16_bf16 v[132:147], v[88:91], v[64:67], v[132:147]
    ds_read_b128 v[60:63], v16 offset:32768
    ds_read_b64_tr_b16 v[72:73], v22 offset:40960
    ds_read_b64_tr_b16 v[74:75], v22 offset:41984
    v_mfma_f32_32x32x16_bf16 v[148:163], v[92:95], v[64:67], v[148:163]
    ds_read_b64_tr_b16 v[76:77], v23 offset:40960
    ds_read_b64_tr_b16 v[78:79], v23 offset:41984
    v_mfma_f32_32x32x16_bf16 v[164:179], v[96:99], v[64:67], v[164:179]
    ds_read_b64_tr_b16 v[80:81], v24 offset:40960
    ds_read_b64_tr_b16 v[82:83], v24 offset:41984
    v_mfma_f32_32x32x16_bf16 v[180:195], v[100:103], v[64:67], v[180:195]
    ds_read_b64_tr_b16 v[84:85], v25 offset:40960
    ds_read_b64_tr_b16 v[86:87], v25 offset:41984
    s_waitcnt lgkmcnt(9)
    v_mfma_f32_32x32x16_bf16 v[132:147], v[104:107], v[68:71], v[132:147]
    ds_read_b128 v[64:67], v17 offset:32768
    ds_read_b64_tr_b16 v[88:89], v22 offset:45056
    ds_read_b64_tr_b16 v[90:91], v22 offset:46080
    v_mfma_f32_32x32x16_bf16 v[148:163], v[108:111], v[68:71], v[148:163]
    ds_read_b64_tr_b16 v[92:93], v23 offset:45056
    ds_read_b64_tr_b16 v[94:95], v23 offset:46080
    v_mfma_f32_32x32x16_bf16 v[164:179], v[112:115], v[68:71], v[164:179]
    ds_read_b64_tr_b16 v[96:97], v24 offset:45056
    ds_read_b64_tr_b16 v[98:99], v24 offset:46080
    v_mfma_f32_32x32x16_bf16 v[180:195], v[116:119], v[68:71], v[180:195]
    ds_read_b64_tr_b16 v[100:101], v25 offset:45056
    ds_read_b64_tr_b16 v[102:103], v25 offset:46080
    s_waitcnt lgkmcnt(0)
    s_barrier
    v_mfma_f32_32x32x16_bf16 v[132:147], v[72:75], v[60:63], v[132:147]
    ds_read_b128 v[68:71], v18 offset:0
    ds_read_b64_tr_b16 v[104:105], v26 offset:0
    ds_read_b64_tr_b16 v[106:107], v26 offset:1024
    v_mfma_f32_32x32x16_bf16 v[148:163], v[76:79], v[60:63], v[148:163]
    ds_read_b64_tr_b16 v[108:109], v27 offset:0
    ds_read_b64_tr_b16 v[110:111], v27 offset:1024
    v_mfma_f32_32x32x16_bf16 v[164:179], v[80:83], v[60:63], v[164:179]
    ds_read_b64_tr_b16 v[112:113], v28 offset:0
    ds_read_b64_tr_b16 v[114:115], v28 offset:1024
    v_mfma_f32_32x32x16_bf16 v[180:195], v[84:87], v[60:63], v[180:195]
    ds_read_b64_tr_b16 v[116:117], v29 offset:0
    ds_read_b64_tr_b16 v[118:119], v29 offset:1024
    s_waitcnt lgkmcnt(9)
    v_mfma_f32_32x32x16_bf16 v[132:147], v[88:91], v[64:67], v[132:147]
    ds_read_b128 v[60:63], v19 offset:0
    ds_read_b64_tr_b16 v[72:73], v26 offset:4096
    ds_read_b64_tr_b16 v[74:75], v26 offset:5120
    v_mfma_f32_32x32x16_bf16 v[148:163], v[92:95], v[64:67], v[148:163]
    ds_read_b64_tr_b16 v[76:77], v27 offset:4096
    ds_read_b64_tr_b16 v[78:79], v27 offset:5120
    v_mfma_f32_32x32x16_bf16 v[164:179], v[96:99], v[64:67], v[164:179]
    ds_read_b64_tr_b16 v[80:81], v28 offset:4096
    ds_read_b64_tr_b16 v[82:83], v28 offset:5120
    v_mfma_f32_32x32x16_bf16 v[180:195], v[100:103], v[64:67], v[180:195]
    ds_read_b64_tr_b16 v[84:85], v29 offset:4096
    ds_read_b64_tr_b16 v[86:87], v29 offset:5120
    s_waitcnt lgkmcnt(9)
    v_mfma_f32_32x32x16_bf16 v[132:147], v[104:107], v[68:71], v[132:147]
    ds_read_b128 v[64:67], v20 offset:0
    ds_read_b64_tr_b16 v[88:89], v26 offset:8192
    ds_read_b64_tr_b16 v[90:91], v26 offset:9216
    v_mfma_f32_32x32x16_bf16 v[148:163], v[108:111], v[68:71], v[148:163]
    ds_read_b64_tr_b16 v[92:93], v27 offset:8192
    ds_read_b64_tr_b16 v[94:95], v27 offset:9216
    v_mfma_f32_32x32x16_bf16 v[164:179], v[112:115], v[68:71], v[164:179]
    ds_read_b64_tr_b16 v[96:97], v28 offset:8192
    ds_read_b64_tr_b16 v[98:99], v28 offset:9216
    v_mfma_f32_32x32x16_bf16 v[180:195], v[116:119], v[68:71], v[180:195]
    ds_read_b64_tr_b16 v[100:101], v29 offset:8192
    ds_read_b64_tr_b16 v[102:103], v29 offset:9216
    s_waitcnt lgkmcnt(9)
    v_mfma_f32_32x32x16_bf16 v[132:147], v[72:75], v[60:63], v[132:147]
    ds_read_b128 v[68:71], v21 offset:0
    ds_read_b64_tr_b16 v[104:105], v26 offset:12288
    ds_read_b64_tr_b16 v[106:107], v26 offset:13312
    v_mfma_f32_32x32x16_bf16 v[148:163], v[76:79], v[60:63], v[148:163]
    ds_read_b64_tr_b16 v[108:109], v27 offset:12288
    ds_read_b64_tr_b16 v[110:111], v27 offset:13312
    v_mfma_f32_32x32x16_bf16 v[164:179], v[80:83], v[60:63], v[164:179]
    ds_read_b64_tr_b16 v[112:113], v28 offset:12288
    ds_read_b64_tr_b16 v[114:115], v28 offset:13312
    v_mfma_f32_32x32x16_bf16 v[180:195], v[84:87], v[60:63], v[180:195]
    ds_read_b64_tr_b16 v[116:117], v29 offset:12288
    ds_read_b64_tr_b16 v[118:119], v29 offset:13312
    s_waitcnt lgkmcnt(0)
    s_barrier
    v_mfma_f32_32x32x16_bf16 v[132:147], v[88:91], v[64:67], v[132:147]
    ds_read_b128 v[60:63], v18 offset:32768
    ds_read_b64_tr_b16 v[72:73], v26 offset:32768
    ds_read_b64_tr_b16 v[74:75], v26 offset:33792
    v_mfma_f32_32x32x16_bf16 v[148:163], v[92:95], v[64:67], v[148:163]
    ds_read_b64_tr_b16 v[76:77], v27 offset:32768
    ds_read_b64_tr_b16 v[78:79], v27 offset:33792
    v_mfma_f32_32x32x16_bf16 v[164:179], v[96:99], v[64:67], v[164:179]
    ds_read_b64_tr_b16 v[80:81], v28 offset:32768
    ds_read_b64_tr_b16 v[82:83], v28 offset:33792
    v_mfma_f32_32x32x16_bf16 v[180:195], v[100:103], v[64:67], v[180:195]
    ds_read_b64_tr_b16 v[84:85], v29 offset:32768
    ds_read_b64_tr_b16 v[86:87], v29 offset:33792
    s_waitcnt lgkmcnt(9)
    v_mfma_f32_32x32x16_bf16 v[132:147], v[104:107], v[68:71], v[132:147]
    ds_read_b128 v[64:67], v19 offset:32768
    ds_read_b64_tr_b16 v[88:89], v26 offset:36864
    ds_read_b64_tr_b16 v[90:91], v26 offset:37888
    v_mfma_f32_32x32x16_bf16 v[148:163], v[108:111], v[68:71], v[148:163]
    ds_read_b64_tr_b16 v[92:93], v27 offset:36864
    ds_read_b64_tr_b16 v[94:95], v27 offset:37888
    v_mfma_f32_32x32x16_bf16 v[164:179], v[112:115], v[68:71], v[164:179]
    ds_read_b64_tr_b16 v[96:97], v28 offset:36864
    ds_read_b64_tr_b16 v[98:99], v28 offset:37888
    v_mfma_f32_32x32x16_bf16 v[180:195], v[116:119], v[68:71], v[180:195]
    ds_read_b64_tr_b16 v[100:101], v29 offset:36864
    ds_read_b64_tr_b16 v[102:103], v29 offset:37888
    s_waitcnt lgkmcnt(9)
    v_mfma_f32_32x32x16_bf16 v[132:147], v[72:75], v[60:63], v[132:147]
    ds_read_b128 v[68:71], v20 offset:32768
    ds_read_b64_tr_b16 v[104:105], v26 offset:40960
    ds_read_b64_tr_b16 v[106:107], v26 offset:41984
    v_mfma_f32_32x32x16_bf16 v[148:163], v[76:79], v[60:63], v[148:163]
    ds_read_b64_tr_b16 v[108:109], v27 offset:40960
    ds_read_b64_tr_b16 v[110:111], v27 offset:41984
    v_mfma_f32_32x32x16_bf16 v[164:179], v[80:83], v[60:63], v[164:179]
    ds_read_b64_tr_b16 v[112:113], v28 offset:40960
    ds_read_b64_tr_b16 v[114:115], v28 offset:41984
    v_mfma_f32_32x32x16_bf16 v[180:195], v[84:87], v[60:63], v[180:195]
    ds_read_b64_tr_b16 v[116:117], v29 offset:40960
    ds_read_b64_tr_b16 v[118:119], v29 offset:41984
    s_waitcnt lgkmcnt(9)
    v_mfma_f32_32x32x16_bf16 v[132:147], v[88:91], v[64:67], v[132:147]
    ds_read_b128 v[60:63], v21 offset:32768
    ds_read_b64_tr_b16 v[72:73], v26 offset:45056
    ds_read_b64_tr_b16 v[74:75], v26 offset:46080
    v_mfma_f32_32x32x16_bf16 v[148:163], v[92:95], v[64:67], v[148:163]
    ds_read_b64_tr_b16 v[76:77], v27 offset:45056
    ds_read_b64_tr_b16 v[78:79], v27 offset:46080
    v_mfma_f32_32x32x16_bf16 v[164:179], v[96:99], v[64:67], v[164:179]
    ds_read_b64_tr_b16 v[80:81], v28 offset:45056
    ds_read_b64_tr_b16 v[82:83], v28 offset:46080
    v_mfma_f32_32x32x16_bf16 v[180:195], v[100:103], v[64:67], v[180:195]
    ds_read_b64_tr_b16 v[84:85], v29 offset:45056
    ds_read_b64_tr_b16 v[86:87], v29 offset:46080
    s_waitcnt lgkmcnt(0)
    s_barrier
    v_mfma_f32_32x32x16_bf16 v[132:147], v[104:107], v[68:71], v[132:147]
    ds_read_b128 v[64:67], v14 offset:0
    ds_read_b64_tr_b16 v[88:89], v22 offset:0
    ds_read_b64_tr_b16 v[90:91], v22 offset:1024
    v_mfma_f32_32x32x16_bf16 v[148:163], v[108:111], v[68:71], v[148:163]
    ds_read_b64_tr_b16 v[92:93], v23 offset:0
    ds_read_b64_tr_b16 v[94:95], v23 offset:1024
    v_mfma_f32_32x32x16_bf16 v[164:179], v[112:115], v[68:71], v[164:179]
    ds_read_b64_tr_b16 v[96:97], v24 offset:0
    ds_read_b64_tr_b16 v[98:99], v24 offset:1024
    v_mfma_f32_32x32x16_bf16 v[180:195], v[116:119], v[68:71], v[180:195]
    ds_read_b64_tr_b16 v[100:101], v25 offset:0
    ds_read_b64_tr_b16 v[102:103], v25 offset:1024
    s_waitcnt lgkmcnt(9)
    v_mfma_f32_32x32x16_bf16 v[132:147], v[72:75], v[60:63], v[132:147]
    ds_read_b128 v[68:71], v15 offset:0
    ds_read_b64_tr_b16 v[104:105], v22 offset:4096
    ds_read_b64_tr_b16 v[106:107], v22 offset:5120
    v_mfma_f32_32x32x16_bf16 v[148:163], v[76:79], v[60:63], v[148:163]
    ds_read_b64_tr_b16 v[108:109], v23 offset:4096
    ds_read_b64_tr_b16 v[110:111], v23 offset:5120
    v_mfma_f32_32x32x16_bf16 v[164:179], v[80:83], v[60:63], v[164:179]
    ds_read_b64_tr_b16 v[112:113], v24 offset:4096
    ds_read_b64_tr_b16 v[114:115], v24 offset:5120
    v_mfma_f32_32x32x16_bf16 v[180:195], v[84:87], v[60:63], v[180:195]
    ds_read_b64_tr_b16 v[116:117], v25 offset:4096
    ds_read_b64_tr_b16 v[118:119], v25 offset:5120
    s_waitcnt lgkmcnt(9)
    v_mfma_f32_32x32x16_bf16 v[132:147], v[88:91], v[64:67], v[132:147]
    ds_read_b128 v[60:63], v16 offset:0
    ds_read_b64_tr_b16 v[72:73], v22 offset:8192
    ds_read_b64_tr_b16 v[74:75], v22 offset:9216
    v_mfma_f32_32x32x16_bf16 v[148:163], v[92:95], v[64:67], v[148:163]
    ds_read_b64_tr_b16 v[76:77], v23 offset:8192
    ds_read_b64_tr_b16 v[78:79], v23 offset:9216
    v_mfma_f32_32x32x16_bf16 v[164:179], v[96:99], v[64:67], v[164:179]
    ds_read_b64_tr_b16 v[80:81], v24 offset:8192
    ds_read_b64_tr_b16 v[82:83], v24 offset:9216
    v_mfma_f32_32x32x16_bf16 v[180:195], v[100:103], v[64:67], v[180:195]
    ds_read_b64_tr_b16 v[84:85], v25 offset:8192
    ds_read_b64_tr_b16 v[86:87], v25 offset:9216
    s_waitcnt lgkmcnt(9)
    v_mfma_f32_32x32x16_bf16 v[132:147], v[104:107], v[68:71], v[132:147]
    ds_read_b128 v[64:67], v17 offset:0
    ds_read_b64_tr_b16 v[88:89], v22 offset:12288
    ds_read_b64_tr_b16 v[90:91], v22 offset:13312
    v_mfma_f32_32x32x16_bf16 v[148:163], v[108:111], v[68:71], v[148:163]
    ds_read_b64_tr_b16 v[92:93], v23 offset:12288
    ds_read_b64_tr_b16 v[94:95], v23 offset:13312
    v_mfma_f32_32x32x16_bf16 v[164:179], v[112:115], v[68:71], v[164:179]
    ds_read_b64_tr_b16 v[96:97], v24 offset:12288
    ds_read_b64_tr_b16 v[98:99], v24 offset:13312
    v_mfma_f32_32x32x16_bf16 v[180:195], v[116:119], v[68:71], v[180:195]
    ds_read_b64_tr_b16 v[100:101], v25 offset:12288
    ds_read_b64_tr_b16 v[102:103], v25 offset:13312
    s_waitcnt lgkmcnt(0)
    s_barrier
    v_mfma_f32_32x32x16_bf16 v[132:147], v[72:75], v[60:63], v[132:147]
    ds_read_b128 v[68:71], v14 offset:32768
    ds_read_b64_tr_b16 v[104:105], v22 offset:32768
    ds_read_b64_tr_b16 v[106:107], v22 offset:33792
    v_mfma_f32_32x32x16_bf16 v[148:163], v[76:79], v[60:63], v[148:163]
    ds_read_b64_tr_b16 v[108:109], v23 offset:32768
    ds_read_b64_tr_b16 v[110:111], v23 offset:33792
    v_mfma_f32_32x32x16_bf16 v[164:179], v[80:83], v[60:63], v[164:179]
    ds_read_b64_tr_b16 v[112:113], v24 offset:32768
    ds_read_b64_tr_b16 v[114:115], v24 offset:33792
    v_mfma_f32_32x32x16_bf16 v[180:195], v[84:87], v[60:63], v[180:195]
    ds_read_b64_tr_b16 v[116:117], v25 offset:32768
    ds_read_b64_tr_b16 v[118:119], v25 offset:33792
    s_waitcnt lgkmcnt(9)
    v_mfma_f32_32x32x16_bf16 v[132:147], v[88:91], v[64:67], v[132:147]
    ds_read_b128 v[60:63], v15 offset:32768
    ds_read_b64_tr_b16 v[72:73], v22 offset:36864
    ds_read_b64_tr_b16 v[74:75], v22 offset:37888
    v_mfma_f32_32x32x16_bf16 v[148:163], v[92:95], v[64:67], v[148:163]
    ds_read_b64_tr_b16 v[76:77], v23 offset:36864
    ds_read_b64_tr_b16 v[78:79], v23 offset:37888
    v_mfma_f32_32x32x16_bf16 v[164:179], v[96:99], v[64:67], v[164:179]
    ds_read_b64_tr_b16 v[80:81], v24 offset:36864
    ds_read_b64_tr_b16 v[82:83], v24 offset:37888
    v_mfma_f32_32x32x16_bf16 v[180:195], v[100:103], v[64:67], v[180:195]
    ds_read_b64_tr_b16 v[84:85], v25 offset:36864
    ds_read_b64_tr_b16 v[86:87], v25 offset:37888
    s_waitcnt lgkmcnt(9)
    v_mfma_f32_32x32x16_bf16 v[132:147], v[104:107], v[68:71], v[132:147]
    ds_read_b128 v[64:67], v16 offset:32768
    ds_read_b64_tr_b16 v[88:89], v22 offset:40960
    ds_read_b64_tr_b16 v[90:91], v22 offset:41984
    v_mfma_f32_32x32x16_bf16 v[148:163], v[108:111], v[68:71], v[148:163]
    ds_read_b64_tr_b16 v[92:93], v23 offset:40960
    ds_read_b64_tr_b16 v[94:95], v23 offset:41984
    v_mfma_f32_32x32x16_bf16 v[164:179], v[112:115], v[68:71], v[164:179]
    ds_read_b64_tr_b16 v[96:97], v24 offset:40960
    ds_read_b64_tr_b16 v[98:99], v24 offset:41984
    v_mfma_f32_32x32x16_bf16 v[180:195], v[116:119], v[68:71], v[180:195]
    ds_read_b64_tr_b16 v[100:101], v25 offset:40960
    ds_read_b64_tr_b16 v[102:103], v25 offset:41984
    s_waitcnt lgkmcnt(9)
    v_mfma_f32_32x32x16_bf16 v[132:147], v[72:75], v[60:63], v[132:147]
    ds_read_b128 v[68:71], v17 offset:32768
    ds_read_b64_tr_b16 v[104:105], v22 offset:45056
    ds_read_b64_tr_b16 v[106:107], v22 offset:46080
    v_mfma_f32_32x32x16_bf16 v[148:163], v[76:79], v[60:63], v[148:163]
    ds_read_b64_tr_b16 v[108:109], v23 offset:45056
    ds_read_b64_tr_b16 v[110:111], v23 offset:46080
    v_mfma_f32_32x32x16_bf16 v[164:179], v[80:83], v[60:63], v[164:179]
    ds_read_b64_tr_b16 v[112:113], v24 offset:45056
    ds_read_b64_tr_b16 v[114:115], v24 offset:46080
    v_mfma_f32_32x32x16_bf16 v[180:195], v[84:87], v[60:63], v[180:195]
    ds_read_b64_tr_b16 v[116:117], v25 offset:45056
    ds_read_b64_tr_b16 v[118:119], v25 offset:46080
    s_waitcnt lgkmcnt(0)
    s_barrier
    v_mfma_f32_32x32x16_bf16 v[132:147], v[88:91], v[64:67], v[132:147]
    ds_read_b128 v[60:63], v18 offset:0
    ds_read_b64_tr_b16 v[72:73], v26 offset:0
    ds_read_b64_tr_b16 v[74:75], v26 offset:1024
    v_mfma_f32_32x32x16_bf16 v[148:163], v[92:95], v[64:67], v[148:163]
    ds_read_b64_tr_b16 v[76:77], v27 offset:0
    ds_read_b64_tr_b16 v[78:79], v27 offset:1024
    v_mfma_f32_32x32x16_bf16 v[164:179], v[96:99], v[64:67], v[164:179]
    ds_read_b64_tr_b16 v[80:81], v28 offset:0
    ds_read_b64_tr_b16 v[82:83], v28 offset:1024
    v_mfma_f32_32x32x16_bf16 v[180:195], v[100:103], v[64:67], v[180:195]
    ds_read_b64_tr_b16 v[84:85], v29 offset:0
    ds_read_b64_tr_b16 v[86:87], v29 offset:1024
    s_waitcnt lgkmcnt(9)
    v_mfma_f32_32x32x16_bf16 v[132:147], v[104:107], v[68:71], v[132:147]
    ds_read_b128 v[64:67], v19 offset:0
    ds_read_b64_tr_b16 v[88:89], v26 offset:4096
    ds_read_b64_tr_b16 v[90:91], v26 offset:5120
    v_mfma_f32_32x32x16_bf16 v[148:163], v[108:111], v[68:71], v[148:163]
    ds_read_b64_tr_b16 v[92:93], v27 offset:4096
    ds_read_b64_tr_b16 v[94:95], v27 offset:5120
    v_mfma_f32_32x32x16_bf16 v[164:179], v[112:115], v[68:71], v[164:179]
    ds_read_b64_tr_b16 v[96:97], v28 offset:4096
    ds_read_b64_tr_b16 v[98:99], v28 offset:5120
    v_mfma_f32_32x32x16_bf16 v[180:195], v[116:119], v[68:71], v[180:195]
    ds_read_b64_tr_b16 v[100:101], v29 offset:4096
    ds_read_b64_tr_b16 v[102:103], v29 offset:5120
    s_waitcnt lgkmcnt(9)
    v_mfma_f32_32x32x16_bf16 v[132:147], v[72:75], v[60:63], v[132:147]
    ds_read_b128 v[68:71], v20 offset:0
    ds_read_b64_tr_b16 v[104:105], v26 offset:8192
    ds_read_b64_tr_b16 v[106:107], v26 offset:9216
    v_mfma_f32_32x32x16_bf16 v[148:163], v[76:79], v[60:63], v[148:163]
    ds_read_b64_tr_b16 v[108:109], v27 offset:8192
    ds_read_b64_tr_b16 v[110:111], v27 offset:9216
    v_mfma_f32_32x32x16_bf16 v[164:179], v[80:83], v[60:63], v[164:179]
    ds_read_b64_tr_b16 v[112:113], v28 offset:8192
    ds_read_b64_tr_b16 v[114:115], v28 offset:9216
    v_mfma_f32_32x32x16_bf16 v[180:195], v[84:87], v[60:63], v[180:195]
    ds_read_b64_tr_b16 v[116:117], v29 offset:8192
    ds_read_b64_tr_b16 v[118:119], v29 offset:9216
    s_waitcnt lgkmcnt(9)
    v_mfma_f32_32x32x16_bf16 v[132:147], v[88:91], v[64:67], v[132:147]
    ds_read_b128 v[60:63], v21 offset:0
    ds_read_b64_tr_b16 v[72:73], v26 offset:12288
    ds_read_b64_tr_b16 v[74:75], v26 offset:13312
    v_mfma_f32_32x32x16_bf16 v[148:163], v[92:95], v[64:67], v[148:163]
    ds_read_b64_tr_b16 v[76:77], v27 offset:12288
    ds_read_b64_tr_b16 v[78:79], v27 offset:13312
    v_mfma_f32_32x32x16_bf16 v[164:179], v[96:99], v[64:67], v[164:179]
    ds_read_b64_tr_b16 v[80:81], v28 offset:12288
    ds_read_b64_tr_b16 v[82:83], v28 offset:13312
    v_mfma_f32_32x32x16_bf16 v[180:195], v[100:103], v[64:67], v[180:195]
    ds_read_b64_tr_b16 v[84:85], v29 offset:12288
    ds_read_b64_tr_b16 v[86:87], v29 offset:13312
    s_waitcnt lgkmcnt(0)
    s_barrier
    v_mfma_f32_32x32x16_bf16 v[132:147], v[104:107], v[68:71], v[132:147]
    ds_read_b128 v[64:67], v18 offset:32768
    ds_read_b64_tr_b16 v[88:89], v26 offset:32768
    ds_read_b64_tr_b16 v[90:91], v26 offset:33792
    v_mfma_f32_32x32x16_bf16 v[148:163], v[108:111], v[68:71], v[148:163]
    ds_read_b64_tr_b16 v[92:93], v27 offset:32768
    ds_read_b64_tr_b16 v[94:95], v27 offset:33792
    v_mfma_f32_32x32x16_bf16 v[164:179], v[112:115], v[68:71], v[164:179]
    ds_read_b64_tr_b16 v[96:97], v28 offset:32768
    ds_read_b64_tr_b16 v[98:99], v28 offset:33792
    v_mfma_f32_32x32x16_bf16 v[180:195], v[116:119], v[68:71], v[180:195]
    ds_read_b64_tr_b16 v[100:101], v29 offset:32768
    ds_read_b64_tr_b16 v[102:103], v29 offset:33792
    s_waitcnt lgkmcnt(9)
    v_mfma_f32_32x32x16_bf16 v[132:147], v[72:75], v[60:63], v[132:147]
    ds_read_b128 v[68:71], v19 offset:32768
    ds_read_b64_tr_b16 v[104:105], v26 offset:36864
    ds_read_b64_tr_b16 v[106:107], v26 offset:37888
    v_mfma_f32_32x32x16_bf16 v[148:163], v[76:79], v[60:63], v[148:163]
    ds_read_b64_tr_b16 v[108:109], v27 offset:36864
    ds_read_b64_tr_b16 v[110:111], v27 offset:37888
    v_mfma_f32_32x32x16_bf16 v[164:179], v[80:83], v[60:63], v[164:179]
    ds_read_b64_tr_b16 v[112:113], v28 offset:36864
    ds_read_b64_tr_b16 v[114:115], v28 offset:37888
    v_mfma_f32_32x32x16_bf16 v[180:195], v[84:87], v[60:63], v[180:195]
    ds_read_b64_tr_b16 v[116:117], v29 offset:36864
    ds_read_b64_tr_b16 v[118:119], v29 offset:37888
    s_waitcnt lgkmcnt(9)
    v_mfma_f32_32x32x16_bf16 v[132:147], v[88:91], v[64:67], v[132:147]
    ds_read_b128 v[60:63], v20 offset:32768
    ds_read_b64_tr_b16 v[72:73], v26 offset:40960
    ds_read_b64_tr_b16 v[74:75], v26 offset:41984
    v_mfma_f32_32x32x16_bf16 v[148:163], v[92:95], v[64:67], v[148:163]
    ds_read_b64_tr_b16 v[76:77], v27 offset:40960
    ds_read_b64_tr_b16 v[78:79], v27 offset:41984
    v_mfma_f32_32x32x16_bf16 v[164:179], v[96:99], v[64:67], v[164:179]
    ds_read_b64_tr_b16 v[80:81], v28 offset:40960
    ds_read_b64_tr_b16 v[82:83], v28 offset:41984
    v_mfma_f32_32x32x16_bf16 v[180:195], v[100:103], v[64:67], v[180:195]
    ds_read_b64_tr_b16 v[84:85], v29 offset:40960
    ds_read_b64_tr_b16 v[86:87], v29 offset:41984
    s_waitcnt lgkmcnt(9)
    v_mfma_f32_32x32x16_bf16 v[132:147], v[104:107], v[68:71], v[132:147]
    ds_read_b128 v[64:67], v21 offset:32768
    ds_read_b64_tr_b16 v[88:89], v26 offset:45056
    ds_read_b64_tr_b16 v[90:91], v26 offset:46080
    v_mfma_f32_32x32x16_bf16 v[148:163], v[108:111], v[68:71], v[148:163]
    ds_read_b64_tr_b16 v[92:93], v27 offset:45056
    ds_read_b64_tr_b16 v[94:95], v27 offset:46080
    v_mfma_f32_32x32x16_bf16 v[164:179], v[112:115], v[68:71], v[164:179]
    ds_read_b64_tr_b16 v[96:97], v28 offset:45056
    ds_read_b64_tr_b16 v[98:99], v28 offset:46080
    v_mfma_f32_32x32x16_bf16 v[180:195], v[116:119], v[68:71], v[180:195]
    ds_read_b64_tr_b16 v[100:101], v29 offset:45056
    ds_read_b64_tr_b16 v[102:103], v29 offset:46080
    s_waitcnt lgkmcnt(9)
    v_mfma_f32_32x32x16_bf16 v[132:147], v[72:75], v[60:63], v[132:147]
    v_mfma_f32_32x32x16_bf16 v[148:163], v[76:79], v[60:63], v[148:163]
    v_mfma_f32_32x32x16_bf16 v[164:179], v[80:83], v[60:63], v[164:179]
    v_mfma_f32_32x32x16_bf16 v[180:195], v[84:87], v[60:63], v[180:195]
    s_waitcnt lgkmcnt(0)
    v_mfma_f32_32x32x16_bf16 v[132:147], v[88:91], v[64:67], v[132:147]
    v_mfma_f32_32x32x16_bf16 v[148:163], v[92:95], v[64:67], v[148:163]
    v_mfma_f32_32x32x16_bf16 v[164:179], v[96:99], v[64:67], v[164:179]
    v_mfma_f32_32x32x16_bf16 v[180:195], v[100:103], v[64:67], v[180:195]
    s_waitcnt vmcnt(0)
    v_pk_add_f32 v[44:45], v[44:45], v[46:47]
    v_pk_add_f32 v[48:49], v[48:49], v[50:51]
    v_pk_add_f32 v[52:53], v[52:53], v[54:55]
    v_pk_add_f32 v[56:57], v[56:57], v[58:59]
    v_pk_add_f32 v[44:45], v[44:45], v[48:49]
    v_pk_add_f32 v[52:53], v[52:53], v[56:57]
    v_pk_add_f32 v[44:45], v[44:45], v[52:53]
    v_mov_b32 v33, v44
    v_mov_b32 v34, v45
    v_mov_b32 v2, v33
    s_nop 1
    v_permlane32_swap_b32 v33, v2
    v_add_f32 v33, v33, v2
    v_mov_b32 v2, v34
    s_nop 1
    v_permlane32_swap_b32 v34, v2
    v_add_f32 v34, v34, v2
    v_mul_f32 v37, 0x3b000000, v33
    v_mul_f32 v2, 0x3b000000, v34
    v_fma_f32 v2, -v37, v37, v2
    v_max_f32 v2, 0, v2
    v_cvt_pk_bf16_f32 v3, v2, v2
    v_and_b32 v2, 0xffff0000, v3
    v_add_f32 v2, 0x3727c5ac, v2
    v_cvt_pk_bf16_f32 v3, v2, v2
    v_and_b32 v2, 0xffff0000, v3
    v_sqrt_f32 v2, v2
    s_nop 0
    v_cvt_pk_bf16_f32 v3, v2, v2
    v_and_b32 v2, 0xffff0000, v3
    v_rcp_f32 v38, v2
    v_cvt_pk_bf16_f32 v3, v37, v37
    v_and_b32 v37, 0xffff0000, v3
    v_mov_b32 v39, v38
    v_mul_f32 v40, v37, v38
    v_sub_f32 v40, 0, v40
    v_mov_b32 v41, v40
    v_and_b32 v2, 31, v1
    v_lshlrev_b32 v2, 2, v2
    s_lshl_b32 s22, s3, 7
    v_add_u32 v3, s22, v2
    v_add_u32 v3, 131072, v3
    v_lshlrev_b32 v36, 16, v36
    ds_write_b32 v3, v36 offset:512
    s_waitcnt lgkmcnt(0)
    s_barrier
    v_lshrrev_b32 v5, 5, v1
    v_lshlrev_b32 v5, 4, v5
    v_add_u32 v5, 131072, v5
    s_lshl_b32 s22, s20, 2
    s_add_u32 s22, s22, s3
    s_mul_i32 s22, s22, 114688
    s_lshl_b32 s23, s21, 13
    s_add_u32 s22, s22, s23
    s_add_u32 s25, s22, 16777216
    s_add_u32 s24, s25, 4096
    v_lshlrev_b32 v34, 4, v1
    ds_read_b128 v[196:199], v5 offset:0
    ds_read_b128 v[212:215], v5 offset:512
    ds_read_b128 v[200:203], v5 offset:32
    ds_read_b128 v[216:219], v5 offset:544
    ds_read_b128 v[204:207], v5 offset:64
    ds_read_b128 v[220:223], v5 offset:576
    ds_read_b128 v[208:211], v5 offset:96
    ds_read_b128 v[224:227], v5 offset:608
    s_waitcnt lgkmcnt(0)
    v_pk_fma_f32 v[196:197], v[196:197], v[40:41], v[212:213]
    v_pk_fma_f32 v[198:199], v[198:199], v[40:41], v[214:215]
    v_pk_fma_f32 v[200:201], v[200:201], v[40:41], v[216:217]
    v_pk_fma_f32 v[202:203], v[202:203], v[40:41], v[218:219]
    v_pk_fma_f32 v[204:205], v[204:205], v[40:41], v[220:221]
    v_pk_fma_f32 v[206:207], v[206:207], v[40:41], v[222:223]
    v_pk_fma_f32 v[208:209], v[208:209], v[40:41], v[224:225]
    v_pk_fma_f32 v[210:211], v[210:211], v[40:41], v[226:227]
    v_pk_fma_f32 v[132:133], v[132:133], v[38:39], v[196:197]
    v_pk_fma_f32 v[134:135], v[134:135], v[38:39], v[198:199]
    v_pk_fma_f32 v[136:137], v[136:137], v[38:39], v[200:201]
    v_pk_fma_f32 v[138:139], v[138:139], v[38:39], v[202:203]
    v_pk_fma_f32 v[140:141], v[140:141], v[38:39], v[204:205]
    v_pk_fma_f32 v[142:143], v[142:143], v[38:39], v[206:207]
    v_pk_fma_f32 v[144:145], v[144:145], v[38:39], v[208:209]
    v_pk_fma_f32 v[146:147], v[146:147], v[38:39], v[210:211]
    v_pk_mul_f32 v[228:229], v[132:133], s[38:39]
    v_pk_mul_f32 v[230:231], v[134:135], s[38:39]
    v_pk_mul_f32 v[232:233], v[136:137], s[38:39]
    v_pk_mul_f32 v[234:235], v[138:139], s[38:39]
    v_pk_mul_f32 v[236:237], v[140:141], s[38:39]
    v_pk_mul_f32 v[238:239], v[142:143], s[38:39]
    v_pk_mul_f32 v[240:241], v[144:145], s[38:39]
    v_pk_mul_f32 v[242:243], v[146:147], s[38:39]
    v_min_f32 v228, 0x41e6d4ca, v228
    v_min_f32 v229, 0x41e6d4ca, v229
    v_min_f32 v230, 0x41e6d4ca, v230
    v_min_f32 v231, 0x41e6d4ca, v231
    v_min_f32 v232, 0x41e6d4ca, v232
    v_min_f32 v233, 0x41e6d4ca, v233
    v_min_f32 v234, 0x41e6d4ca, v234
    v_min_f32 v235, 0x41e6d4ca, v235
    v_min_f32 v236, 0x41e6d4ca, v236
    v_min_f32 v237, 0x41e6d4ca, v237
    v_min_f32 v238, 0x41e6d4ca, v238
    v_min_f32 v239, 0x41e6d4ca, v239
    v_min_f32 v240, 0x41e6d4ca, v240
    v_min_f32 v241, 0x41e6d4ca, v241
    v_min_f32 v242, 0x41e6d4ca, v242
    v_min_f32 v243, 0x41e6d4ca, v243
    v_exp_f32 v228, v228
    v_exp_f32 v229, v229
    v_exp_f32 v230, v230
    v_exp_f32 v231, v231
    v_exp_f32 v232, v232
    v_exp_f32 v233, v233
    v_exp_f32 v234, v234
    v_exp_f32 v235, v235
    v_exp_f32 v236, v236
    v_exp_f32 v237, v237
    v_exp_f32 v238, v238
    v_exp_f32 v239, v239
    v_exp_f32 v240, v240
    v_exp_f32 v241, v241
    v_exp_f32 v242, v242
    v_exp_f32 v243, v243
    v_pk_add_f32 v[72:73], v[228:229], s[36:37]
    v_pk_add_f32 v[74:75], v[230:231], s[36:37]
    v_pk_add_f32 v[76:77], v[232:233], s[36:37]
    v_pk_add_f32 v[78:79], v[234:235], s[36:37]
    v_pk_add_f32 v[80:81], v[236:237], s[36:37]
    v_pk_add_f32 v[82:83], v[238:239], s[36:37]
    v_pk_add_f32 v[84:85], v[240:241], s[36:37]
    v_pk_add_f32 v[86:87], v[242:243], s[36:37]
    v_pk_mul_f32 v[228:229], v[228:229], v[72:73]
    v_pk_mul_f32 v[230:231], v[230:231], v[74:75]
    v_pk_mul_f32 v[232:233], v[232:233], v[76:77]
    v_pk_mul_f32 v[234:235], v[234:235], v[78:79]
    v_pk_mul_f32 v[236:237], v[236:237], v[80:81]
    v_pk_mul_f32 v[238:239], v[238:239], v[82:83]
    v_pk_mul_f32 v[240:241], v[240:241], v[84:85]
    v_pk_mul_f32 v[242:243], v[242:243], v[86:87]
    v_pk_add_f32 v[72:73], v[228:229], s[36:37]
    v_pk_add_f32 v[74:75], v[230:231], s[36:37]
    v_pk_add_f32 v[76:77], v[232:233], s[36:37]
    v_pk_add_f32 v[78:79], v[234:235], s[36:37]
    v_pk_add_f32 v[80:81], v[236:237], s[36:37]
    v_pk_add_f32 v[82:83], v[238:239], s[36:37]
    v_pk_add_f32 v[84:85], v[240:241], s[36:37]
    v_pk_add_f32 v[86:87], v[242:243], s[36:37]
    v_rcp_f32 v72, v72
    v_rcp_f32 v73, v73
    v_rcp_f32 v74, v74
    v_rcp_f32 v75, v75
    v_rcp_f32 v76, v76
    v_rcp_f32 v77, v77
    v_rcp_f32 v78, v78
    v_rcp_f32 v79, v79
    v_rcp_f32 v80, v80
    v_rcp_f32 v81, v81
    v_rcp_f32 v82, v82
    v_rcp_f32 v83, v83
    v_rcp_f32 v84, v84
    v_rcp_f32 v85, v85
    v_rcp_f32 v86, v86
    v_rcp_f32 v87, v87
    v_pk_mul_f32 v[132:133], v[132:133], v[228:229]
    v_pk_mul_f32 v[134:135], v[134:135], v[230:231]
    v_pk_mul_f32 v[136:137], v[136:137], v[232:233]
    v_pk_mul_f32 v[138:139], v[138:139], v[234:235]
    v_pk_mul_f32 v[140:141], v[140:141], v[236:237]
    v_pk_mul_f32 v[142:143], v[142:143], v[238:239]
    v_pk_mul_f32 v[144:145], v[144:145], v[240:241]
    v_pk_mul_f32 v[146:147], v[146:147], v[242:243]
    v_pk_mul_f32 v[132:133], v[132:133], v[72:73]
    v_pk_mul_f32 v[134:135], v[134:135], v[74:75]
    v_pk_mul_f32 v[136:137], v[136:137], v[76:77]
    v_pk_mul_f32 v[138:139], v[138:139], v[78:79]
    v_pk_mul_f32 v[140:141], v[140:141], v[80:81]
    v_pk_mul_f32 v[142:143], v[142:143], v[82:83]
    v_pk_mul_f32 v[144:145], v[144:145], v[84:85]
    v_pk_mul_f32 v[146:147], v[146:147], v[86:87]
    v_cvt_pk_bf16_f32 v244, v132, v133
    v_cvt_pk_bf16_f32 v245, v134, v135
    v_cvt_pk_bf16_f32 v246, v136, v137
    v_cvt_pk_bf16_f32 v247, v138, v139
    v_cvt_pk_bf16_f32 v248, v140, v141
    v_cvt_pk_bf16_f32 v249, v142, v143
    v_cvt_pk_bf16_f32 v250, v144, v145
    v_cvt_pk_bf16_f32 v251, v146, v147
    s_nop 0
    v_permlane32_swap_b32 v244, v246
    v_permlane32_swap_b32 v245, v247
    buffer_store_dwordx4 v[244:247], v34, s[12:15], s25 offen offset:0
    v_permlane32_swap_b32 v248, v250
    v_permlane32_swap_b32 v249, v251
    buffer_store_dwordx4 v[248:251], v34, s[12:15], s25 offen offset:1024
    ds_read_b128 v[196:199], v5 offset:128
    ds_read_b128 v[212:215], v5 offset:640
    ds_read_b128 v[200:203], v5 offset:160
    ds_read_b128 v[216:219], v5 offset:672
    ds_read_b128 v[204:207], v5 offset:192
    ds_read_b128 v[220:223], v5 offset:704
    ds_read_b128 v[208:211], v5 offset:224
    ds_read_b128 v[224:227], v5 offset:736
    s_waitcnt lgkmcnt(0)
    v_pk_fma_f32 v[196:197], v[196:197], v[40:41], v[212:213]
    v_pk_fma_f32 v[198:199], v[198:199], v[40:41], v[214:215]
    v_pk_fma_f32 v[200:201], v[200:201], v[40:41], v[216:217]
    v_pk_fma_f32 v[202:203], v[202:203], v[40:41], v[218:219]
    v_pk_fma_f32 v[204:205], v[204:205], v[40:41], v[220:221]
    v_pk_fma_f32 v[206:207], v[206:207], v[40:41], v[222:223]
    v_pk_fma_f32 v[208:209], v[208:209], v[40:41], v[224:225]
    v_pk_fma_f32 v[210:211], v[210:211], v[40:41], v[226:227]
    v_pk_fma_f32 v[148:149], v[148:149], v[38:39], v[196:197]
    v_pk_fma_f32 v[150:151], v[150:151], v[38:39], v[198:199]
    v_pk_fma_f32 v[152:153], v[152:153], v[38:39], v[200:201]
    v_pk_fma_f32 v[154:155], v[154:155], v[38:39], v[202:203]
    v_pk_fma_f32 v[156:157], v[156:157], v[38:39], v[204:205]
    v_pk_fma_f32 v[158:159], v[158:159], v[38:39], v[206:207]
    v_pk_fma_f32 v[160:161], v[160:161], v[38:39], v[208:209]
    v_pk_fma_f32 v[162:163], v[162:163], v[38:39], v[210:211]
    v_pk_mul_f32 v[228:229], v[148:149], s[38:39]
    v_pk_mul_f32 v[230:231], v[150:151], s[38:39]
    v_pk_mul_f32 v[232:233], v[152:153], s[38:39]
    v_pk_mul_f32 v[234:235], v[154:155], s[38:39]
    v_pk_mul_f32 v[236:237], v[156:157], s[38:39]
    v_pk_mul_f32 v[238:239], v[158:159], s[38:39]
    v_pk_mul_f32 v[240:241], v[160:161], s[38:39]
    v_pk_mul_f32 v[242:243], v[162:163], s[38:39]
    v_min_f32 v228, 0x41e6d4ca, v228
    v_min_f32 v229, 0x41e6d4ca, v229
    v_min_f32 v230, 0x41e6d4ca, v230
    v_min_f32 v231, 0x41e6d4ca, v231
    v_min_f32 v232, 0x41e6d4ca, v232
    v_min_f32 v233, 0x41e6d4ca, v233
    v_min_f32 v234, 0x41e6d4ca, v234
    v_min_f32 v235, 0x41e6d4ca, v235
    v_min_f32 v236, 0x41e6d4ca, v236
    v_min_f32 v237, 0x41e6d4ca, v237
    v_min_f32 v238, 0x41e6d4ca, v238
    v_min_f32 v239, 0x41e6d4ca, v239
    v_min_f32 v240, 0x41e6d4ca, v240
    v_min_f32 v241, 0x41e6d4ca, v241
    v_min_f32 v242, 0x41e6d4ca, v242
    v_min_f32 v243, 0x41e6d4ca, v243
    v_exp_f32 v228, v228
    v_exp_f32 v229, v229
    v_exp_f32 v230, v230
    v_exp_f32 v231, v231
    v_exp_f32 v232, v232
    v_exp_f32 v233, v233
    v_exp_f32 v234, v234
    v_exp_f32 v235, v235
    v_exp_f32 v236, v236
    v_exp_f32 v237, v237
    v_exp_f32 v238, v238
    v_exp_f32 v239, v239
    v_exp_f32 v240, v240
    v_exp_f32 v241, v241
    v_exp_f32 v242, v242
    v_exp_f32 v243, v243
    v_pk_add_f32 v[72:73], v[228:229], s[36:37]
    v_pk_add_f32 v[74:75], v[230:231], s[36:37]
    v_pk_add_f32 v[76:77], v[232:233], s[36:37]
    v_pk_add_f32 v[78:79], v[234:235], s[36:37]
    v_pk_add_f32 v[80:81], v[236:237], s[36:37]
    v_pk_add_f32 v[82:83], v[238:239], s[36:37]
    v_pk_add_f32 v[84:85], v[240:241], s[36:37]
    v_pk_add_f32 v[86:87], v[242:243], s[36:37]
    v_pk_mul_f32 v[228:229], v[228:229], v[72:73]
    v_pk_mul_f32 v[230:231], v[230:231], v[74:75]
    v_pk_mul_f32 v[232:233], v[232:233], v[76:77]
    v_pk_mul_f32 v[234:235], v[234:235], v[78:79]
    v_pk_mul_f32 v[236:237], v[236:237], v[80:81]
    v_pk_mul_f32 v[238:239], v[238:239], v[82:83]
    v_pk_mul_f32 v[240:241], v[240:241], v[84:85]
    v_pk_mul_f32 v[242:243], v[242:243], v[86:87]
    v_pk_add_f32 v[72:73], v[228:229], s[36:37]
    v_pk_add_f32 v[74:75], v[230:231], s[36:37]
    v_pk_add_f32 v[76:77], v[232:233], s[36:37]
    v_pk_add_f32 v[78:79], v[234:235], s[36:37]
    v_pk_add_f32 v[80:81], v[236:237], s[36:37]
    v_pk_add_f32 v[82:83], v[238:239], s[36:37]
    v_pk_add_f32 v[84:85], v[240:241], s[36:37]
    v_pk_add_f32 v[86:87], v[242:243], s[36:37]
    v_rcp_f32 v72, v72
    v_rcp_f32 v73, v73
    v_rcp_f32 v74, v74
    v_rcp_f32 v75, v75
    v_rcp_f32 v76, v76
    v_rcp_f32 v77, v77
    v_rcp_f32 v78, v78
    v_rcp_f32 v79, v79
    v_rcp_f32 v80, v80
    v_rcp_f32 v81, v81
    v_rcp_f32 v82, v82
    v_rcp_f32 v83, v83
    v_rcp_f32 v84, v84
    v_rcp_f32 v85, v85
    v_rcp_f32 v86, v86
    v_rcp_f32 v87, v87
    v_pk_mul_f32 v[148:149], v[148:149], v[228:229]
    v_pk_mul_f32 v[150:151], v[150:151], v[230:231]
    v_pk_mul_f32 v[152:153], v[152:153], v[232:233]
    v_pk_mul_f32 v[154:155], v[154:155], v[234:235]
    v_pk_mul_f32 v[156:157], v[156:157], v[236:237]
    v_pk_mul_f32 v[158:159], v[158:159], v[238:239]
    v_pk_mul_f32 v[160:161], v[160:161], v[240:241]
    v_pk_mul_f32 v[162:163], v[162:163], v[242:243]
    v_pk_mul_f32 v[148:149], v[148:149], v[72:73]
    v_pk_mul_f32 v[150:151], v[150:151], v[74:75]
    v_pk_mul_f32 v[152:153], v[152:153], v[76:77]
    v_pk_mul_f32 v[154:155], v[154:155], v[78:79]
    v_pk_mul_f32 v[156:157], v[156:157], v[80:81]
    v_pk_mul_f32 v[158:159], v[158:159], v[82:83]
    v_pk_mul_f32 v[160:161], v[160:161], v[84:85]
    v_pk_mul_f32 v[162:163], v[162:163], v[86:87]
    v_cvt_pk_bf16_f32 v60, v148, v149
    v_cvt_pk_bf16_f32 v61, v150, v151
    v_cvt_pk_bf16_f32 v62, v152, v153
    v_cvt_pk_bf16_f32 v63, v154, v155
    v_cvt_pk_bf16_f32 v64, v156, v157
    v_cvt_pk_bf16_f32 v65, v158, v159
    v_cvt_pk_bf16_f32 v66, v160, v161
    v_cvt_pk_bf16_f32 v67, v162, v163
    s_nop 0
    v_permlane32_swap_b32 v60, v62
    v_permlane32_swap_b32 v61, v63
    buffer_store_dwordx4 v[60:63], v34, s[12:15], s25 offen offset:2048
    v_permlane32_swap_b32 v64, v66
    v_permlane32_swap_b32 v65, v67
    buffer_store_dwordx4 v[64:67], v34, s[12:15], s25 offen offset:3072
    ds_read_b128 v[196:199], v5 offset:256
    ds_read_b128 v[212:215], v5 offset:768
    ds_read_b128 v[200:203], v5 offset:288
    ds_read_b128 v[216:219], v5 offset:800
    ds_read_b128 v[204:207], v5 offset:320
    ds_read_b128 v[220:223], v5 offset:832
    ds_read_b128 v[208:211], v5 offset:352
    ds_read_b128 v[224:227], v5 offset:864
    s_waitcnt lgkmcnt(0)
    v_pk_fma_f32 v[196:197], v[196:197], v[40:41], v[212:213]
    v_pk_fma_f32 v[198:199], v[198:199], v[40:41], v[214:215]
    v_pk_fma_f32 v[200:201], v[200:201], v[40:41], v[216:217]
    v_pk_fma_f32 v[202:203], v[202:203], v[40:41], v[218:219]
    v_pk_fma_f32 v[204:205], v[204:205], v[40:41], v[220:221]
    v_pk_fma_f32 v[206:207], v[206:207], v[40:41], v[222:223]
    v_pk_fma_f32 v[208:209], v[208:209], v[40:41], v[224:225]
    v_pk_fma_f32 v[210:211], v[210:211], v[40:41], v[226:227]
    v_pk_fma_f32 v[164:165], v[164:165], v[38:39], v[196:197]
    v_pk_fma_f32 v[166:167], v[166:167], v[38:39], v[198:199]
    v_pk_fma_f32 v[168:169], v[168:169], v[38:39], v[200:201]
    v_pk_fma_f32 v[170:171], v[170:171], v[38:39], v[202:203]
    v_pk_fma_f32 v[172:173], v[172:173], v[38:39], v[204:205]
    v_pk_fma_f32 v[174:175], v[174:175], v[38:39], v[206:207]
    v_pk_fma_f32 v[176:177], v[176:177], v[38:39], v[208:209]
    v_pk_fma_f32 v[178:179], v[178:179], v[38:39], v[210:211]
    v_pk_mul_f32 v[228:229], v[164:165], s[38:39]
    v_pk_mul_f32 v[230:231], v[166:167], s[38:39]
    v_pk_mul_f32 v[232:233], v[168:169], s[38:39]
    v_pk_mul_f32 v[234:235], v[170:171], s[38:39]
    v_pk_mul_f32 v[236:237], v[172:173], s[38:39]
    v_pk_mul_f32 v[238:239], v[174:175], s[38:39]
    v_pk_mul_f32 v[240:241], v[176:177], s[38:39]
    v_pk_mul_f32 v[242:243], v[178:179], s[38:39]
    v_min_f32 v228, 0x41e6d4ca, v228
    v_min_f32 v229, 0x41e6d4ca, v229
    v_min_f32 v230, 0x41e6d4ca, v230
    v_min_f32 v231, 0x41e6d4ca, v231
    v_min_f32 v232, 0x41e6d4ca, v232
    v_min_f32 v233, 0x41e6d4ca, v233
    v_min_f32 v234, 0x41e6d4ca, v234
    v_min_f32 v235, 0x41e6d4ca, v235
    v_min_f32 v236, 0x41e6d4ca, v236
    v_min_f32 v237, 0x41e6d4ca, v237
    v_min_f32 v238, 0x41e6d4ca, v238
    v_min_f32 v239, 0x41e6d4ca, v239
    v_min_f32 v240, 0x41e6d4ca, v240
    v_min_f32 v241, 0x41e6d4ca, v241
    v_min_f32 v242, 0x41e6d4ca, v242
    v_min_f32 v243, 0x41e6d4ca, v243
    v_exp_f32 v228, v228
    v_exp_f32 v229, v229
    v_exp_f32 v230, v230
    v_exp_f32 v231, v231
    v_exp_f32 v232, v232
    v_exp_f32 v233, v233
    v_exp_f32 v234, v234
    v_exp_f32 v235, v235
    v_exp_f32 v236, v236
    v_exp_f32 v237, v237
    v_exp_f32 v238, v238
    v_exp_f32 v239, v239
    v_exp_f32 v240, v240
    v_exp_f32 v241, v241
    v_exp_f32 v242, v242
    v_exp_f32 v243, v243
    v_pk_add_f32 v[72:73], v[228:229], s[36:37]
    v_pk_add_f32 v[74:75], v[230:231], s[36:37]
    v_pk_add_f32 v[76:77], v[232:233], s[36:37]
    v_pk_add_f32 v[78:79], v[234:235], s[36:37]
    v_pk_add_f32 v[80:81], v[236:237], s[36:37]
    v_pk_add_f32 v[82:83], v[238:239], s[36:37]
    v_pk_add_f32 v[84:85], v[240:241], s[36:37]
    v_pk_add_f32 v[86:87], v[242:243], s[36:37]
    v_pk_mul_f32 v[228:229], v[228:229], v[72:73]
    v_pk_mul_f32 v[230:231], v[230:231], v[74:75]
    v_pk_mul_f32 v[232:233], v[232:233], v[76:77]
    v_pk_mul_f32 v[234:235], v[234:235], v[78:79]
    v_pk_mul_f32 v[236:237], v[236:237], v[80:81]
    v_pk_mul_f32 v[238:239], v[238:239], v[82:83]
    v_pk_mul_f32 v[240:241], v[240:241], v[84:85]
    v_pk_mul_f32 v[242:243], v[242:243], v[86:87]
    v_pk_add_f32 v[72:73], v[228:229], s[36:37]
    v_pk_add_f32 v[74:75], v[230:231], s[36:37]
    v_pk_add_f32 v[76:77], v[232:233], s[36:37]
    v_pk_add_f32 v[78:79], v[234:235], s[36:37]
    v_pk_add_f32 v[80:81], v[236:237], s[36:37]
    v_pk_add_f32 v[82:83], v[238:239], s[36:37]
    v_pk_add_f32 v[84:85], v[240:241], s[36:37]
    v_pk_add_f32 v[86:87], v[242:243], s[36:37]
    v_rcp_f32 v72, v72
    v_rcp_f32 v73, v73
    v_rcp_f32 v74, v74
    v_rcp_f32 v75, v75
    v_rcp_f32 v76, v76
    v_rcp_f32 v77, v77
    v_rcp_f32 v78, v78
    v_rcp_f32 v79, v79
    v_rcp_f32 v80, v80
    v_rcp_f32 v81, v81
    v_rcp_f32 v82, v82
    v_rcp_f32 v83, v83
    v_rcp_f32 v84, v84
    v_rcp_f32 v85, v85
    v_rcp_f32 v86, v86
    v_rcp_f32 v87, v87
    v_pk_mul_f32 v[164:165], v[164:165], v[228:229]
    v_pk_mul_f32 v[166:167], v[166:167], v[230:231]
    v_pk_mul_f32 v[168:169], v[168:169], v[232:233]
    v_pk_mul_f32 v[170:171], v[170:171], v[234:235]
    v_pk_mul_f32 v[172:173], v[172:173], v[236:237]
    v_pk_mul_f32 v[174:175], v[174:175], v[238:239]
    v_pk_mul_f32 v[176:177], v[176:177], v[240:241]
    v_pk_mul_f32 v[178:179], v[178:179], v[242:243]
    v_pk_mul_f32 v[164:165], v[164:165], v[72:73]
    v_pk_mul_f32 v[166:167], v[166:167], v[74:75]
    v_pk_mul_f32 v[168:169], v[168:169], v[76:77]
    v_pk_mul_f32 v[170:171], v[170:171], v[78:79]
    v_pk_mul_f32 v[172:173], v[172:173], v[80:81]
    v_pk_mul_f32 v[174:175], v[174:175], v[82:83]
    v_pk_mul_f32 v[176:177], v[176:177], v[84:85]
    v_pk_mul_f32 v[178:179], v[178:179], v[86:87]
    v_cvt_pk_bf16_f32 v244, v164, v165
    v_cvt_pk_bf16_f32 v245, v166, v167
    v_cvt_pk_bf16_f32 v246, v168, v169
    v_cvt_pk_bf16_f32 v247, v170, v171
    v_cvt_pk_bf16_f32 v248, v172, v173
    v_cvt_pk_bf16_f32 v249, v174, v175
    v_cvt_pk_bf16_f32 v250, v176, v177
    v_cvt_pk_bf16_f32 v251, v178, v179
    s_nop 0
    v_permlane32_swap_b32 v244, v246
    v_permlane32_swap_b32 v245, v247
    buffer_store_dwordx4 v[244:247], v34, s[12:15], s24 offen offset:0
    v_permlane32_swap_b32 v248, v250
    v_permlane32_swap_b32 v249, v251
    buffer_store_dwordx4 v[248:251], v34, s[12:15], s24 offen offset:1024
    ds_read_b128 v[196:199], v5 offset:384
    ds_read_b128 v[212:215], v5 offset:896
    ds_read_b128 v[200:203], v5 offset:416
    ds_read_b128 v[216:219], v5 offset:928
    ds_read_b128 v[204:207], v5 offset:448
    ds_read_b128 v[220:223], v5 offset:960
    ds_read_b128 v[208:211], v5 offset:480
    ds_read_b128 v[224:227], v5 offset:992
    s_waitcnt lgkmcnt(0)
    v_pk_fma_f32 v[196:197], v[196:197], v[40:41], v[212:213]
    v_pk_fma_f32 v[198:199], v[198:199], v[40:41], v[214:215]
    v_pk_fma_f32 v[200:201], v[200:201], v[40:41], v[216:217]
    v_pk_fma_f32 v[202:203], v[202:203], v[40:41], v[218:219]
    v_pk_fma_f32 v[204:205], v[204:205], v[40:41], v[220:221]
    v_pk_fma_f32 v[206:207], v[206:207], v[40:41], v[222:223]
    v_pk_fma_f32 v[208:209], v[208:209], v[40:41], v[224:225]
    v_pk_fma_f32 v[210:211], v[210:211], v[40:41], v[226:227]
    v_pk_fma_f32 v[180:181], v[180:181], v[38:39], v[196:197]
    v_pk_fma_f32 v[182:183], v[182:183], v[38:39], v[198:199]
    v_pk_fma_f32 v[184:185], v[184:185], v[38:39], v[200:201]
    v_pk_fma_f32 v[186:187], v[186:187], v[38:39], v[202:203]
    v_pk_fma_f32 v[188:189], v[188:189], v[38:39], v[204:205]
    v_pk_fma_f32 v[190:191], v[190:191], v[38:39], v[206:207]
    v_pk_fma_f32 v[192:193], v[192:193], v[38:39], v[208:209]
    v_pk_fma_f32 v[194:195], v[194:195], v[38:39], v[210:211]
    v_pk_mul_f32 v[228:229], v[180:181], s[38:39]
    v_pk_mul_f32 v[230:231], v[182:183], s[38:39]
    v_pk_mul_f32 v[232:233], v[184:185], s[38:39]
    v_pk_mul_f32 v[234:235], v[186:187], s[38:39]
    v_pk_mul_f32 v[236:237], v[188:189], s[38:39]
    v_pk_mul_f32 v[238:239], v[190:191], s[38:39]
    v_pk_mul_f32 v[240:241], v[192:193], s[38:39]
    v_pk_mul_f32 v[242:243], v[194:195], s[38:39]
    v_min_f32 v228, 0x41e6d4ca, v228
    v_min_f32 v229, 0x41e6d4ca, v229
    v_min_f32 v230, 0x41e6d4ca, v230
    v_min_f32 v231, 0x41e6d4ca, v231
    v_min_f32 v232, 0x41e6d4ca, v232
    v_min_f32 v233, 0x41e6d4ca, v233
    v_min_f32 v234, 0x41e6d4ca, v234
    v_min_f32 v235, 0x41e6d4ca, v235
    v_min_f32 v236, 0x41e6d4ca, v236
    v_min_f32 v237, 0x41e6d4ca, v237
    v_min_f32 v238, 0x41e6d4ca, v238
    v_min_f32 v239, 0x41e6d4ca, v239
    v_min_f32 v240, 0x41e6d4ca, v240
    v_min_f32 v241, 0x41e6d4ca, v241
    v_min_f32 v242, 0x41e6d4ca, v242
    v_min_f32 v243, 0x41e6d4ca, v243
    v_exp_f32 v228, v228
    v_exp_f32 v229, v229
    v_exp_f32 v230, v230
    v_exp_f32 v231, v231
    v_exp_f32 v232, v232
    v_exp_f32 v233, v233
    v_exp_f32 v234, v234
    v_exp_f32 v235, v235
    v_exp_f32 v236, v236
    v_exp_f32 v237, v237
    v_exp_f32 v238, v238
    v_exp_f32 v239, v239
    v_exp_f32 v240, v240
    v_exp_f32 v241, v241
    v_exp_f32 v242, v242
    v_exp_f32 v243, v243
    v_pk_add_f32 v[72:73], v[228:229], s[36:37]
    v_pk_add_f32 v[74:75], v[230:231], s[36:37]
    v_pk_add_f32 v[76:77], v[232:233], s[36:37]
    v_pk_add_f32 v[78:79], v[234:235], s[36:37]
    v_pk_add_f32 v[80:81], v[236:237], s[36:37]
    v_pk_add_f32 v[82:83], v[238:239], s[36:37]
    v_pk_add_f32 v[84:85], v[240:241], s[36:37]
    v_pk_add_f32 v[86:87], v[242:243], s[36:37]
    v_pk_mul_f32 v[228:229], v[228:229], v[72:73]
    v_pk_mul_f32 v[230:231], v[230:231], v[74:75]
    v_pk_mul_f32 v[232:233], v[232:233], v[76:77]
    v_pk_mul_f32 v[234:235], v[234:235], v[78:79]
    v_pk_mul_f32 v[236:237], v[236:237], v[80:81]
    v_pk_mul_f32 v[238:239], v[238:239], v[82:83]
    v_pk_mul_f32 v[240:241], v[240:241], v[84:85]
    v_pk_mul_f32 v[242:243], v[242:243], v[86:87]
    v_pk_add_f32 v[72:73], v[228:229], s[36:37]
    v_pk_add_f32 v[74:75], v[230:231], s[36:37]
    v_pk_add_f32 v[76:77], v[232:233], s[36:37]
    v_pk_add_f32 v[78:79], v[234:235], s[36:37]
    v_pk_add_f32 v[80:81], v[236:237], s[36:37]
    v_pk_add_f32 v[82:83], v[238:239], s[36:37]
    v_pk_add_f32 v[84:85], v[240:241], s[36:37]
    v_pk_add_f32 v[86:87], v[242:243], s[36:37]
    v_rcp_f32 v72, v72
    v_rcp_f32 v73, v73
    v_rcp_f32 v74, v74
    v_rcp_f32 v75, v75
    v_rcp_f32 v76, v76
    v_rcp_f32 v77, v77
    v_rcp_f32 v78, v78
    v_rcp_f32 v79, v79
    v_rcp_f32 v80, v80
    v_rcp_f32 v81, v81
    v_rcp_f32 v82, v82
    v_rcp_f32 v83, v83
    v_rcp_f32 v84, v84
    v_rcp_f32 v85, v85
    v_rcp_f32 v86, v86
    v_rcp_f32 v87, v87
    v_pk_mul_f32 v[180:181], v[180:181], v[228:229]
    v_pk_mul_f32 v[182:183], v[182:183], v[230:231]
    v_pk_mul_f32 v[184:185], v[184:185], v[232:233]
    v_pk_mul_f32 v[186:187], v[186:187], v[234:235]
    v_pk_mul_f32 v[188:189], v[188:189], v[236:237]
    v_pk_mul_f32 v[190:191], v[190:191], v[238:239]
    v_pk_mul_f32 v[192:193], v[192:193], v[240:241]
    v_pk_mul_f32 v[194:195], v[194:195], v[242:243]
    v_pk_mul_f32 v[180:181], v[180:181], v[72:73]
    v_pk_mul_f32 v[182:183], v[182:183], v[74:75]
    v_pk_mul_f32 v[184:185], v[184:185], v[76:77]
    v_pk_mul_f32 v[186:187], v[186:187], v[78:79]
    v_pk_mul_f32 v[188:189], v[188:189], v[80:81]
    v_pk_mul_f32 v[190:191], v[190:191], v[82:83]
    v_pk_mul_f32 v[192:193], v[192:193], v[84:85]
    v_pk_mul_f32 v[194:195], v[194:195], v[86:87]
    v_cvt_pk_bf16_f32 v60, v180, v181
    v_cvt_pk_bf16_f32 v61, v182, v183
    v_cvt_pk_bf16_f32 v62, v184, v185
    v_cvt_pk_bf16_f32 v63, v186, v187
    v_cvt_pk_bf16_f32 v64, v188, v189
    v_cvt_pk_bf16_f32 v65, v190, v191
    v_cvt_pk_bf16_f32 v66, v192, v193
    v_cvt_pk_bf16_f32 v67, v194, v195
    s_nop 0
    v_permlane32_swap_b32 v60, v62
    v_permlane32_swap_b32 v61, v63
    buffer_store_dwordx4 v[60:63], v34, s[12:15], s24 offen offset:2048
    v_permlane32_swap_b32 v64, v66
    v_permlane32_swap_b32 v65, v67
    buffer_store_dwordx4 v[64:67], v34, s[12:15], s24 offen offset:3072
ffa2_kernel_end:
    s_endpgm
.section .rodata,"a"
.p2align 6
.amdhsa_kernel ffa2_kernel
  .amdhsa_next_free_vgpr 256
  .amdhsa_next_free_sgpr 96
  .amdhsa_accum_offset 256
  .amdhsa_group_segment_fixed_size 0
  .amdhsa_kernarg_size 80
  .amdhsa_user_sgpr_count 2
  .amdhsa_user_sgpr_kernarg_segment_ptr 1
  .amdhsa_system_sgpr_workgroup_id_x 1
.end_amdhsa_kernel
.text
.globl ffb2_kernel
.p2align 8
.type ffb2_kernel,@function
ffb2_kernel:
    s_cmp_ge_u32 s2, 256
    s_cbranch_scc1 ffb2_kernel_end
    s_load_dwordx2 s[28:29], s[0:1], 72
    s_load_dwordx2 s[30:31], s[0:1], 48
    s_load_dwordx2 s[32:33], s[0:1], 0
    s_load_dwordx2 s[34:35], s[0:1], 56
    v_and_b32 v1, 63, v0
    v_lshrrev_b32 v2, 6, v0
    s_and_b32 s20, s2, 7
    v_readfirstlane_b32 s44, v2
    s_lshl_b32 s20, s20, 2
    s_bfe_u32 s22, s2, 0x20003
    s_add_u32 s20, s20, s22
    s_lshr_b32 s21, s2, 5
    s_and_b32 s3, s44, 3
    s_cmp_lt_u32 s44, 4
    s_cbranch_scc1 ffb2_kernel_comp
    s_lshl_b32 s22, s20, 1
    s_lshr_b32 s23, s3, 1
    s_add_u32 s22, s22, s23
    s_mul_i32 s22, s22, 114688
    s_and_b32 s23, s3, 1
    s_lshl_b32 s23, s23, 11
    s_add_u32 s22, s22, s23
    v_lshlrev_b32 v6, 4, v1
    v_add_u32 v6, s22, v6
    v_add_u32 v7, 1024, v6
    s_lshl_b32 s26, s3, 11
    s_waitcnt lgkmcnt(0)
    s_add_u32 s4, s28, 0x1000000
    s_addc_u32 s5, s29, 0
    s_and_b32 s5, s5, 0xffff
    s_mov_b32 s6, 0x700000
    s_mov_b32 s7, 0x00020000
    s_add_u32 s8, s28, 0x1b00000
    s_addc_u32 s9, s29, 0
    s_and_b32 s9, s9, 0xffff
    s_mov_b32 s10, 0x1c0000
    s_mov_b32 s11, 0x00020000
    s_mul_i32 s23, s21, 229376
    s_add_u32 s23, s23, s26
    v_lshlrev_b32 v8, 4, v1
    v_add_u32 v8, s23, v8
    v_add_u32 v9, 1024, v8
    s_mov_b32 s24, 0
    s_mov_b32 s25, 0
    s_add_u32 m0, s26, 0
    s_nop 0
    buffer_load_dwordx4 v6, s[4:7], s24 offen lds
    s_add_u32 m0, s26, 1024
    s_nop 0
    buffer_load_dwordx4 v7, s[4:7], s24 offen lds
    s_add_u32 m0, s26, 8192
    s_nop 0
    buffer_load_dwordx4 v8, s[8:11], s25 offen lds
    s_add_u32 m0, s26, 9216
    s_nop 0
    buffer_load_dwordx4 v9, s[8:11], s25 offen lds
    s_mov_b32 s24, 4096
    s_mov_b32 s25, 8192
    s_add_u32 m0, s26, 16384
    s_nop 0
    buffer_load_dwordx4 v6, s[4:7], s24 offen lds
    s_add_u32 m0, s26, 17408
    s_nop 0
    buffer_load_dwordx4 v7, s[4:7], s24 offen lds
    s_add_u32 m0, s26, 24576
    s_nop 0
    buffer_load_dwordx4 v8, s[8:11], s25 offen lds
    s_add_u32 m0, s26, 25600
    s_nop 0
    buffer_load_dwordx4 v9, s[8:11], s25 offen lds
    s_mov_b32 s24, 8192
    s_mov_b32 s25, 16384
    s_add_u32 m0, s26, 32768
    s_nop 0
    buffer_load_dwordx4 v6, s[4:7], s24 offen lds
    s_add_u32 m0, s26, 33792
    s_nop 0
    buffer_load_dwordx4 v7, s[4:7], s24 offen lds
    s_add_u32 m0, s26, 40960
    s_nop 0
    buffer_load_dwordx4 v8, s[8:11], s25 offen lds
    s_add_u32 m0, s26, 41984
    s_nop 0
    buffer_load_dwordx4 v9, s[8:11], s25 offen lds
    s_mov_b32 s24, 12288
    s_mov_b32 s25, 24576
    s_add_u32 m0, s26, 49152
    s_nop 0
    buffer_load_dwordx4 v6, s[4:7], s24 offen lds
    s_add_u32 m0, s26, 50176
    s_nop 0
    buffer_load_dwordx4 v7, s[4:7], s24 offen lds
    s_add_u32 m0, s26, 57344
    s_nop 0
    buffer_load_dwordx4 v8, s[8:11], s25 offen lds
    s_add_u32 m0, s26, 58368
    s_nop 0
    buffer_load_dwordx4 v9, s[8:11], s25 offen lds
    s_mov_b32 s24, 16384
    s_mov_b32 s25, 32768
    s_add_u32 m0, s26, 65536
    s_nop 0
    buffer_load_dwordx4 v6, s[4:7], s24 offen lds
    s_add_u32 m0, s26, 66560
    s_nop 0
    buffer_load_dwordx4 v7, s[4:7], s24 offen lds
    s_add_u32 m0, s26, 73728
    s_nop 0
    buffer_load_dwordx4 v8, s[8:11], s25 offen lds
    s_add_u32 m0, s26, 74752
    s_nop 0
    buffer_load_dwordx4 v9, s[8:11], s25 offen lds
    s_mov_b32 s24, 20480
    s_mov_b32 s25, 40960
    s_add_u32 m0, s26, 81920
    s_nop 0
    buffer_load_dwordx4 v6, s[4:7], s24 offen lds
    s_add_u32 m0, s26, 82944
    s_nop 0
    buffer_load_dwordx4 v7, s[4:7], s24 offen lds
    s_add_u32 m0, s26, 90112
    s_nop 0
    buffer_load_dwordx4 v8, s[8:11], s25 offen lds
    s_add_u32 m0, s26, 91136
    s_nop 0
    buffer_load_dwordx4 v9, s[8:11], s25 offen lds
    s_waitcnt vmcnt(20)
    s_barrier
    s_mov_b32 s24, 24576
    s_mov_b32 s25, 49152
    s_add_u32 m0, s26, 98304
    s_nop 0
    buffer_load_dwordx4 v6, s[4:7], s24 offen lds
    s_add_u32 m0, s26, 99328
    s_nop 0
    buffer_load_dwordx4 v7, s[4:7], s24 offen lds
    s_add_u32 m0, s26, 106496
    s_nop 0
    buffer_load_dwordx4 v8, s[8:11], s25 offen lds
    s_add_u32 m0, s26, 107520
    s_nop 0
    buffer_load_dwordx4 v9, s[8:11], s25 offen lds
    s_waitcnt vmcnt(20)
    s_barrier
    s_mov_b32 s24, 28672
    s_mov_b32 s25, 57344
    s_add_u32 m0, s26, 0
    s_nop 0
    buffer_load_dwordx4 v6, s[4:7], s24 offen lds
    s_add_u32 m0, s26, 1024
    s_nop 0
    buffer_load_dwordx4 v7, s[4:7], s24 offen lds
    s_add_u32 m0, s26, 8192
    s_nop 0
    buffer_load_dwordx4 v8, s[8:11], s25 offen lds
    s_add_u32 m0, s26, 9216
    s_nop 0
    buffer_load_dwordx4 v9, s[8:11], s25 offen lds
    s_waitcnt vmcnt(20)
    s_barrier
    s_mov_b32 s24, 32768
    s_mov_b32 s25, 65536
    s_add_u32 m0, s26, 16384
    s_nop 0
    buffer_load_dwordx4 v6, s[4:7], s24 offen lds
    s_add_u32 m0, s26, 17408
    s_nop 0
    buffer_load_dwordx4 v7, s[4:7], s24 offen lds
    s_add_u32 m0, s26, 24576
    s_nop 0
    buffer_load_dwordx4 v8, s[8:11], s25 offen lds
    s_add_u32 m0, s26, 25600
    s_nop 0
    buffer_load_dwordx4 v9, s[8:11], s25 offen lds
    s_waitcnt vmcnt(20)
    s_barrier
    s_mov_b32 s24, 36864
    s_mov_b32 s25, 73728
    s_add_u32 m0, s26, 32768
    s_nop 0
    buffer_load_dwordx4 v6, s[4:7], s24 offen lds
    s_add_u32 m0, s26, 33792
    s_nop 0
    buffer_load_dwordx4 v7, s[4:7], s24 offen lds
    s_add_u32 m0, s26, 40960
    s_nop 0
    buffer_load_dwordx4 v8, s[8:11], s25 offen lds
    s_add_u32 m0, s26, 41984
    s_nop 0
    buffer_load_dwordx4 v9, s[8:11], s25 offen lds
    s_waitcnt vmcnt(20)
    s_barrier
    s_mov_b32 s24, 40960
    s_mov_b32 s25, 81920
    s_add_u32 m0, s26, 49152
    s_nop 0
    buffer_load_dwordx4 v6, s[4:7], s24 offen lds
    s_add_u32 m0, s26, 50176
    s_nop 0
    buffer_load_dwordx4 v7, s[4:7], s24 offen lds
    s_add_u32 m0, s26, 57344
    s_nop 0
    buffer_load_dwordx4 v8, s[8:11], s25 offen lds
    s_add_u32 m0, s26, 58368
    s_nop 0
    buffer_load_dwordx4 v9, s[8:11], s25 offen lds
    s_waitcnt vmcnt(20)
    s_barrier
    s_mov_b32 s24, 45056
    s_mov_b32 s25, 90112
    s_add_u32 m0, s26, 65536
    s_nop 0
    buffer_load_dwordx4 v6, s[4:7], s24 offen lds
    s_add_u32 m0, s26, 66560
    s_nop 0
    buffer_load_dwordx4 v7, s[4:7], s24 offen lds
    s_add_u32 m0, s26, 73728
    s_nop 0
    buffer_load_dwordx4 v8, s[8:11], s25 offen lds
    s_add_u32 m0, s26, 74752
    s_nop 0
    buffer_load_dwordx4 v9, s[8:11], s25 offen lds
    s_waitcnt vmcnt(20)
    s_barrier
    s_mov_b32 s24, 49152
    s_mov_b32 s25, 98304
    s_add_u32 m0, s26, 81920
    s_nop 0
    buffer_load_dwordx4 v6, s[4:7], s24 offen lds
    s_add_u32 m0, s26, 82944
    s_nop 0
    buffer_load_dwordx4 v7, s[4:7], s24 offen lds
    s_add_u32 m0, s26, 90112
    s_nop 0
    buffer_load_dwordx4 v8, s[8:11], s25 offen lds
    s_add_u32 m0, s26, 91136
    s_nop 0
    buffer_load_dwordx4 v9, s[8:11], s25 offen lds
    s_waitcnt vmcnt(20)
    s_barrier
    s_mov_b32 s36, 13
ffb2_kernel_pl1:
    s_lshl_b32 s24, s36, 12
    s_lshl_b32 s25, s36, 13
    s_cmp_lt_u32 s36, 28
    s_cselect_b32 s24, s24, 0x7ff00000
    s_cselect_b32 s25, s25, 0x7ff00000
    s_add_u32 s36, s36, 1
    s_add_u32 m0, s26, 98304
    s_nop 0
    buffer_load_dwordx4 v6, s[4:7], s24 offen lds
    s_add_u32 m0, s26, 99328
    s_nop 0
    buffer_load_dwordx4 v7, s[4:7], s24 offen lds
    s_add_u32 m0, s26, 106496
    s_nop 0
    buffer_load_dwordx4 v8, s[8:11], s25 offen lds
    s_add_u32 m0, s26, 107520
    s_nop 0
    buffer_load_dwordx4 v9, s[8:11], s25 offen lds
    s_waitcnt vmcnt(20)
    s_barrier
    s_lshl_b32 s24, s36, 12
    s_lshl_b32 s25, s36, 13
    s_cmp_lt_u32 s36, 28
    s_cselect_b32 s24, s24, 0x7ff00000
    s_cselect_b32 s25, s25, 0x7ff00000
    s_add_u32 s36, s36, 1
    s_add_u32 m0, s26, 0
    s_nop 0
    buffer_load_dwordx4 v6, s[4:7], s24 offen lds
    s_add_u32 m0, s26, 1024
    s_nop 0
    buffer_load_dwordx4 v7, s[4:7], s24 offen lds
    s_add_u32 m0, s26, 8192
    s_nop 0
    buffer_load_dwordx4 v8, s[8:11], s25 offen lds
    s_add_u32 m0, s26, 9216
    s_nop 0
    buffer_load_dwordx4 v9, s[8:11], s25 offen lds
    s_waitcnt vmcnt(20)
    s_barrier
    s_lshl_b32 s24, s36, 12
    s_lshl_b32 s25, s36, 13
    s_cmp_lt_u32 s36, 28
    s_cselect_b32 s24, s24, 0x7ff00000
    s_cselect_b32 s25, s25, 0x7ff00000
    s_add_u32 s36, s36, 1
    s_add_u32 m0, s26, 16384
    s_nop 0
    buffer_load_dwordx4 v6, s[4:7], s24 offen lds
    s_add_u32 m0, s26, 17408
    s_nop 0
    buffer_load_dwordx4 v7, s[4:7], s24 offen lds
    s_add_u32 m0, s26, 24576
    s_nop 0
    buffer_load_dwordx4 v8, s[8:11], s25 offen lds
    s_add_u32 m0, s26, 25600
    s_nop 0
    buffer_load_dwordx4 v9, s[8:11], s25 offen lds
    s_waitcnt vmcnt(20)
    s_barrier
    s_lshl_b32 s24, s36, 12
    s_lshl_b32 s25, s36, 13
    s_cmp_lt_u32 s36, 28
    s_cselect_b32 s24, s24, 0x7ff00000
    s_cselect_b32 s25, s25, 0x7ff00000
    s_add_u32 s36, s36, 1
    s_add_u32 m0, s26, 32768
    s_nop 0
    buffer_load_dwordx4 v6, s[4:7], s24 offen lds
    s_add_u32 m0, s26, 33792
    s_nop 0
    buffer_load_dwordx4 v7, s[4:7], s24 offen lds
    s_add_u32 m0, s26, 40960
    s_nop 0
    buffer_load_dwordx4 v8, s[8:11], s25 offen lds
    s_add_u32 m0, s26, 41984
    s_nop 0
    buffer_load_dwordx4 v9, s[8:11], s25 offen lds
    s_waitcnt vmcnt(20)
    s_barrier
    s_lshl_b32 s24, s36, 12
    s_lshl_b32 s25, s36, 13
    s_cmp_lt_u32 s36, 28
    s_cselect_b32 s24, s24, 0x7ff00000
    s_cselect_b32 s25, s25, 0x7ff00000
    s_add_u32 s36, s36, 1
    s_add_u32 m0, s26, 49152
    s_nop 0
    buffer_load_dwordx4 v6, s[4:7], s24 offen lds
    s_add_u32 m0, s26, 50176
    s_nop 0
    buffer_load_dwordx4 v7, s[4:7], s24 offen lds
    s_add_u32 m0, s26, 57344
    s_nop 0
    buffer_load_dwordx4 v8, s[8:11], s25 offen lds
    s_add_u32 m0, s26, 58368
    s_nop 0
    buffer_load_dwordx4 v9, s[8:11], s25 offen lds
    s_waitcnt vmcnt(20)
    s_barrier
    s_lshl_b32 s24, s36, 12
    s_lshl_b32 s25, s36, 13
    s_cmp_lt_u32 s36, 28
    s_cselect_b32 s24, s24, 0x7ff00000
    s_cselect_b32 s25, s25, 0x7ff00000
    s_add_u32 s36, s36, 1
    s_add_u32 m0, s26, 65536
    s_nop 0
    buffer_load_dwordx4 v6, s[4:7], s24 offen lds
    s_add_u32 m0, s26, 66560
    s_nop 0
    buffer_load_dwordx4 v7, s[4:7], s24 offen lds
    s_add_u32 m0, s26, 73728
    s_nop 0
    buffer_load_dwordx4 v8, s[8:11], s25 offen lds
    s_add_u32 m0, s26, 74752
    s_nop 0
    buffer_load_dwordx4 v9, s[8:11], s25 offen lds
    s_waitcnt vmcnt(20)
    s_barrier
    s_lshl_b32 s24, s36, 12
    s_lshl_b32 s25, s36, 13
    s_cmp_lt_u32 s36, 28
    s_cselect_b32 s24, s24, 0x7ff00000
    s_cselect_b32 s25, s25, 0x7ff00000
    s_add_u32 s36, s36, 1
    s_add_u32 m0, s26, 81920
    s_nop 0
    buffer_load_dwordx4 v6, s[4:7], s24 offen lds
    s_add_u32 m0, s26, 82944
    s_nop 0
    buffer_load_dwordx4 v7, s[4:7], s24 offen lds
    s_add_u32 m0, s26, 90112
    s_nop 0
    buffer_load_dwordx4 v8, s[8:11], s25 offen lds
    s_add_u32 m0, s26, 91136
    s_nop 0
    buffer_load_dwordx4 v9, s[8:11], s25 offen lds
    s_waitcnt vmcnt(20)
    s_barrier
    s_cmp_lt_u32 s36, 34
    s_cbranch_scc1 ffb2_kernel_pl1
    s_endpgm
ffb2_kernel_comp:
    s_lshl_b32 s22, s20, 1
    s_and_b32 s23, s3, 1
    s_add_u32 s22, s22, s23
    s_lshl_b32 s23, s21, 1
    s_lshr_b32 s25, s3, 1
    s_add_u32 s23, s23, s25
    s_lshl_b32 s24, s22, 15
    s_lshl_b32 s25, s23, 6
    s_add_u32 s25, s24, s25
    v_and_b32 v4, 31, v1
    v_lshlrev_b32 v4, 10, v4
    v_lshrrev_b32 v2, 5, v1
    v_lshl_add_u32 v4, v2, 4, v4
    v_add_u32 v4, s25, v4
    s_lshl_b32 s25, s23, 11
    s_add_u32 s25, s24, s25
    v_lshlrev_b32 v5, 4, v1
    v_add_u32 v5, s25, v5
    v_mov_b32 v88, v4
    v_mov_b32 v89, v5
    s_lshl_b32 s27, s22, 12
    s_lshl_b32 s23, s23, 3
    s_add_u32 s27, s27, s23
    s_add_u32 s27, s27, 14680064
    s_and_b32 s22, s3, 1
    s_lshl_b32 s22, s22, 12
    v_lshlrev_b32 v10, 4, v1
    v_add_u32 v10, s22, v10
    v_add_u32 v11, 1024, v10
    v_add_u32 v12, 2048, v10
    v_add_u32 v13, 3072, v10
    v_add_u32 v14, 65536, v10
    v_add_u32 v15, 65536, v11
    v_add_u32 v16, 65536, v12
    v_add_u32 v17, 65536, v13
    s_lshr_b32 s22, s3, 1
    v_bfe_u32 v2, v1, 2, 2
    v_lshrrev_b32 v3, 5, v1
    v_lshl_add_u32 v3, v3, 3, v2
    v_lshlrev_b32 v3, 7, v3
    v_lshrrev_b32 v4, 1, v2
    v_xor_b32 v4, s22, v4
    v_lshl_add_u32 v3, v4, 6, v3
    v_bfe_u32 v4, v1, 4, 1
    v_lshl_add_u32 v3, v4, 5, v3
    v_and_b32 v4, 3, v1
    v_lshl_add_u32 v3, v4, 3, v3
    v_add_u32 v18, 8192, v3
    v_add_u32 v19, 65536, v18
    v_mov_b32 v20, 0x3f803f80
    v_mov_b32 v56, 0
    v_mov_b32 v57, 0
    v_mov_b32 v58, 0
    v_mov_b32 v59, 0
    v_mov_b32 v60, 0
    v_mov_b32 v61, 0
    v_mov_b32 v62, 0
    v_mov_b32 v63, 0
    v_mov_b32 v64, 0
    v_mov_b32 v65, 0
    v_mov_b32 v66, 0
    v_mov_b32 v67, 0
    v_mov_b32 v68, 0
    v_mov_b32 v69, 0
    v_mov_b32 v70, 0
    v_mov_b32 v71, 0
    s_waitcnt lgkmcnt(0)
    s_add_u32 s16, s28, 0xc00000
    s_addc_u32 s17, s29, 0
    s_and_b32 s17, s17, 0xffff
    s_mov_b32 s18, 0x200000
    s_mov_b32 s19, 0x00020000
    buffer_load_dwordx4 v[72:75], v89, s[16:19], 0 offen offset:0
    buffer_load_dwordx4 v[76:79], v89, s[16:19], 0 offen offset:1024
    s_mov_b32 s12, s34
    s_mov_b32 s13, s35
    s_and_b32 s13, s13, 0xffff
    s_mov_b32 s14, 0x200000
    s_mov_b32 s15, 0x00020000
    s_barrier
    ds_read_b128 v[24:27], v10 offset:0
    ds_read_b64_tr_b16 v[40:41], v18 offset:0
    ds_read_b64_tr_b16 v[42:43], v18 offset:512
    ds_read_b128 v[28:31], v11 offset:0
    ds_read_b64_tr_b16 v[44:45], v18 offset:2048
    ds_read_b64_tr_b16 v[46:47], v18 offset:2560
    s_mov_b32 s36, 0
ffb2_kernel_lp2:
    s_waitcnt lgkmcnt(3)
    v_mfma_f32_32x32x16_bf16 v[56:71], v[40:43], v[24:27], v[56:71]
    ds_read_b128 v[32:35], v12 offset:0
    ds_read_b64_tr_b16 v[48:49], v18 offset:4096
    ds_read_b64_tr_b16 v[50:51], v18 offset:4608
    s_waitcnt lgkmcnt(3)
    v_mfma_f32_32x32x16_bf16 v[56:71], v[44:47], v[28:31], v[56:71]
    ds_read_b128 v[36:39], v13 offset:0
    ds_read_b64_tr_b16 v[52:53], v18 offset:6144
    ds_read_b64_tr_b16 v[54:55], v18 offset:6656
    s_waitcnt lgkmcnt(0)
    s_barrier
    v_mfma_f32_32x32x16_bf16 v[56:71], v[48:51], v[32:35], v[56:71]
    ds_read_b128 v[24:27], v10 offset:16384
    ds_read_b64_tr_b16 v[40:41], v18 offset:16384
    ds_read_b64_tr_b16 v[42:43], v18 offset:16896
    s_waitcnt lgkmcnt(3)
    v_mfma_f32_32x32x16_bf16 v[56:71], v[52:55], v[36:39], v[56:71]
    ds_read_b128 v[28:31], v11 offset:16384
    ds_read_b64_tr_b16 v[44:45], v18 offset:18432
    ds_read_b64_tr_b16 v[46:47], v18 offset:18944
    s_waitcnt lgkmcnt(3)
    v_mfma_f32_32x32x16_bf16 v[56:71], v[40:43], v[24:27], v[56:71]
    ds_read_b128 v[32:35], v12 offset:16384
    ds_read_b64_tr_b16 v[48:49], v18 offset:20480
    ds_read_b64_tr_b16 v[50:51], v18 offset:20992
    s_waitcnt lgkmcnt(3)
    v_mfma_f32_32x32x16_bf16 v[56:71], v[44:47], v[28:31], v[56:71]
    ds_read_b128 v[36:39], v13 offset:16384
    ds_read_b64_tr_b16 v[52:53], v18 offset:22528
    ds_read_b64_tr_b16 v[54:55], v18 offset:23040
    s_waitcnt lgkmcnt(0)
    s_barrier
    v_mfma_f32_32x32x16_bf16 v[56:71], v[48:51], v[32:35], v[56:71]
    ds_read_b128 v[24:27], v10 offset:32768
    ds_read_b64_tr_b16 v[40:41], v18 offset:32768
    ds_read_b64_tr_b16 v[42:43], v18 offset:33280
    s_waitcnt lgkmcnt(3)
    v_mfma_f32_32x32x16_bf16 v[56:71], v[52:55], v[36:39], v[56:71]
    ds_read_b128 v[28:31], v11 offset:32768
    ds_read_b64_tr_b16 v[44:45], v18 offset:34816
    ds_read_b64_tr_b16 v[46:47], v18 offset:35328
    s_waitcnt lgkmcnt(3)
    v_mfma_f32_32x32x16_bf16 v[56:71], v[40:43], v[24:27], v[56:71]
    ds_read_b128 v[32:35], v12 offset:32768
    ds_read_b64_tr_b16 v[48:49], v18 offset:36864
    ds_read_b64_tr_b16 v[50:51], v18 offset:37376
    s_waitcnt lgkmcnt(3)
    v_mfma_f32_32x32x16_bf16 v[56:71], v[44:47], v[28:31], v[56:71]
    ds_read_b128 v[36:39], v13 offset:32768
    ds_read_b64_tr_b16 v[52:53], v18 offset:38912
    ds_read_b64_tr_b16 v[54:55], v18 offset:39424
    s_waitcnt lgkmcnt(0)
    s_barrier
    v_mfma_f32_32x32x16_bf16 v[56:71], v[48:51], v[32:35], v[56:71]
    ds_read_b128 v[24:27], v10 offset:49152
    ds_read_b64_tr_b16 v[40:41], v18 offset:49152
    ds_read_b64_tr_b16 v[42:43], v18 offset:49664
    s_waitcnt lgkmcnt(3)
    v_mfma_f32_32x32x16_bf16 v[56:71], v[52:55], v[36:39], v[56:71]
    ds_read_b128 v[28:31], v11 offset:49152
    ds_read_b64_tr_b16 v[44:45], v18 offset:51200
    ds_read_b64_tr_b16 v[46:47], v18 offset:51712
    s_waitcnt lgkmcnt(3)
    v_mfma_f32_32x32x16_bf16 v[56:71], v[40:43], v[24:27], v[56:71]
    ds_read_b128 v[32:35], v12 offset:49152
    ds_read_b64_tr_b16 v[48:49], v18 offset:53248
    ds_read_b64_tr_b16 v[50:51], v18 offset:53760
    s_waitcnt lgkmcnt(3)
    v_mfma_f32_32x32x16_bf16 v[56:71], v[44:47], v[28:31], v[56:71]
    ds_read_b128 v[36:39], v13 offset:49152
    ds_read_b64_tr_b16 v[52:53], v18 offset:55296
    ds_read_b64_tr_b16 v[54:55], v18 offset:55808
    s_waitcnt lgkmcnt(0)
    s_barrier
    v_mfma_f32_32x32x16_bf16 v[56:71], v[48:51], v[32:35], v[56:71]
    ds_read_b128 v[24:27], v14 offset:0
    ds_read_b64_tr_b16 v[40:41], v19 offset:0
    ds_read_b64_tr_b16 v[42:43], v19 offset:512
    s_waitcnt lgkmcnt(3)
    v_mfma_f32_32x32x16_bf16 v[56:71], v[52:55], v[36:39], v[56:71]
    ds_read_b128 v[28:31], v15 offset:0
    ds_read_b64_tr_b16 v[44:45], v19 offset:2048
    ds_read_b64_tr_b16 v[46:47], v19 offset:2560
    s_waitcnt lgkmcnt(3)
    v_mfma_f32_32x32x16_bf16 v[56:71], v[40:43], v[24:27], v[56:71]
    ds_read_b128 v[32:35], v16 offset:0
    ds_read_b64_tr_b16 v[48:49], v19 offset:4096
    ds_read_b64_tr_b16 v[50:51], v19 offset:4608
    s_waitcnt lgkmcnt(3)
    v_mfma_f32_32x32x16_bf16 v[56:71], v[44:47], v[28:31], v[56:71]
    ds_read_b128 v[36:39], v17 offset:0
    ds_read_b64_tr_b16 v[52:53], v19 offset:6144
    ds_read_b64_tr_b16 v[54:55], v19 offset:6656
    s_waitcnt lgkmcnt(0)
    s_barrier
    v_mfma_f32_32x32x16_bf16 v[56:71], v[48:51], v[32:35], v[56:71]
    ds_read_b128 v[24:27], v14 offset:16384
    ds_read_b64_tr_b16 v[40:41], v19 offset:16384
    ds_read_b64_tr_b16 v[42:43], v19 offset:16896
    s_waitcnt lgkmcnt(3)
    v_mfma_f32_32x32x16_bf16 v[56:71], v[52:55], v[36:39], v[56:71]
    ds_read_b128 v[28:31], v15 offset:16384
    ds_read_b64_tr_b16 v[44:45], v19 offset:18432
    ds_read_b64_tr_b16 v[46:47], v19 offset:18944
    s_waitcnt lgkmcnt(3)
    v_mfma_f32_32x32x16_bf16 v[56:71], v[40:43], v[24:27], v[56:71]
    ds_read_b128 v[32:35], v16 offset:16384
    ds_read_b64_tr_b16 v[48:49], v19 offset:20480
    ds_read_b64_tr_b16 v[50:51], v19 offset:20992
    s_waitcnt lgkmcnt(3)
    v_mfma_f32_32x32x16_bf16 v[56:71], v[44:47], v[28:31], v[56:71]
    ds_read_b128 v[36:39], v17 offset:16384
    ds_read_b64_tr_b16 v[52:53], v19 offset:22528
    ds_read_b64_tr_b16 v[54:55], v19 offset:23040
    s_waitcnt lgkmcnt(0)
    s_barrier
    v_mfma_f32_32x32x16_bf16 v[56:71], v[48:51], v[32:35], v[56:71]
    ds_read_b128 v[24:27], v14 offset:32768
    ds_read_b64_tr_b16 v[40:41], v19 offset:32768
    ds_read_b64_tr_b16 v[42:43], v19 offset:33280
    s_waitcnt lgkmcnt(3)
    v_mfma_f32_32x32x16_bf16 v[56:71], v[52:55], v[36:39], v[56:71]
    ds_read_b128 v[28:31], v15 offset:32768
    ds_read_b64_tr_b16 v[44:45], v19 offset:34816
    ds_read_b64_tr_b16 v[46:47], v19 offset:35328
    s_waitcnt lgkmcnt(3)
    v_mfma_f32_32x32x16_bf16 v[56:71], v[40:43], v[24:27], v[56:71]
    ds_read_b128 v[32:35], v16 offset:32768
    ds_read_b64_tr_b16 v[48:49], v19 offset:36864
    ds_read_b64_tr_b16 v[50:51], v19 offset:37376
    s_waitcnt lgkmcnt(3)
    v_mfma_f32_32x32x16_bf16 v[56:71], v[44:47], v[28:31], v[56:71]
    ds_read_b128 v[36:39], v17 offset:32768
    ds_read_b64_tr_b16 v[52:53], v19 offset:38912
    ds_read_b64_tr_b16 v[54:55], v19 offset:39424
    s_waitcnt lgkmcnt(0)
    s_barrier
    v_mfma_f32_32x32x16_bf16 v[56:71], v[48:51], v[32:35], v[56:71]
    ds_read_b128 v[24:27], v10 offset:0
    ds_read_b64_tr_b16 v[40:41], v18 offset:0
    ds_read_b64_tr_b16 v[42:43], v18 offset:512
    s_waitcnt lgkmcnt(3)
    v_mfma_f32_32x32x16_bf16 v[56:71], v[52:55], v[36:39], v[56:71]
    ds_read_b128 v[28:31], v11 offset:0
    ds_read_b64_tr_b16 v[44:45], v18 offset:2048
    ds_read_b64_tr_b16 v[46:47], v18 offset:2560
    s_add_u32 s36, s36, 1
    s_cmp_lt_u32 s36, 4
    s_cbranch_scc1 ffb2_kernel_lp2
    s_waitcnt lgkmcnt(0)
    s_waitcnt vmcnt(0)
    s_nop 15
    v_cvt_pk_bf16_f32 v80, v56, v57
    v_cvt_pk_bf16_f32 v81, v58, v59
    v_cvt_pk_bf16_f32 v82, v60, v61
    v_cvt_pk_bf16_f32 v83, v62, v63
    v_cvt_pk_bf16_f32 v84, v64, v65
    v_cvt_pk_bf16_f32 v85, v66, v67
    v_cvt_pk_bf16_f32 v86, v68, v69
    v_cvt_pk_bf16_f32 v87, v70, v71
    s_nop 0
    v_permlane32_swap_b32 v80, v82
    v_permlane32_swap_b32 v81, v83
    v_permlane32_swap_b32 v84, v86
    v_permlane32_swap_b32 v85, v87
    v_lshlrev_b32 v2, 16, v80
    v_lshlrev_b32 v3, 16, v72
    v_add_f32 v2, v2, v3
    v_and_b32 v4, 0xffff0000, v80
    v_and_b32 v5, 0xffff0000, v72
    v_add_f32 v4, v4, v5
    v_cvt_pk_bf16_f32 v80, v2, v4
    v_lshlrev_b32 v2, 16, v81
    v_lshlrev_b32 v3, 16, v73
    v_add_f32 v2, v2, v3
    v_and_b32 v4, 0xffff0000, v81
    v_and_b32 v5, 0xffff0000, v73
    v_add_f32 v4, v4, v5
    v_cvt_pk_bf16_f32 v81, v2, v4
    v_lshlrev_b32 v2, 16, v82
    v_lshlrev_b32 v3, 16, v74
    v_add_f32 v2, v2, v3
    v_and_b32 v4, 0xffff0000, v82
    v_and_b32 v5, 0xffff0000, v74
    v_add_f32 v4, v4, v5
    v_cvt_pk_bf16_f32 v82, v2, v4
    v_lshlrev_b32 v2, 16, v83
    v_lshlrev_b32 v3, 16, v75
    v_add_f32 v2, v2, v3
    v_and_b32 v4, 0xffff0000, v83
    v_and_b32 v5, 0xffff0000, v75
    v_add_f32 v4, v4, v5
    v_cvt_pk_bf16_f32 v83, v2, v4
    buffer_store_dwordx4 v[80:83], v88, s[12:15], 0 offen offset:0
    v_lshlrev_b32 v2, 16, v84
    v_lshlrev_b32 v3, 16, v76
    v_add_f32 v2, v2, v3
    v_and_b32 v4, 0xffff0000, v84
    v_and_b32 v5, 0xffff0000, v76
    v_add_f32 v4, v4, v5
    v_cvt_pk_bf16_f32 v84, v2, v4
    v_lshlrev_b32 v2, 16, v85
    v_lshlrev_b32 v3, 16, v77
    v_add_f32 v2, v2, v3
    v_and_b32 v4, 0xffff0000, v85
    v_and_b32 v5, 0xffff0000, v77
    v_add_f32 v4, v4, v5
    v_cvt_pk_bf16_f32 v85, v2, v4
    v_lshlrev_b32 v2, 16, v86
    v_lshlrev_b32 v3, 16, v78
    v_add_f32 v2, v2, v3
    v_and_b32 v4, 0xffff0000, v86
    v_and_b32 v5, 0xffff0000, v78
    v_add_f32 v4, v4, v5
    v_cvt_pk_bf16_f32 v86, v2, v4
    v_lshlrev_b32 v2, 16, v87
    v_lshlrev_b32 v3, 16, v79
    v_add_f32 v2, v2, v3
    v_and_b32 v4, 0xffff0000, v87
    v_and_b32 v5, 0xffff0000, v79
    v_add_f32 v4, v4, v5
    v_cvt_pk_bf16_f32 v87, v2, v4
    buffer_store_dwordx4 v[84:87], v88, s[12:15], 0 offen offset:32
ffb2_kernel_end:
    s_endpgm
.section .rodata,"a"
.p2align 6
.amdhsa_kernel ffb2_kernel
  .amdhsa_next_free_vgpr 96
  .amdhsa_next_free_sgpr 96
  .amdhsa_accum_offset 96
  .amdhsa_group_segment_fixed_size 0
  .amdhsa_kernarg_size 80
  .amdhsa_user_sgpr_count 2
  .amdhsa_user_sgpr_kernarg_segment_ptr 1
  .amdhsa_system_sgpr_workgroup_id_x 1
.end_amdhsa_kernel
```
